```python
import torch

def _softmax(x, axis=-1):
    return torch.softmax(x, dim=axis)

def _gelu(x):
    return torch.nn.functional.gelu(x, approximate='tanh')

def _silu(x):
    return torch.nn.functional.silu(x)

def _sigmoid(x):
    return torch.sigmoid(x)

def _layernorm(x, axis=-1, eps=1e-05):
    m = x.mean(dim=axis, keepdim=True)
    v = x.var(dim=axis, keepdim=True, unbiased=False)
    return (x - m) / torch.sqrt(v + eps)

def _scatter_add(tgt, idx, src, axis=0):
    return tgt.clone().index_add_(axis, idx, src)

def _segment_sum(src, seg, n):
    out = torch.zeros((n,) + src.shape[1:], dtype=src.dtype)
    return out.index_add_(0, seg, src)

def _pad(x, pw):
    flat = tuple((v for pair in reversed(pw) for v in pair))
    return torch.nn.functional.pad(x, flat)
kernel_name = 'standalone__dilated_atrous__vision'

def setup_inputs():

    _w = lambda a: (lambda t: t.to(torch.bfloat16) if t.is_floating_point() else t)(torch.as_tensor(a))
    H = W = 224
    C = 192
    k = 3
    return {'x': _w((lambda *s: torch.randn(*s, dtype=torch.bfloat16) * 0.05)(1, H, W, C)), 'w': _w((lambda *s: torch.randn(*s, dtype=torch.bfloat16) * 0.05)(k, k, C, C) * (1.0 / (k * C ** 0.5)))}

def reference(x, w):
    B, H, W, C = x.shape
    k = 3
    rate = 2
    pad = (k - 1) * rate // 2
    xp = _pad(x, ((0, 0), (pad, pad), (pad, pad), (0, 0)))
    out = torch.zeros_like(x)
    for i in range(k):
        for j in range(k):
            tap = xp[:, i * rate:i * rate + H, j * rate:j * rate + W, :].clone()
            out = out + torch.einsum('bhwc,co->bhwo', tap, w[i, j])
    return out
```

```asm
; @launch grid=(224,1,1) block=(512,1,1) lds=158976
.amdgcn_target "amdgcn-amd-amdhsa--gfx950"
.text
.globl standalone__dilated_atrous__vision_kernel
.p2align 8
.type standalone__dilated_atrous__vision_kernel,@function
standalone__dilated_atrous__vision_kernel:
s_cmp_ge_u32 s2, 224
s_cbranch_scc1 L_end
s_load_dwordx4 s[4:7], s[0:1], 0
s_load_dwordx4 s[68:71], s[0:1], 16
s_load_dwordx2 s[20:21], s[0:1], 32
v_lshrrev_b32 v1, 6, v0
v_and_b32 v0, 63, v0
v_readfirstlane_b32 s3, v1
s_and_b32 s22, s2, 7
s_lshr_b32 s23, s2, 3
s_lshr_b32 s24, s22, 1
s_lshr_b32 s25, s24, 1
s_and_b32 s26, s24, 1
s_and_b32 s27, s22, 1
s_lshl_b32 s27, s27, 2
s_and_b32 s28, s23, 3
s_add_u32 s28, s28, s27
s_lshr_b32 s27, s23, 2
s_mov_b32 s97, s2
s_lshl_b32 s29, s27, 4
s_mul_i32 s30, s28, 14
s_cmp_ge_u32 s3, 4
s_cbranch_scc1 L_producer
s_mul_i32 s33, s3, 96
v_add_u32 v96, 0, v0
v_mul_u32_u24 v97, 10923, v96
v_lshrrev_b32 v97, 16, v97
v_mul_u32_u24 v98, 6, v97
v_sub_u32 v96, v96, v98
v_and_b32 v98, 0x13, v97
v_and_b32 v99, 4, v97
v_lshl_or_b32 v98, v99, 1, v98
v_bfe_u32 v99, v97, 3, 1
v_lshl_or_b32 v98, v99, 2, v98
v_mul_u32_u24 v98, 384, v98
v_lshl_add_u32 v98, v96, 4, v98
v_add_u32 v88, s33, v98
v_add_u32 v96, 64, v0
v_mul_u32_u24 v97, 10923, v96
v_lshrrev_b32 v97, 16, v97
v_mul_u32_u24 v98, 6, v97
v_sub_u32 v96, v96, v98
v_and_b32 v98, 0x13, v97
v_and_b32 v99, 4, v97
v_lshl_or_b32 v98, v99, 1, v98
v_bfe_u32 v99, v97, 3, 1
v_lshl_or_b32 v98, v99, 2, v98
v_mul_u32_u24 v98, 384, v98
v_lshl_add_u32 v98, v96, 4, v98
v_add_u32 v89, s33, v98
v_subrev_u32 v89, 1024, v89
v_add_u32 v96, 128, v0
v_mul_u32_u24 v97, 10923, v96
v_lshrrev_b32 v97, 16, v97
v_mul_u32_u24 v98, 6, v97
v_sub_u32 v96, v96, v98
v_and_b32 v98, 0x13, v97
v_and_b32 v99, 4, v97
v_lshl_or_b32 v98, v99, 1, v98
v_bfe_u32 v99, v97, 3, 1
v_lshl_or_b32 v98, v99, 2, v98
v_mul_u32_u24 v98, 384, v98
v_lshl_add_u32 v98, v96, 4, v98
v_add_u32 v90, s33, v98
v_subrev_u32 v90, 2048, v90
s_mul_i32 s95, s3, 15360
s_add_u32 s95, s95, 97536
s_waitcnt lgkmcnt(0)
s_mov_b32 s72, s6
s_mov_b32 s73, s7
s_mov_b32 s74, 663552
s_mov_b32 s75, 0x20000
s_mov_b32 s12, s20
s_mov_b32 s13, s21
s_mov_b32 s14, 884736
s_mov_b32 s15, 0x20000
s_mov_b32 s34, 0
s_add_u32 m0, s95, 0
s_nop 0
buffer_load_dwordx4 v88, s[72:75], s34 offen offset:0 lds
buffer_load_dwordx4 v89, s[72:75], s34 offen offset:1024 lds
buffer_load_dwordx4 v90, s[72:75], s34 offen offset:2048 lds
s_mov_b32 s34, 221184
s_add_u32 m0, s95, 3072
s_nop 0
buffer_load_dwordx4 v88, s[72:75], s34 offen offset:0 lds
buffer_load_dwordx4 v89, s[72:75], s34 offen offset:1024 lds
buffer_load_dwordx4 v90, s[72:75], s34 offen offset:2048 lds
v_and_b32 v4, 15, v0
v_lshrrev_b32 v5, 4, v0
s_mul_i32 s31, s3, 3072
v_lshlrev_b32 v255, 4, v0
v_add_u32 v255, s31, v255
v_add_u32 v6, 0, v4
v_bfe_u32 v7, v6, 2, 1
v_lshlrev_b32 v7, 1, v7
v_xor_b32 v7, v7, v5
v_lshlrev_b32 v7, 4, v7
v_lshl_add_u32 v252, v6, 6, v7
v_add_u32 v6, 7, v4
v_bfe_u32 v7, v6, 2, 1
v_lshlrev_b32 v7, 1, v7
v_xor_b32 v7, v7, v5
v_lshlrev_b32 v7, 4, v7
v_lshl_add_u32 v253, v6, 6, v7
v_add_u32 v6, 14, v4
v_bfe_u32 v7, v6, 2, 1
v_lshlrev_b32 v7, 1, v7
v_xor_b32 v7, v7, v5
v_lshlrev_b32 v7, 4, v7
v_lshl_add_u32 v254, v6, 6, v7
s_mul_i32 s33, s3, 96
v_mul_u32_u24 v6, 400, v4
v_add_u32 v6, s33, v6
v_lshl_add_u32 v1, v5, 3, v6
v_lshrrev_b32 v96, 5, v0
v_lshlrev_b32 v96, 4, v96
v_bfe_u32 v97, v0, 4, 1
v_lshl_add_u32 v96, v97, 2, v96
v_bfe_u32 v97, v0, 2, 2
v_add_u32 v96, v96, v97
v_mul_u32_u24 v96, 96, v96
v_and_b32 v97, 3, v0
v_lshl_add_u32 v96, v97, 3, v96
v_add_u32 v91, s95, v96
s_waitcnt vmcnt(3)
ds_read_b64_tr_b16 v[192:193], v91 offset:0
ds_read_b64_tr_b16 v[194:195], v91 offset:768
ds_read_b64_tr_b16 v[196:197], v91 offset:32
ds_read_b64_tr_b16 v[198:199], v91 offset:800
ds_read_b64_tr_b16 v[200:201], v91 offset:64
ds_read_b64_tr_b16 v[202:203], v91 offset:832
s_barrier
s_setprio 3
ds_read_b128 v[172:175], v252 offset:0
ds_read_b128 v[176:179], v252 offset:1024
ds_read_b128 v[180:183], v252 offset:2048
ds_read_b128 v[184:187], v252 offset:3072
ds_read_b128 v[188:191], v252 offset:4096
s_waitcnt lgkmcnt(5)
s_waitcnt lgkmcnt(3)
v_mfma_f32_16x16x32_bf16 v[4:7], v[192:195], v[172:175], 0
s_waitcnt vmcnt(0)
v_mfma_f32_16x16x32_bf16 v[8:11], v[196:199], v[172:175], 0
ds_read_b64_tr_b16 v[204:205], v91 offset:3072
v_mfma_f32_16x16x32_bf16 v[12:15], v[200:203], v[172:175], 0
ds_read_b128 v[172:175], v252 offset:5120
v_mfma_f32_16x16x32_bf16 v[16:19], v[192:195], v[176:179], 0
ds_read_b64_tr_b16 v[206:207], v91 offset:3840
v_mfma_f32_16x16x32_bf16 v[20:23], v[196:199], v[176:179], 0
ds_read_b64_tr_b16 v[208:209], v91 offset:3104
v_mfma_f32_16x16x32_bf16 v[24:27], v[200:203], v[176:179], 0
ds_read_b128 v[176:179], v252 offset:6144
s_waitcnt lgkmcnt(6)
v_mfma_f32_16x16x32_bf16 v[28:31], v[192:195], v[180:183], 0
ds_read_b64_tr_b16 v[210:211], v91 offset:3872
v_mfma_f32_16x16x32_bf16 v[32:35], v[196:199], v[180:183], 0
ds_read_b64_tr_b16 v[212:213], v91 offset:3136
v_mfma_f32_16x16x32_bf16 v[36:39], v[200:203], v[180:183], 0
ds_read_b128 v[180:183], v253 offset:0
v_mfma_f32_16x16x32_bf16 v[40:43], v[192:195], v[184:187], 0
ds_read_b64_tr_b16 v[214:215], v91 offset:3904
v_mfma_f32_16x16x32_bf16 v[44:47], v[196:199], v[184:187], 0
s_mov_b32 s34, 442368
s_add_u32 m0, s95, 6144
v_mfma_f32_16x16x32_bf16 v[48:51], v[200:203], v[184:187], 0
ds_read_b128 v[184:187], v253 offset:1024
buffer_load_dwordx4 v88, s[72:75], s34 offen offset:0 lds
s_waitcnt lgkmcnt(8)
v_mfma_f32_16x16x32_bf16 v[52:55], v[192:195], v[188:191], 0
buffer_load_dwordx4 v89, s[72:75], s34 offen offset:1024 lds
v_mfma_f32_16x16x32_bf16 v[56:59], v[196:199], v[188:191], 0
buffer_load_dwordx4 v90, s[72:75], s34 offen offset:2048 lds
v_mfma_f32_16x16x32_bf16 v[60:63], v[200:203], v[188:191], 0
ds_read_b128 v[188:191], v253 offset:2048
v_mfma_f32_16x16x32_bf16 v[64:67], v[192:195], v[172:175], 0
s_mov_b32 s34, 12288
s_add_u32 m0, s95, 9216
v_mfma_f32_16x16x32_bf16 v[68:71], v[196:199], v[172:175], 0
buffer_load_dwordx4 v88, s[72:75], s34 offen offset:0 lds
v_mfma_f32_16x16x32_bf16 v[72:75], v[200:203], v[172:175], 0
ds_read_b128 v[172:175], v253 offset:3072
s_waitcnt lgkmcnt(4)
v_mfma_f32_16x16x32_bf16 v[76:79], v[192:195], v[176:179], 0
buffer_load_dwordx4 v89, s[72:75], s34 offen offset:1024 lds
v_mfma_f32_16x16x32_bf16 v[80:83], v[196:199], v[176:179], 0
buffer_load_dwordx4 v90, s[72:75], s34 offen offset:2048 lds
v_mfma_f32_16x16x32_bf16 v[84:87], v[200:203], v[176:179], 0
ds_read_b128 v[176:179], v253 offset:4096
s_waitcnt lgkmcnt(4)
v_mfma_f32_16x16x32_bf16 v[4:7], v[204:207], v[180:183], v[4:7]
s_waitcnt vmcnt(3)
v_mfma_f32_16x16x32_bf16 v[8:11], v[208:211], v[180:183], v[8:11]
ds_read_b64_tr_b16 v[216:217], v91 offset:6144
v_mfma_f32_16x16x32_bf16 v[12:15], v[212:215], v[180:183], v[12:15]
ds_read_b128 v[180:183], v253 offset:5120
s_waitcnt lgkmcnt(4)
v_mfma_f32_16x16x32_bf16 v[16:19], v[204:207], v[184:187], v[16:19]
ds_read_b64_tr_b16 v[218:219], v91 offset:6912
v_mfma_f32_16x16x32_bf16 v[20:23], v[208:211], v[184:187], v[20:23]
ds_read_b64_tr_b16 v[220:221], v91 offset:6176
v_mfma_f32_16x16x32_bf16 v[24:27], v[212:215], v[184:187], v[24:27]
ds_read_b128 v[184:187], v253 offset:6144
v_mfma_f32_16x16x32_bf16 v[28:31], v[204:207], v[188:191], v[28:31]
ds_read_b64_tr_b16 v[222:223], v91 offset:6944
v_mfma_f32_16x16x32_bf16 v[32:35], v[208:211], v[188:191], v[32:35]
ds_read_b64_tr_b16 v[224:225], v91 offset:6208
v_mfma_f32_16x16x32_bf16 v[36:39], v[212:215], v[188:191], v[36:39]
ds_read_b128 v[188:191], v254 offset:0
s_waitcnt lgkmcnt(8)
v_mfma_f32_16x16x32_bf16 v[40:43], v[204:207], v[172:175], v[40:43]
ds_read_b64_tr_b16 v[226:227], v91 offset:6976
v_mfma_f32_16x16x32_bf16 v[44:47], v[208:211], v[172:175], v[44:47]
s_mov_b32 s34, 233472
s_add_u32 m0, s95, 12288
v_mfma_f32_16x16x32_bf16 v[48:51], v[212:215], v[172:175], v[48:51]
ds_read_b128 v[172:175], v254 offset:1024
buffer_load_dwordx4 v88, s[72:75], s34 offen offset:0 lds
v_mfma_f32_16x16x32_bf16 v[52:55], v[204:207], v[176:179], v[52:55]
buffer_load_dwordx4 v89, s[72:75], s34 offen offset:1024 lds
v_mfma_f32_16x16x32_bf16 v[56:59], v[208:211], v[176:179], v[56:59]
buffer_load_dwordx4 v90, s[72:75], s34 offen offset:2048 lds
v_mfma_f32_16x16x32_bf16 v[60:63], v[212:215], v[176:179], v[60:63]
ds_read_b128 v[176:179], v254 offset:2048
s_waitcnt lgkmcnt(6)
v_mfma_f32_16x16x32_bf16 v[64:67], v[204:207], v[180:183], v[64:67]
s_mov_b32 s34, 454656
s_add_u32 m0, s95, 0
v_mfma_f32_16x16x32_bf16 v[68:71], v[208:211], v[180:183], v[68:71]
buffer_load_dwordx4 v88, s[72:75], s34 offen offset:0 lds
v_mfma_f32_16x16x32_bf16 v[72:75], v[212:215], v[180:183], v[72:75]
ds_read_b128 v[180:183], v254 offset:3072
v_mfma_f32_16x16x32_bf16 v[76:79], v[204:207], v[184:187], v[76:79]
buffer_load_dwordx4 v89, s[72:75], s34 offen offset:1024 lds
v_mfma_f32_16x16x32_bf16 v[80:83], v[208:211], v[184:187], v[80:83]
buffer_load_dwordx4 v90, s[72:75], s34 offen offset:2048 lds
v_mfma_f32_16x16x32_bf16 v[84:87], v[212:215], v[184:187], v[84:87]
ds_read_b128 v[184:187], v254 offset:4096
s_waitcnt lgkmcnt(4)
s_waitcnt lgkmcnt(3)
v_mfma_f32_16x16x32_bf16 v[4:7], v[216:219], v[188:191], v[4:7]
s_waitcnt vmcnt(6)
v_mfma_f32_16x16x32_bf16 v[8:11], v[220:223], v[188:191], v[8:11]
ds_read_b64_tr_b16 v[228:229], v91 offset:9216
v_mfma_f32_16x16x32_bf16 v[12:15], v[224:227], v[188:191], v[12:15]
ds_read_b128 v[188:191], v254 offset:5120
v_mfma_f32_16x16x32_bf16 v[16:19], v[216:219], v[172:175], v[16:19]
ds_read_b64_tr_b16 v[230:231], v91 offset:9984
v_mfma_f32_16x16x32_bf16 v[20:23], v[220:223], v[172:175], v[20:23]
ds_read_b64_tr_b16 v[232:233], v91 offset:9248
v_mfma_f32_16x16x32_bf16 v[24:27], v[224:227], v[172:175], v[24:27]
ds_read_b128 v[172:175], v254 offset:6144
s_waitcnt lgkmcnt(6)
v_mfma_f32_16x16x32_bf16 v[28:31], v[216:219], v[176:179], v[28:31]
ds_read_b64_tr_b16 v[234:235], v91 offset:10016
v_mfma_f32_16x16x32_bf16 v[32:35], v[220:223], v[176:179], v[32:35]
ds_read_b64_tr_b16 v[236:237], v91 offset:9280
v_mfma_f32_16x16x32_bf16 v[36:39], v[224:227], v[176:179], v[36:39]
ds_read_b128 v[176:179], v252 offset:8128
v_mfma_f32_16x16x32_bf16 v[40:43], v[216:219], v[180:183], v[40:43]
ds_read_b64_tr_b16 v[238:239], v91 offset:10048
v_mfma_f32_16x16x32_bf16 v[44:47], v[220:223], v[180:183], v[44:47]
s_mov_b32 s34, 24576
s_add_u32 m0, s95, 3072
v_mfma_f32_16x16x32_bf16 v[48:51], v[224:227], v[180:183], v[48:51]
ds_read_b128 v[180:183], v252 offset:9152
s_waitcnt lgkmcnt(8)
v_mfma_f32_16x16x32_bf16 v[52:55], v[216:219], v[184:187], v[52:55]
buffer_load_dwordx4 v88, s[72:75], s34 offen offset:0 lds
v_mfma_f32_16x16x32_bf16 v[56:59], v[220:223], v[184:187], v[56:59]
buffer_load_dwordx4 v89, s[72:75], s34 offen offset:1024 lds
v_mfma_f32_16x16x32_bf16 v[60:63], v[224:227], v[184:187], v[60:63]
ds_read_b128 v[184:187], v252 offset:10176
v_mfma_f32_16x16x32_bf16 v[64:67], v[216:219], v[188:191], v[64:67]
v_mfma_f32_16x16x32_bf16 v[68:71], v[220:223], v[188:191], v[68:71]
buffer_load_dwordx4 v90, s[72:75], s34 offen offset:2048 lds
v_mfma_f32_16x16x32_bf16 v[72:75], v[224:227], v[188:191], v[72:75]
ds_read_b128 v[188:191], v252 offset:11200
s_waitcnt lgkmcnt(4)
v_mfma_f32_16x16x32_bf16 v[76:79], v[216:219], v[172:175], v[76:79]
v_mfma_f32_16x16x32_bf16 v[80:83], v[220:223], v[172:175], v[80:83]
v_mfma_f32_16x16x32_bf16 v[84:87], v[224:227], v[172:175], v[84:87]
ds_read_b128 v[172:175], v252 offset:12224
s_waitcnt lgkmcnt(4)
v_mfma_f32_16x16x32_bf16 v[4:7], v[228:231], v[176:179], v[4:7]
s_waitcnt vmcnt(6)
v_mfma_f32_16x16x32_bf16 v[8:11], v[232:235], v[176:179], v[8:11]
ds_read_b64_tr_b16 v[240:241], v91 offset:12288
v_mfma_f32_16x16x32_bf16 v[12:15], v[236:239], v[176:179], v[12:15]
ds_read_b128 v[176:179], v252 offset:13248
s_waitcnt lgkmcnt(4)
v_mfma_f32_16x16x32_bf16 v[16:19], v[228:231], v[180:183], v[16:19]
ds_read_b64_tr_b16 v[242:243], v91 offset:13056
v_mfma_f32_16x16x32_bf16 v[20:23], v[232:235], v[180:183], v[20:23]
ds_read_b64_tr_b16 v[244:245], v91 offset:12320
v_mfma_f32_16x16x32_bf16 v[24:27], v[236:239], v[180:183], v[24:27]
ds_read_b128 v[180:183], v252 offset:14272
v_mfma_f32_16x16x32_bf16 v[28:31], v[228:231], v[184:187], v[28:31]
ds_read_b64_tr_b16 v[246:247], v91 offset:13088
v_mfma_f32_16x16x32_bf16 v[32:35], v[232:235], v[184:187], v[32:35]
ds_read_b64_tr_b16 v[248:249], v91 offset:12352
v_mfma_f32_16x16x32_bf16 v[36:39], v[236:239], v[184:187], v[36:39]
ds_read_b128 v[184:187], v253 offset:8128
s_waitcnt lgkmcnt(8)
v_mfma_f32_16x16x32_bf16 v[40:43], v[228:231], v[188:191], v[40:43]
ds_read_b64_tr_b16 v[250:251], v91 offset:13120
v_mfma_f32_16x16x32_bf16 v[44:47], v[232:235], v[188:191], v[44:47]
s_mov_b32 s34, 245760
s_add_u32 m0, s95, 6144
v_mfma_f32_16x16x32_bf16 v[48:51], v[236:239], v[188:191], v[48:51]
ds_read_b128 v[188:191], v253 offset:9152
v_mfma_f32_16x16x32_bf16 v[52:55], v[228:231], v[172:175], v[52:55]
buffer_load_dwordx4 v88, s[72:75], s34 offen offset:0 lds
v_mfma_f32_16x16x32_bf16 v[56:59], v[232:235], v[172:175], v[56:59]
buffer_load_dwordx4 v89, s[72:75], s34 offen offset:1024 lds
v_mfma_f32_16x16x32_bf16 v[60:63], v[236:239], v[172:175], v[60:63]
ds_read_b128 v[172:175], v253 offset:10176
s_waitcnt lgkmcnt(6)
v_mfma_f32_16x16x32_bf16 v[64:67], v[228:231], v[176:179], v[64:67]
v_mfma_f32_16x16x32_bf16 v[68:71], v[232:235], v[176:179], v[68:71]
buffer_load_dwordx4 v90, s[72:75], s34 offen offset:2048 lds
v_mfma_f32_16x16x32_bf16 v[72:75], v[236:239], v[176:179], v[72:75]
ds_read_b128 v[176:179], v253 offset:11200
v_mfma_f32_16x16x32_bf16 v[76:79], v[228:231], v[180:183], v[76:79]
v_mfma_f32_16x16x32_bf16 v[80:83], v[232:235], v[180:183], v[80:83]
v_mfma_f32_16x16x32_bf16 v[84:87], v[236:239], v[180:183], v[84:87]
ds_read_b128 v[180:183], v253 offset:12224
s_waitcnt lgkmcnt(4)
s_waitcnt lgkmcnt(3)
v_mfma_f32_16x16x32_bf16 v[4:7], v[240:243], v[184:187], v[4:7]
s_waitcnt vmcnt(6)
v_mfma_f32_16x16x32_bf16 v[8:11], v[244:247], v[184:187], v[8:11]
ds_read_b64_tr_b16 v[192:193], v91 offset:0
v_mfma_f32_16x16x32_bf16 v[12:15], v[248:251], v[184:187], v[12:15]
ds_read_b128 v[184:187], v253 offset:13248
v_mfma_f32_16x16x32_bf16 v[16:19], v[240:243], v[188:191], v[16:19]
ds_read_b64_tr_b16 v[194:195], v91 offset:768
v_mfma_f32_16x16x32_bf16 v[20:23], v[244:247], v[188:191], v[20:23]
ds_read_b64_tr_b16 v[196:197], v91 offset:32
v_mfma_f32_16x16x32_bf16 v[24:27], v[248:251], v[188:191], v[24:27]
ds_read_b128 v[188:191], v253 offset:14272
s_waitcnt lgkmcnt(6)
v_mfma_f32_16x16x32_bf16 v[28:31], v[240:243], v[172:175], v[28:31]
ds_read_b64_tr_b16 v[198:199], v91 offset:800
v_mfma_f32_16x16x32_bf16 v[32:35], v[244:247], v[172:175], v[32:35]
ds_read_b64_tr_b16 v[200:201], v91 offset:64
v_mfma_f32_16x16x32_bf16 v[36:39], v[248:251], v[172:175], v[36:39]
ds_read_b128 v[172:175], v254 offset:8128
v_mfma_f32_16x16x32_bf16 v[40:43], v[240:243], v[176:179], v[40:43]
ds_read_b64_tr_b16 v[202:203], v91 offset:832
v_mfma_f32_16x16x32_bf16 v[44:47], v[244:247], v[176:179], v[44:47]
s_mov_b32 s34, 466944
s_add_u32 m0, s95, 9216
v_mfma_f32_16x16x32_bf16 v[48:51], v[248:251], v[176:179], v[48:51]
ds_read_b128 v[176:179], v254 offset:9152
s_waitcnt lgkmcnt(8)
v_mfma_f32_16x16x32_bf16 v[52:55], v[240:243], v[180:183], v[52:55]
buffer_load_dwordx4 v88, s[72:75], s34 offen offset:0 lds
v_mfma_f32_16x16x32_bf16 v[56:59], v[244:247], v[180:183], v[56:59]
buffer_load_dwordx4 v89, s[72:75], s34 offen offset:1024 lds
v_mfma_f32_16x16x32_bf16 v[60:63], v[248:251], v[180:183], v[60:63]
ds_read_b128 v[180:183], v254 offset:10176
v_mfma_f32_16x16x32_bf16 v[64:67], v[240:243], v[184:187], v[64:67]
v_mfma_f32_16x16x32_bf16 v[68:71], v[244:247], v[184:187], v[68:71]
buffer_load_dwordx4 v90, s[72:75], s34 offen offset:2048 lds
v_mfma_f32_16x16x32_bf16 v[72:75], v[248:251], v[184:187], v[72:75]
ds_read_b128 v[184:187], v254 offset:11200
s_waitcnt lgkmcnt(4)
v_mfma_f32_16x16x32_bf16 v[76:79], v[240:243], v[188:191], v[76:79]
v_mfma_f32_16x16x32_bf16 v[80:83], v[244:247], v[188:191], v[80:83]
v_mfma_f32_16x16x32_bf16 v[84:87], v[248:251], v[188:191], v[84:87]
ds_read_b128 v[188:191], v254 offset:12224
s_barrier
s_waitcnt lgkmcnt(4)
v_mfma_f32_16x16x32_bf16 v[4:7], v[192:195], v[172:175], v[4:7]
s_waitcnt vmcnt(6)
v_mfma_f32_16x16x32_bf16 v[8:11], v[196:199], v[172:175], v[8:11]
ds_read_b64_tr_b16 v[204:205], v91 offset:3072
v_mfma_f32_16x16x32_bf16 v[12:15], v[200:203], v[172:175], v[12:15]
ds_read_b128 v[172:175], v254 offset:13248
s_waitcnt lgkmcnt(4)
v_mfma_f32_16x16x32_bf16 v[16:19], v[192:195], v[176:179], v[16:19]
ds_read_b64_tr_b16 v[206:207], v91 offset:3840
v_mfma_f32_16x16x32_bf16 v[20:23], v[196:199], v[176:179], v[20:23]
ds_read_b64_tr_b16 v[208:209], v91 offset:3104
v_mfma_f32_16x16x32_bf16 v[24:27], v[200:203], v[176:179], v[24:27]
ds_read_b128 v[176:179], v254 offset:14272
v_mfma_f32_16x16x32_bf16 v[28:31], v[192:195], v[180:183], v[28:31]
ds_read_b64_tr_b16 v[210:211], v91 offset:3872
v_mfma_f32_16x16x32_bf16 v[32:35], v[196:199], v[180:183], v[32:35]
ds_read_b64_tr_b16 v[212:213], v91 offset:3136
v_mfma_f32_16x16x32_bf16 v[36:39], v[200:203], v[180:183], v[36:39]
ds_read_b128 v[180:183], v252 offset:16256
s_waitcnt lgkmcnt(8)
v_mfma_f32_16x16x32_bf16 v[40:43], v[192:195], v[184:187], v[40:43]
ds_read_b64_tr_b16 v[214:215], v91 offset:3904
v_mfma_f32_16x16x32_bf16 v[44:47], v[196:199], v[184:187], v[44:47]
s_mov_b32 s34, 36864
s_add_u32 m0, s95, 12288
v_mfma_f32_16x16x32_bf16 v[48:51], v[200:203], v[184:187], v[48:51]
ds_read_b128 v[184:187], v252 offset:17280
v_mfma_f32_16x16x32_bf16 v[52:55], v[192:195], v[188:191], v[52:55]
buffer_load_dwordx4 v88, s[72:75], s34 offen offset:0 lds
v_mfma_f32_16x16x32_bf16 v[56:59], v[196:199], v[188:191], v[56:59]
buffer_load_dwordx4 v89, s[72:75], s34 offen offset:1024 lds
v_mfma_f32_16x16x32_bf16 v[60:63], v[200:203], v[188:191], v[60:63]
ds_read_b128 v[188:191], v252 offset:18304
s_waitcnt lgkmcnt(6)
v_mfma_f32_16x16x32_bf16 v[64:67], v[192:195], v[172:175], v[64:67]
v_mfma_f32_16x16x32_bf16 v[68:71], v[196:199], v[172:175], v[68:71]
buffer_load_dwordx4 v90, s[72:75], s34 offen offset:2048 lds
v_mfma_f32_16x16x32_bf16 v[72:75], v[200:203], v[172:175], v[72:75]
ds_read_b128 v[172:175], v252 offset:19328
v_mfma_f32_16x16x32_bf16 v[76:79], v[192:195], v[176:179], v[76:79]
v_mfma_f32_16x16x32_bf16 v[80:83], v[196:199], v[176:179], v[80:83]
v_mfma_f32_16x16x32_bf16 v[84:87], v[200:203], v[176:179], v[84:87]
ds_read_b128 v[176:179], v252 offset:20352
s_waitcnt lgkmcnt(4)
s_waitcnt lgkmcnt(3)
v_mfma_f32_16x16x32_bf16 v[4:7], v[204:207], v[180:183], v[4:7]
s_waitcnt vmcnt(6)
v_mfma_f32_16x16x32_bf16 v[8:11], v[208:211], v[180:183], v[8:11]
ds_read_b64_tr_b16 v[216:217], v91 offset:6144
v_mfma_f32_16x16x32_bf16 v[12:15], v[212:215], v[180:183], v[12:15]
ds_read_b128 v[180:183], v252 offset:21376
v_mfma_f32_16x16x32_bf16 v[16:19], v[204:207], v[184:187], v[16:19]
ds_read_b64_tr_b16 v[218:219], v91 offset:6912
v_mfma_f32_16x16x32_bf16 v[20:23], v[208:211], v[184:187], v[20:23]
ds_read_b64_tr_b16 v[220:221], v91 offset:6176
v_mfma_f32_16x16x32_bf16 v[24:27], v[212:215], v[184:187], v[24:27]
ds_read_b128 v[184:187], v252 offset:22400
s_waitcnt lgkmcnt(6)
v_mfma_f32_16x16x32_bf16 v[28:31], v[204:207], v[188:191], v[28:31]
ds_read_b64_tr_b16 v[222:223], v91 offset:6944
v_mfma_f32_16x16x32_bf16 v[32:35], v[208:211], v[188:191], v[32:35]
ds_read_b64_tr_b16 v[224:225], v91 offset:6208
v_mfma_f32_16x16x32_bf16 v[36:39], v[212:215], v[188:191], v[36:39]
ds_read_b128 v[188:191], v253 offset:16256
v_mfma_f32_16x16x32_bf16 v[40:43], v[204:207], v[172:175], v[40:43]
ds_read_b64_tr_b16 v[226:227], v91 offset:6976
v_mfma_f32_16x16x32_bf16 v[44:47], v[208:211], v[172:175], v[44:47]
s_mov_b32 s34, 258048
s_add_u32 m0, s95, 0
v_mfma_f32_16x16x32_bf16 v[48:51], v[212:215], v[172:175], v[48:51]
ds_read_b128 v[172:175], v253 offset:17280
s_waitcnt lgkmcnt(8)
v_mfma_f32_16x16x32_bf16 v[52:55], v[204:207], v[176:179], v[52:55]
buffer_load_dwordx4 v88, s[72:75], s34 offen offset:0 lds
v_mfma_f32_16x16x32_bf16 v[56:59], v[208:211], v[176:179], v[56:59]
buffer_load_dwordx4 v89, s[72:75], s34 offen offset:1024 lds
v_mfma_f32_16x16x32_bf16 v[60:63], v[212:215], v[176:179], v[60:63]
ds_read_b128 v[176:179], v253 offset:18304
v_mfma_f32_16x16x32_bf16 v[64:67], v[204:207], v[180:183], v[64:67]
v_mfma_f32_16x16x32_bf16 v[68:71], v[208:211], v[180:183], v[68:71]
buffer_load_dwordx4 v90, s[72:75], s34 offen offset:2048 lds
v_mfma_f32_16x16x32_bf16 v[72:75], v[212:215], v[180:183], v[72:75]
ds_read_b128 v[180:183], v253 offset:19328
s_waitcnt lgkmcnt(4)
v_mfma_f32_16x16x32_bf16 v[76:79], v[204:207], v[184:187], v[76:79]
v_mfma_f32_16x16x32_bf16 v[80:83], v[208:211], v[184:187], v[80:83]
v_mfma_f32_16x16x32_bf16 v[84:87], v[212:215], v[184:187], v[84:87]
ds_read_b128 v[184:187], v253 offset:20352
s_waitcnt lgkmcnt(4)
v_mfma_f32_16x16x32_bf16 v[4:7], v[216:219], v[188:191], v[4:7]
s_waitcnt vmcnt(6)
v_mfma_f32_16x16x32_bf16 v[8:11], v[220:223], v[188:191], v[8:11]
ds_read_b64_tr_b16 v[228:229], v91 offset:9216
v_mfma_f32_16x16x32_bf16 v[12:15], v[224:227], v[188:191], v[12:15]
ds_read_b128 v[188:191], v253 offset:21376
s_waitcnt lgkmcnt(4)
v_mfma_f32_16x16x32_bf16 v[16:19], v[216:219], v[172:175], v[16:19]
ds_read_b64_tr_b16 v[230:231], v91 offset:9984
v_mfma_f32_16x16x32_bf16 v[20:23], v[220:223], v[172:175], v[20:23]
ds_read_b64_tr_b16 v[232:233], v91 offset:9248
v_mfma_f32_16x16x32_bf16 v[24:27], v[224:227], v[172:175], v[24:27]
ds_read_b128 v[172:175], v253 offset:22400
v_mfma_f32_16x16x32_bf16 v[28:31], v[216:219], v[176:179], v[28:31]
ds_read_b64_tr_b16 v[234:235], v91 offset:10016
v_mfma_f32_16x16x32_bf16 v[32:35], v[220:223], v[176:179], v[32:35]
ds_read_b64_tr_b16 v[236:237], v91 offset:9280
v_mfma_f32_16x16x32_bf16 v[36:39], v[224:227], v[176:179], v[36:39]
ds_read_b128 v[176:179], v254 offset:16256
s_waitcnt lgkmcnt(8)
v_mfma_f32_16x16x32_bf16 v[40:43], v[216:219], v[180:183], v[40:43]
ds_read_b64_tr_b16 v[238:239], v91 offset:10048
v_mfma_f32_16x16x32_bf16 v[44:47], v[220:223], v[180:183], v[44:47]
s_mov_b32 s34, 479232
s_add_u32 m0, s95, 3072
v_mfma_f32_16x16x32_bf16 v[48:51], v[224:227], v[180:183], v[48:51]
ds_read_b128 v[180:183], v254 offset:17280
v_mfma_f32_16x16x32_bf16 v[52:55], v[216:219], v[184:187], v[52:55]
buffer_load_dwordx4 v88, s[72:75], s34 offen offset:0 lds
v_mfma_f32_16x16x32_bf16 v[56:59], v[220:223], v[184:187], v[56:59]
buffer_load_dwordx4 v89, s[72:75], s34 offen offset:1024 lds
v_mfma_f32_16x16x32_bf16 v[60:63], v[224:227], v[184:187], v[60:63]
ds_read_b128 v[184:187], v254 offset:18304
s_waitcnt lgkmcnt(6)
v_mfma_f32_16x16x32_bf16 v[64:67], v[216:219], v[188:191], v[64:67]
v_mfma_f32_16x16x32_bf16 v[68:71], v[220:223], v[188:191], v[68:71]
buffer_load_dwordx4 v90, s[72:75], s34 offen offset:2048 lds
v_mfma_f32_16x16x32_bf16 v[72:75], v[224:227], v[188:191], v[72:75]
ds_read_b128 v[188:191], v254 offset:19328
v_mfma_f32_16x16x32_bf16 v[76:79], v[216:219], v[172:175], v[76:79]
v_mfma_f32_16x16x32_bf16 v[80:83], v[220:223], v[172:175], v[80:83]
v_mfma_f32_16x16x32_bf16 v[84:87], v[224:227], v[172:175], v[84:87]
ds_read_b128 v[172:175], v254 offset:20352
s_waitcnt lgkmcnt(4)
s_waitcnt lgkmcnt(3)
v_mfma_f32_16x16x32_bf16 v[4:7], v[228:231], v[176:179], v[4:7]
s_waitcnt vmcnt(6)
v_mfma_f32_16x16x32_bf16 v[8:11], v[232:235], v[176:179], v[8:11]
ds_read_b64_tr_b16 v[240:241], v91 offset:12288
v_mfma_f32_16x16x32_bf16 v[12:15], v[236:239], v[176:179], v[12:15]
ds_read_b128 v[176:179], v254 offset:21376
v_mfma_f32_16x16x32_bf16 v[16:19], v[228:231], v[180:183], v[16:19]
ds_read_b64_tr_b16 v[242:243], v91 offset:13056
v_mfma_f32_16x16x32_bf16 v[20:23], v[232:235], v[180:183], v[20:23]
ds_read_b64_tr_b16 v[244:245], v91 offset:12320
v_mfma_f32_16x16x32_bf16 v[24:27], v[236:239], v[180:183], v[24:27]
ds_read_b128 v[180:183], v254 offset:22400
s_waitcnt lgkmcnt(6)
v_mfma_f32_16x16x32_bf16 v[28:31], v[228:231], v[184:187], v[28:31]
ds_read_b64_tr_b16 v[246:247], v91 offset:13088
v_mfma_f32_16x16x32_bf16 v[32:35], v[232:235], v[184:187], v[32:35]
ds_read_b64_tr_b16 v[248:249], v91 offset:12352
v_mfma_f32_16x16x32_bf16 v[36:39], v[236:239], v[184:187], v[36:39]
ds_read_b128 v[184:187], v252 offset:24384
v_mfma_f32_16x16x32_bf16 v[40:43], v[228:231], v[188:191], v[40:43]
ds_read_b64_tr_b16 v[250:251], v91 offset:13120
v_mfma_f32_16x16x32_bf16 v[44:47], v[232:235], v[188:191], v[44:47]
s_mov_b32 s34, 49152
s_add_u32 m0, s95, 6144
v_mfma_f32_16x16x32_bf16 v[48:51], v[236:239], v[188:191], v[48:51]
ds_read_b128 v[188:191], v252 offset:25408
s_waitcnt lgkmcnt(8)
v_mfma_f32_16x16x32_bf16 v[52:55], v[228:231], v[172:175], v[52:55]
buffer_load_dwordx4 v88, s[72:75], s34 offen offset:0 lds
v_mfma_f32_16x16x32_bf16 v[56:59], v[232:235], v[172:175], v[56:59]
buffer_load_dwordx4 v89, s[72:75], s34 offen offset:1024 lds
v_mfma_f32_16x16x32_bf16 v[60:63], v[236:239], v[172:175], v[60:63]
ds_read_b128 v[172:175], v252 offset:26432
v_mfma_f32_16x16x32_bf16 v[64:67], v[228:231], v[176:179], v[64:67]
v_mfma_f32_16x16x32_bf16 v[68:71], v[232:235], v[176:179], v[68:71]
buffer_load_dwordx4 v90, s[72:75], s34 offen offset:2048 lds
v_mfma_f32_16x16x32_bf16 v[72:75], v[236:239], v[176:179], v[72:75]
ds_read_b128 v[176:179], v252 offset:27456
s_waitcnt lgkmcnt(4)
v_mfma_f32_16x16x32_bf16 v[76:79], v[228:231], v[180:183], v[76:79]
v_mfma_f32_16x16x32_bf16 v[80:83], v[232:235], v[180:183], v[80:83]
v_mfma_f32_16x16x32_bf16 v[84:87], v[236:239], v[180:183], v[84:87]
ds_read_b128 v[180:183], v252 offset:28480
s_waitcnt lgkmcnt(4)
v_mfma_f32_16x16x32_bf16 v[4:7], v[240:243], v[184:187], v[4:7]
s_waitcnt vmcnt(6)
v_mfma_f32_16x16x32_bf16 v[8:11], v[244:247], v[184:187], v[8:11]
ds_read_b64_tr_b16 v[192:193], v91 offset:0
v_mfma_f32_16x16x32_bf16 v[12:15], v[248:251], v[184:187], v[12:15]
ds_read_b128 v[184:187], v252 offset:29504
s_waitcnt lgkmcnt(4)
v_mfma_f32_16x16x32_bf16 v[16:19], v[240:243], v[188:191], v[16:19]
ds_read_b64_tr_b16 v[194:195], v91 offset:768
v_mfma_f32_16x16x32_bf16 v[20:23], v[244:247], v[188:191], v[20:23]
ds_read_b64_tr_b16 v[196:197], v91 offset:32
v_mfma_f32_16x16x32_bf16 v[24:27], v[248:251], v[188:191], v[24:27]
ds_read_b128 v[188:191], v252 offset:30528
v_mfma_f32_16x16x32_bf16 v[28:31], v[240:243], v[172:175], v[28:31]
ds_read_b64_tr_b16 v[198:199], v91 offset:800
v_mfma_f32_16x16x32_bf16 v[32:35], v[244:247], v[172:175], v[32:35]
ds_read_b64_tr_b16 v[200:201], v91 offset:64
v_mfma_f32_16x16x32_bf16 v[36:39], v[248:251], v[172:175], v[36:39]
ds_read_b128 v[172:175], v253 offset:24384
s_waitcnt lgkmcnt(8)
v_mfma_f32_16x16x32_bf16 v[40:43], v[240:243], v[176:179], v[40:43]
ds_read_b64_tr_b16 v[202:203], v91 offset:832
v_mfma_f32_16x16x32_bf16 v[44:47], v[244:247], v[176:179], v[44:47]
s_mov_b32 s34, 270336
s_add_u32 m0, s95, 9216
v_mfma_f32_16x16x32_bf16 v[48:51], v[248:251], v[176:179], v[48:51]
ds_read_b128 v[176:179], v253 offset:25408
v_mfma_f32_16x16x32_bf16 v[52:55], v[240:243], v[180:183], v[52:55]
buffer_load_dwordx4 v88, s[72:75], s34 offen offset:0 lds
v_mfma_f32_16x16x32_bf16 v[56:59], v[244:247], v[180:183], v[56:59]
buffer_load_dwordx4 v89, s[72:75], s34 offen offset:1024 lds
v_mfma_f32_16x16x32_bf16 v[60:63], v[248:251], v[180:183], v[60:63]
ds_read_b128 v[180:183], v253 offset:26432
s_waitcnt lgkmcnt(6)
v_mfma_f32_16x16x32_bf16 v[64:67], v[240:243], v[184:187], v[64:67]
v_mfma_f32_16x16x32_bf16 v[68:71], v[244:247], v[184:187], v[68:71]
buffer_load_dwordx4 v90, s[72:75], s34 offen offset:2048 lds
v_mfma_f32_16x16x32_bf16 v[72:75], v[248:251], v[184:187], v[72:75]
ds_read_b128 v[184:187], v253 offset:27456
v_mfma_f32_16x16x32_bf16 v[76:79], v[240:243], v[188:191], v[76:79]
v_mfma_f32_16x16x32_bf16 v[80:83], v[244:247], v[188:191], v[80:83]
v_mfma_f32_16x16x32_bf16 v[84:87], v[248:251], v[188:191], v[84:87]
ds_read_b128 v[188:191], v253 offset:28480
s_waitcnt lgkmcnt(4)
s_waitcnt lgkmcnt(3)
v_mfma_f32_16x16x32_bf16 v[4:7], v[192:195], v[172:175], v[4:7]
s_waitcnt vmcnt(6)
v_mfma_f32_16x16x32_bf16 v[8:11], v[196:199], v[172:175], v[8:11]
ds_read_b64_tr_b16 v[204:205], v91 offset:3072
v_mfma_f32_16x16x32_bf16 v[12:15], v[200:203], v[172:175], v[12:15]
ds_read_b128 v[172:175], v253 offset:29504
v_mfma_f32_16x16x32_bf16 v[16:19], v[192:195], v[176:179], v[16:19]
ds_read_b64_tr_b16 v[206:207], v91 offset:3840
v_mfma_f32_16x16x32_bf16 v[20:23], v[196:199], v[176:179], v[20:23]
ds_read_b64_tr_b16 v[208:209], v91 offset:3104
v_mfma_f32_16x16x32_bf16 v[24:27], v[200:203], v[176:179], v[24:27]
ds_read_b128 v[176:179], v253 offset:30528
s_waitcnt lgkmcnt(6)
v_mfma_f32_16x16x32_bf16 v[28:31], v[192:195], v[180:183], v[28:31]
ds_read_b64_tr_b16 v[210:211], v91 offset:3872
v_mfma_f32_16x16x32_bf16 v[32:35], v[196:199], v[180:183], v[32:35]
ds_read_b64_tr_b16 v[212:213], v91 offset:3136
v_mfma_f32_16x16x32_bf16 v[36:39], v[200:203], v[180:183], v[36:39]
ds_read_b128 v[180:183], v254 offset:24384
v_mfma_f32_16x16x32_bf16 v[40:43], v[192:195], v[184:187], v[40:43]
ds_read_b64_tr_b16 v[214:215], v91 offset:3904
v_mfma_f32_16x16x32_bf16 v[44:47], v[196:199], v[184:187], v[44:47]
s_mov_b32 s34, 491520
s_add_u32 m0, s95, 12288
v_mfma_f32_16x16x32_bf16 v[48:51], v[200:203], v[184:187], v[48:51]
ds_read_b128 v[184:187], v254 offset:25408
s_waitcnt lgkmcnt(8)
v_mfma_f32_16x16x32_bf16 v[52:55], v[192:195], v[188:191], v[52:55]
buffer_load_dwordx4 v88, s[72:75], s34 offen offset:0 lds
v_mfma_f32_16x16x32_bf16 v[56:59], v[196:199], v[188:191], v[56:59]
buffer_load_dwordx4 v89, s[72:75], s34 offen offset:1024 lds
v_mfma_f32_16x16x32_bf16 v[60:63], v[200:203], v[188:191], v[60:63]
ds_read_b128 v[188:191], v254 offset:26432
v_mfma_f32_16x16x32_bf16 v[64:67], v[192:195], v[172:175], v[64:67]
v_mfma_f32_16x16x32_bf16 v[68:71], v[196:199], v[172:175], v[68:71]
buffer_load_dwordx4 v90, s[72:75], s34 offen offset:2048 lds
v_mfma_f32_16x16x32_bf16 v[72:75], v[200:203], v[172:175], v[72:75]
ds_read_b128 v[172:175], v254 offset:27456
s_waitcnt lgkmcnt(4)
v_mfma_f32_16x16x32_bf16 v[76:79], v[192:195], v[176:179], v[76:79]
v_mfma_f32_16x16x32_bf16 v[80:83], v[196:199], v[176:179], v[80:83]
v_mfma_f32_16x16x32_bf16 v[84:87], v[200:203], v[176:179], v[84:87]
ds_read_b128 v[176:179], v254 offset:28480
s_barrier
s_waitcnt lgkmcnt(4)
v_mfma_f32_16x16x32_bf16 v[4:7], v[204:207], v[180:183], v[4:7]
s_waitcnt vmcnt(6)
v_mfma_f32_16x16x32_bf16 v[8:11], v[208:211], v[180:183], v[8:11]
ds_read_b64_tr_b16 v[216:217], v91 offset:6144
v_mfma_f32_16x16x32_bf16 v[12:15], v[212:215], v[180:183], v[12:15]
ds_read_b128 v[180:183], v254 offset:29504
s_waitcnt lgkmcnt(4)
v_mfma_f32_16x16x32_bf16 v[16:19], v[204:207], v[184:187], v[16:19]
ds_read_b64_tr_b16 v[218:219], v91 offset:6912
v_mfma_f32_16x16x32_bf16 v[20:23], v[208:211], v[184:187], v[20:23]
ds_read_b64_tr_b16 v[220:221], v91 offset:6176
v_mfma_f32_16x16x32_bf16 v[24:27], v[212:215], v[184:187], v[24:27]
ds_read_b128 v[184:187], v254 offset:30528
v_mfma_f32_16x16x32_bf16 v[28:31], v[204:207], v[188:191], v[28:31]
ds_read_b64_tr_b16 v[222:223], v91 offset:6944
v_mfma_f32_16x16x32_bf16 v[32:35], v[208:211], v[188:191], v[32:35]
ds_read_b64_tr_b16 v[224:225], v91 offset:6208
v_mfma_f32_16x16x32_bf16 v[36:39], v[212:215], v[188:191], v[36:39]
ds_read_b128 v[188:191], v252 offset:32512
s_waitcnt lgkmcnt(8)
v_mfma_f32_16x16x32_bf16 v[40:43], v[204:207], v[172:175], v[40:43]
ds_read_b64_tr_b16 v[226:227], v91 offset:6976
v_mfma_f32_16x16x32_bf16 v[44:47], v[208:211], v[172:175], v[44:47]
s_mov_b32 s34, 61440
s_add_u32 m0, s95, 0
v_mfma_f32_16x16x32_bf16 v[48:51], v[212:215], v[172:175], v[48:51]
ds_read_b128 v[172:175], v252 offset:33536
v_mfma_f32_16x16x32_bf16 v[52:55], v[204:207], v[176:179], v[52:55]
buffer_load_dwordx4 v88, s[72:75], s34 offen offset:0 lds
v_mfma_f32_16x16x32_bf16 v[56:59], v[208:211], v[176:179], v[56:59]
buffer_load_dwordx4 v89, s[72:75], s34 offen offset:1024 lds
v_mfma_f32_16x16x32_bf16 v[60:63], v[212:215], v[176:179], v[60:63]
ds_read_b128 v[176:179], v252 offset:34560
s_waitcnt lgkmcnt(6)
v_mfma_f32_16x16x32_bf16 v[64:67], v[204:207], v[180:183], v[64:67]
v_mfma_f32_16x16x32_bf16 v[68:71], v[208:211], v[180:183], v[68:71]
buffer_load_dwordx4 v90, s[72:75], s34 offen offset:2048 lds
v_mfma_f32_16x16x32_bf16 v[72:75], v[212:215], v[180:183], v[72:75]
ds_read_b128 v[180:183], v252 offset:35584
v_mfma_f32_16x16x32_bf16 v[76:79], v[204:207], v[184:187], v[76:79]
v_mfma_f32_16x16x32_bf16 v[80:83], v[208:211], v[184:187], v[80:83]
v_mfma_f32_16x16x32_bf16 v[84:87], v[212:215], v[184:187], v[84:87]
ds_read_b128 v[184:187], v252 offset:36608
s_waitcnt lgkmcnt(4)
s_waitcnt lgkmcnt(3)
v_mfma_f32_16x16x32_bf16 v[4:7], v[216:219], v[188:191], v[4:7]
s_waitcnt vmcnt(6)
v_mfma_f32_16x16x32_bf16 v[8:11], v[220:223], v[188:191], v[8:11]
ds_read_b64_tr_b16 v[228:229], v91 offset:9216
v_mfma_f32_16x16x32_bf16 v[12:15], v[224:227], v[188:191], v[12:15]
ds_read_b128 v[188:191], v252 offset:37632
v_mfma_f32_16x16x32_bf16 v[16:19], v[216:219], v[172:175], v[16:19]
ds_read_b64_tr_b16 v[230:231], v91 offset:9984
v_mfma_f32_16x16x32_bf16 v[20:23], v[220:223], v[172:175], v[20:23]
ds_read_b64_tr_b16 v[232:233], v91 offset:9248
v_mfma_f32_16x16x32_bf16 v[24:27], v[224:227], v[172:175], v[24:27]
ds_read_b128 v[172:175], v252 offset:38656
s_waitcnt lgkmcnt(6)
v_mfma_f32_16x16x32_bf16 v[28:31], v[216:219], v[176:179], v[28:31]
ds_read_b64_tr_b16 v[234:235], v91 offset:10016
v_mfma_f32_16x16x32_bf16 v[32:35], v[220:223], v[176:179], v[32:35]
ds_read_b64_tr_b16 v[236:237], v91 offset:9280
v_mfma_f32_16x16x32_bf16 v[36:39], v[224:227], v[176:179], v[36:39]
ds_read_b128 v[176:179], v253 offset:32512
v_mfma_f32_16x16x32_bf16 v[40:43], v[216:219], v[180:183], v[40:43]
ds_read_b64_tr_b16 v[238:239], v91 offset:10048
v_mfma_f32_16x16x32_bf16 v[44:47], v[220:223], v[180:183], v[44:47]
s_mov_b32 s34, 282624
s_add_u32 m0, s95, 3072
v_mfma_f32_16x16x32_bf16 v[48:51], v[224:227], v[180:183], v[48:51]
ds_read_b128 v[180:183], v253 offset:33536
s_waitcnt lgkmcnt(8)
v_mfma_f32_16x16x32_bf16 v[52:55], v[216:219], v[184:187], v[52:55]
buffer_load_dwordx4 v88, s[72:75], s34 offen offset:0 lds
v_mfma_f32_16x16x32_bf16 v[56:59], v[220:223], v[184:187], v[56:59]
buffer_load_dwordx4 v89, s[72:75], s34 offen offset:1024 lds
v_mfma_f32_16x16x32_bf16 v[60:63], v[224:227], v[184:187], v[60:63]
ds_read_b128 v[184:187], v253 offset:34560
v_mfma_f32_16x16x32_bf16 v[64:67], v[216:219], v[188:191], v[64:67]
v_mfma_f32_16x16x32_bf16 v[68:71], v[220:223], v[188:191], v[68:71]
buffer_load_dwordx4 v90, s[72:75], s34 offen offset:2048 lds
v_mfma_f32_16x16x32_bf16 v[72:75], v[224:227], v[188:191], v[72:75]
ds_read_b128 v[188:191], v253 offset:35584
s_waitcnt lgkmcnt(4)
v_mfma_f32_16x16x32_bf16 v[76:79], v[216:219], v[172:175], v[76:79]
v_mfma_f32_16x16x32_bf16 v[80:83], v[220:223], v[172:175], v[80:83]
v_mfma_f32_16x16x32_bf16 v[84:87], v[224:227], v[172:175], v[84:87]
ds_read_b128 v[172:175], v253 offset:36608
s_waitcnt lgkmcnt(4)
v_mfma_f32_16x16x32_bf16 v[4:7], v[228:231], v[176:179], v[4:7]
s_waitcnt vmcnt(6)
v_mfma_f32_16x16x32_bf16 v[8:11], v[232:235], v[176:179], v[8:11]
ds_read_b64_tr_b16 v[240:241], v91 offset:12288
v_mfma_f32_16x16x32_bf16 v[12:15], v[236:239], v[176:179], v[12:15]
ds_read_b128 v[176:179], v253 offset:37632
s_waitcnt lgkmcnt(4)
v_mfma_f32_16x16x32_bf16 v[16:19], v[228:231], v[180:183], v[16:19]
ds_read_b64_tr_b16 v[242:243], v91 offset:13056
v_mfma_f32_16x16x32_bf16 v[20:23], v[232:235], v[180:183], v[20:23]
ds_read_b64_tr_b16 v[244:245], v91 offset:12320
v_mfma_f32_16x16x32_bf16 v[24:27], v[236:239], v[180:183], v[24:27]
ds_read_b128 v[180:183], v253 offset:38656
v_mfma_f32_16x16x32_bf16 v[28:31], v[228:231], v[184:187], v[28:31]
ds_read_b64_tr_b16 v[246:247], v91 offset:13088
v_mfma_f32_16x16x32_bf16 v[32:35], v[232:235], v[184:187], v[32:35]
ds_read_b64_tr_b16 v[248:249], v91 offset:12352
v_mfma_f32_16x16x32_bf16 v[36:39], v[236:239], v[184:187], v[36:39]
ds_read_b128 v[184:187], v254 offset:32512
s_waitcnt lgkmcnt(8)
v_mfma_f32_16x16x32_bf16 v[40:43], v[228:231], v[188:191], v[40:43]
ds_read_b64_tr_b16 v[250:251], v91 offset:13120
v_mfma_f32_16x16x32_bf16 v[44:47], v[232:235], v[188:191], v[44:47]
s_mov_b32 s34, 503808
s_add_u32 m0, s95, 6144
v_mfma_f32_16x16x32_bf16 v[48:51], v[236:239], v[188:191], v[48:51]
ds_read_b128 v[188:191], v254 offset:33536
v_mfma_f32_16x16x32_bf16 v[52:55], v[228:231], v[172:175], v[52:55]
buffer_load_dwordx4 v88, s[72:75], s34 offen offset:0 lds
v_mfma_f32_16x16x32_bf16 v[56:59], v[232:235], v[172:175], v[56:59]
buffer_load_dwordx4 v89, s[72:75], s34 offen offset:1024 lds
v_mfma_f32_16x16x32_bf16 v[60:63], v[236:239], v[172:175], v[60:63]
ds_read_b128 v[172:175], v254 offset:34560
s_waitcnt lgkmcnt(6)
v_mfma_f32_16x16x32_bf16 v[64:67], v[228:231], v[176:179], v[64:67]
v_mfma_f32_16x16x32_bf16 v[68:71], v[232:235], v[176:179], v[68:71]
buffer_load_dwordx4 v90, s[72:75], s34 offen offset:2048 lds
v_mfma_f32_16x16x32_bf16 v[72:75], v[236:239], v[176:179], v[72:75]
ds_read_b128 v[176:179], v254 offset:35584
v_mfma_f32_16x16x32_bf16 v[76:79], v[228:231], v[180:183], v[76:79]
v_mfma_f32_16x16x32_bf16 v[80:83], v[232:235], v[180:183], v[80:83]
v_mfma_f32_16x16x32_bf16 v[84:87], v[236:239], v[180:183], v[84:87]
ds_read_b128 v[180:183], v254 offset:36608
s_waitcnt lgkmcnt(4)
s_waitcnt lgkmcnt(3)
v_mfma_f32_16x16x32_bf16 v[4:7], v[240:243], v[184:187], v[4:7]
s_waitcnt vmcnt(6)
v_mfma_f32_16x16x32_bf16 v[8:11], v[244:247], v[184:187], v[8:11]
ds_read_b64_tr_b16 v[192:193], v91 offset:0
v_mfma_f32_16x16x32_bf16 v[12:15], v[248:251], v[184:187], v[12:15]
ds_read_b128 v[184:187], v254 offset:37632
v_mfma_f32_16x16x32_bf16 v[16:19], v[240:243], v[188:191], v[16:19]
ds_read_b64_tr_b16 v[194:195], v91 offset:768
v_mfma_f32_16x16x32_bf16 v[20:23], v[244:247], v[188:191], v[20:23]
ds_read_b64_tr_b16 v[196:197], v91 offset:32
v_mfma_f32_16x16x32_bf16 v[24:27], v[248:251], v[188:191], v[24:27]
ds_read_b128 v[188:191], v254 offset:38656
s_waitcnt lgkmcnt(6)
v_mfma_f32_16x16x32_bf16 v[28:31], v[240:243], v[172:175], v[28:31]
ds_read_b64_tr_b16 v[198:199], v91 offset:800
v_mfma_f32_16x16x32_bf16 v[32:35], v[244:247], v[172:175], v[32:35]
ds_read_b64_tr_b16 v[200:201], v91 offset:64
v_mfma_f32_16x16x32_bf16 v[36:39], v[248:251], v[172:175], v[36:39]
ds_read_b128 v[172:175], v252 offset:40640
v_mfma_f32_16x16x32_bf16 v[40:43], v[240:243], v[176:179], v[40:43]
ds_read_b64_tr_b16 v[202:203], v91 offset:832
v_mfma_f32_16x16x32_bf16 v[44:47], v[244:247], v[176:179], v[44:47]
v_mfma_f32_16x16x32_bf16 v[48:51], v[248:251], v[176:179], v[48:51]
ds_read_b128 v[176:179], v252 offset:41664
s_waitcnt lgkmcnt(8)
v_mfma_f32_16x16x32_bf16 v[52:55], v[240:243], v[180:183], v[52:55]
v_mfma_f32_16x16x32_bf16 v[56:59], v[244:247], v[180:183], v[56:59]
v_mfma_f32_16x16x32_bf16 v[60:63], v[248:251], v[180:183], v[60:63]
ds_read_b128 v[180:183], v252 offset:42688
v_mfma_f32_16x16x32_bf16 v[64:67], v[240:243], v[184:187], v[64:67]
v_mfma_f32_16x16x32_bf16 v[68:71], v[244:247], v[184:187], v[68:71]
v_mfma_f32_16x16x32_bf16 v[72:75], v[248:251], v[184:187], v[72:75]
ds_read_b128 v[184:187], v252 offset:43712
s_waitcnt lgkmcnt(4)
v_mfma_f32_16x16x32_bf16 v[76:79], v[240:243], v[188:191], v[76:79]
v_mfma_f32_16x16x32_bf16 v[80:83], v[244:247], v[188:191], v[80:83]
v_mfma_f32_16x16x32_bf16 v[84:87], v[248:251], v[188:191], v[84:87]
ds_read_b128 v[188:191], v252 offset:44736
s_barrier
s_waitcnt lgkmcnt(4)
v_mfma_f32_16x16x32_bf16 v[4:7], v[192:195], v[172:175], v[4:7]
s_waitcnt vmcnt(3)
v_mfma_f32_16x16x32_bf16 v[8:11], v[196:199], v[172:175], v[8:11]
ds_read_b64_tr_b16 v[204:205], v91 offset:3072
v_mfma_f32_16x16x32_bf16 v[12:15], v[200:203], v[172:175], v[12:15]
ds_read_b128 v[172:175], v252 offset:45760
s_waitcnt lgkmcnt(4)
v_mfma_f32_16x16x32_bf16 v[16:19], v[192:195], v[176:179], v[16:19]
ds_read_b64_tr_b16 v[206:207], v91 offset:3840
v_mfma_f32_16x16x32_bf16 v[20:23], v[196:199], v[176:179], v[20:23]
ds_read_b64_tr_b16 v[208:209], v91 offset:3104
v_mfma_f32_16x16x32_bf16 v[24:27], v[200:203], v[176:179], v[24:27]
ds_read_b128 v[176:179], v252 offset:46784
v_mfma_f32_16x16x32_bf16 v[28:31], v[192:195], v[180:183], v[28:31]
ds_read_b64_tr_b16 v[210:211], v91 offset:3872
v_mfma_f32_16x16x32_bf16 v[32:35], v[196:199], v[180:183], v[32:35]
ds_read_b64_tr_b16 v[212:213], v91 offset:3136
v_mfma_f32_16x16x32_bf16 v[36:39], v[200:203], v[180:183], v[36:39]
ds_read_b128 v[180:183], v253 offset:40640
s_waitcnt lgkmcnt(8)
v_mfma_f32_16x16x32_bf16 v[40:43], v[192:195], v[184:187], v[40:43]
ds_read_b64_tr_b16 v[214:215], v91 offset:3904
v_mfma_f32_16x16x32_bf16 v[44:47], v[196:199], v[184:187], v[44:47]
s_mov_b32 s34, 221184
v_mfma_f32_16x16x32_bf16 v[48:51], v[200:203], v[184:187], v[48:51]
ds_read_b128 v[184:187], v253 offset:41664
v_mfma_f32_16x16x32_bf16 v[52:55], v[192:195], v[188:191], v[52:55]
buffer_load_dwordx4 v[228:231], v255, s[12:15], s34 offen offset:0 sc1
v_mfma_f32_16x16x32_bf16 v[56:59], v[196:199], v[188:191], v[56:59]
buffer_load_dwordx4 v[232:235], v255, s[12:15], s34 offen offset:1024 sc1
v_mfma_f32_16x16x32_bf16 v[60:63], v[200:203], v[188:191], v[60:63]
ds_read_b128 v[188:191], v253 offset:42688
s_waitcnt lgkmcnt(6)
v_mfma_f32_16x16x32_bf16 v[64:67], v[192:195], v[172:175], v[64:67]
v_mfma_f32_16x16x32_bf16 v[68:71], v[196:199], v[172:175], v[68:71]
buffer_load_dwordx4 v[236:239], v255, s[12:15], s34 offen offset:2048 sc1
v_mfma_f32_16x16x32_bf16 v[72:75], v[200:203], v[172:175], v[72:75]
ds_read_b128 v[172:175], v253 offset:43712
v_mfma_f32_16x16x32_bf16 v[76:79], v[192:195], v[176:179], v[76:79]
v_mfma_f32_16x16x32_bf16 v[80:83], v[196:199], v[176:179], v[80:83]
v_mfma_f32_16x16x32_bf16 v[84:87], v[200:203], v[176:179], v[84:87]
ds_read_b128 v[176:179], v253 offset:44736
s_waitcnt lgkmcnt(4)
s_waitcnt lgkmcnt(3)
v_mfma_f32_16x16x32_bf16 v[4:7], v[204:207], v[180:183], v[4:7]
s_waitcnt vmcnt(3)
s_mov_b32 s37, 233472
v_mfma_f32_16x16x32_bf16 v[8:11], v[208:211], v[180:183], v[8:11]
ds_read_b64_tr_b16 v[216:217], v91 offset:6144
buffer_load_dwordx4 v[240:243], v255, s[12:15], s37 offen offset:0 sc1
v_mfma_f32_16x16x32_bf16 v[12:15], v[212:215], v[180:183], v[12:15]
ds_read_b128 v[180:183], v253 offset:45760
v_mfma_f32_16x16x32_bf16 v[16:19], v[204:207], v[184:187], v[16:19]
ds_read_b64_tr_b16 v[218:219], v91 offset:6912
buffer_load_dwordx4 v[244:247], v255, s[12:15], s37 offen offset:1024 sc1
v_mfma_f32_16x16x32_bf16 v[20:23], v[208:211], v[184:187], v[20:23]
ds_read_b64_tr_b16 v[220:221], v91 offset:6176
v_mfma_f32_16x16x32_bf16 v[24:27], v[212:215], v[184:187], v[24:27]
ds_read_b128 v[184:187], v253 offset:46784
buffer_load_dwordx4 v[248:251], v255, s[12:15], s37 offen offset:2048 sc1
s_waitcnt lgkmcnt(6)
v_mfma_f32_16x16x32_bf16 v[28:31], v[204:207], v[188:191], v[28:31]
ds_read_b64_tr_b16 v[222:223], v91 offset:6944
v_mfma_f32_16x16x32_bf16 v[32:35], v[208:211], v[188:191], v[32:35]
ds_read_b64_tr_b16 v[224:225], v91 offset:6208
v_mfma_f32_16x16x32_bf16 v[36:39], v[212:215], v[188:191], v[36:39]
ds_read_b128 v[188:191], v254 offset:40640
v_mfma_f32_16x16x32_bf16 v[40:43], v[204:207], v[172:175], v[40:43]
ds_read_b64_tr_b16 v[226:227], v91 offset:6976
v_mfma_f32_16x16x32_bf16 v[44:47], v[208:211], v[172:175], v[44:47]
s_mov_b32 s34, 245760
v_mfma_f32_16x16x32_bf16 v[48:51], v[212:215], v[172:175], v[48:51]
ds_read_b128 v[172:175], v254 offset:41664
s_waitcnt lgkmcnt(8)
v_mfma_f32_16x16x32_bf16 v[52:55], v[204:207], v[176:179], v[52:55]
buffer_load_dwordx4 v[192:195], v255, s[12:15], s34 offen offset:0 sc1
v_mfma_f32_16x16x32_bf16 v[56:59], v[208:211], v[176:179], v[56:59]
buffer_load_dwordx4 v[196:199], v255, s[12:15], s34 offen offset:1024 sc1
v_mfma_f32_16x16x32_bf16 v[60:63], v[212:215], v[176:179], v[60:63]
ds_read_b128 v[176:179], v254 offset:42688
v_mfma_f32_16x16x32_bf16 v[64:67], v[204:207], v[180:183], v[64:67]
v_mfma_f32_16x16x32_bf16 v[68:71], v[208:211], v[180:183], v[68:71]
buffer_load_dwordx4 v[200:203], v255, s[12:15], s34 offen offset:2048 sc1
v_mfma_f32_16x16x32_bf16 v[72:75], v[212:215], v[180:183], v[72:75]
ds_read_b128 v[180:183], v254 offset:43712
s_waitcnt lgkmcnt(4)
v_mfma_f32_16x16x32_bf16 v[76:79], v[204:207], v[184:187], v[76:79]
v_mfma_f32_16x16x32_bf16 v[80:83], v[208:211], v[184:187], v[80:83]
v_mfma_f32_16x16x32_bf16 v[84:87], v[212:215], v[184:187], v[84:87]
ds_read_b128 v[184:187], v254 offset:44736
s_barrier
s_waitcnt lgkmcnt(4)
v_mfma_f32_16x16x32_bf16 v[4:7], v[216:219], v[188:191], v[4:7]
v_mfma_f32_16x16x32_bf16 v[8:11], v[220:223], v[188:191], v[8:11]
v_mfma_f32_16x16x32_bf16 v[12:15], v[224:227], v[188:191], v[12:15]
ds_read_b128 v[188:191], v254 offset:45760
s_waitcnt lgkmcnt(3)
v_mfma_f32_16x16x32_bf16 v[16:19], v[216:219], v[172:175], v[16:19]
v_mfma_f32_16x16x32_bf16 v[20:23], v[220:223], v[172:175], v[20:23]
v_mfma_f32_16x16x32_bf16 v[24:27], v[224:227], v[172:175], v[24:27]
ds_read_b128 v[172:175], v254 offset:46784
v_mfma_f32_16x16x32_bf16 v[28:31], v[216:219], v[176:179], v[28:31]
v_mfma_f32_16x16x32_bf16 v[32:35], v[220:223], v[176:179], v[32:35]
v_add_u32 v252, 48768, v252
v_mfma_f32_16x16x32_bf16 v[36:39], v[224:227], v[176:179], v[36:39]
ds_read_b128 v[176:179], v252 offset:0
s_waitcnt lgkmcnt(3)
v_mfma_f32_16x16x32_bf16 v[40:43], v[216:219], v[180:183], v[40:43]
v_mfma_f32_16x16x32_bf16 v[44:47], v[220:223], v[180:183], v[44:47]
s_mov_b32 s37, 258048
v_mfma_f32_16x16x32_bf16 v[48:51], v[224:227], v[180:183], v[48:51]
ds_read_b128 v[180:183], v252 offset:1024
v_mfma_f32_16x16x32_bf16 v[52:55], v[216:219], v[184:187], v[52:55]
buffer_load_dwordx4 v[204:207], v255, s[12:15], s37 offen offset:0 sc1
v_mfma_f32_16x16x32_bf16 v[56:59], v[220:223], v[184:187], v[56:59]
buffer_load_dwordx4 v[208:211], v255, s[12:15], s37 offen offset:1024 sc1
v_mfma_f32_16x16x32_bf16 v[60:63], v[224:227], v[184:187], v[60:63]
ds_read_b128 v[184:187], v252 offset:2048
s_waitcnt lgkmcnt(3)
v_mfma_f32_16x16x32_bf16 v[64:67], v[216:219], v[188:191], v[64:67]
v_mfma_f32_16x16x32_bf16 v[68:71], v[220:223], v[188:191], v[68:71]
buffer_load_dwordx4 v[212:215], v255, s[12:15], s37 offen offset:2048 sc1
v_mfma_f32_16x16x32_bf16 v[72:75], v[224:227], v[188:191], v[72:75]
ds_read_b128 v[188:191], v252 offset:3072
v_mfma_f32_16x16x32_bf16 v[76:79], v[216:219], v[172:175], v[76:79]
v_mfma_f32_16x16x32_bf16 v[80:83], v[220:223], v[172:175], v[80:83]
v_mfma_f32_16x16x32_bf16 v[84:87], v[224:227], v[172:175], v[84:87]
ds_read_b128 v[172:175], v252 offset:4096
s_waitcnt vmcnt(9)
s_waitcnt lgkmcnt(3)
v_mfma_f32_16x16x32_bf16 v[88:91], v[228:231], v[176:179], 0
s_mov_b32 s34, 270336
v_mfma_f32_16x16x32_bf16 v[92:95], v[232:235], v[176:179], 0
buffer_load_dwordx4 v[216:219], v255, s[12:15], s34 offen offset:0 sc1
v_mfma_f32_16x16x32_bf16 v[96:99], v[236:239], v[176:179], 0
ds_read_b128 v[176:179], v252 offset:5120
v_mfma_f32_16x16x32_bf16 v[100:103], v[228:231], v[180:183], 0
v_mfma_f32_16x16x32_bf16 v[104:107], v[232:235], v[180:183], 0
buffer_load_dwordx4 v[220:223], v255, s[12:15], s34 offen offset:1024 sc1
v_mfma_f32_16x16x32_bf16 v[108:111], v[236:239], v[180:183], 0
ds_read_b128 v[180:183], v252 offset:6144
s_waitcnt lgkmcnt(3)
v_mfma_f32_16x16x32_bf16 v[112:115], v[228:231], v[184:187], 0
buffer_load_dwordx4 v[224:227], v255, s[12:15], s34 offen offset:2048 sc1
v_mfma_f32_16x16x32_bf16 v[116:119], v[232:235], v[184:187], 0
v_add_u32 v253, 48768, v253
v_mfma_f32_16x16x32_bf16 v[120:123], v[236:239], v[184:187], 0
ds_read_b128 v[184:187], v253 offset:0
v_mfma_f32_16x16x32_bf16 v[124:127], v[228:231], v[188:191], 0
v_mfma_f32_16x16x32_bf16 v[128:131], v[232:235], v[188:191], 0
v_mfma_f32_16x16x32_bf16 v[132:135], v[236:239], v[188:191], 0
ds_read_b128 v[188:191], v253 offset:1024
s_waitcnt lgkmcnt(3)
v_mfma_f32_16x16x32_bf16 v[136:139], v[228:231], v[172:175], 0
v_mfma_f32_16x16x32_bf16 v[140:143], v[232:235], v[172:175], 0
v_mfma_f32_16x16x32_bf16 v[144:147], v[236:239], v[172:175], 0
ds_read_b128 v[172:175], v253 offset:2048
v_mfma_f32_16x16x32_bf16 v[148:151], v[228:231], v[176:179], 0
v_mfma_f32_16x16x32_bf16 v[152:155], v[232:235], v[176:179], 0
v_mfma_f32_16x16x32_bf16 v[156:159], v[236:239], v[176:179], 0
ds_read_b128 v[176:179], v253 offset:3072
s_waitcnt lgkmcnt(3)
v_mfma_f32_16x16x32_bf16 v[160:163], v[228:231], v[180:183], 0
v_mfma_f32_16x16x32_bf16 v[164:167], v[232:235], v[180:183], 0
v_mfma_f32_16x16x32_bf16 v[168:171], v[236:239], v[180:183], 0
ds_read_b128 v[180:183], v253 offset:4096
s_waitcnt vmcnt(9)
v_mfma_f32_16x16x32_bf16 v[88:91], v[240:243], v[184:187], v[88:91]
s_mov_b32 s37, 282624
v_mfma_f32_16x16x32_bf16 v[92:95], v[244:247], v[184:187], v[92:95]
buffer_load_dwordx4 v[228:231], v255, s[12:15], s37 offen offset:0 sc1
v_mfma_f32_16x16x32_bf16 v[96:99], v[248:251], v[184:187], v[96:99]
ds_read_b128 v[184:187], v253 offset:5120
s_waitcnt lgkmcnt(3)
v_mfma_f32_16x16x32_bf16 v[100:103], v[240:243], v[188:191], v[100:103]
v_mfma_f32_16x16x32_bf16 v[104:107], v[244:247], v[188:191], v[104:107]
buffer_load_dwordx4 v[232:235], v255, s[12:15], s37 offen offset:1024 sc1
v_mfma_f32_16x16x32_bf16 v[108:111], v[248:251], v[188:191], v[108:111]
ds_read_b128 v[188:191], v253 offset:6144
v_mfma_f32_16x16x32_bf16 v[112:115], v[240:243], v[172:175], v[112:115]
buffer_load_dwordx4 v[236:239], v255, s[12:15], s37 offen offset:2048 sc1
v_mfma_f32_16x16x32_bf16 v[116:119], v[244:247], v[172:175], v[116:119]
v_add_u32 v254, 48768, v254
v_mfma_f32_16x16x32_bf16 v[120:123], v[248:251], v[172:175], v[120:123]
ds_read_b128 v[172:175], v254 offset:0
s_waitcnt lgkmcnt(3)
v_mfma_f32_16x16x32_bf16 v[124:127], v[240:243], v[176:179], v[124:127]
v_mfma_f32_16x16x32_bf16 v[128:131], v[244:247], v[176:179], v[128:131]
v_mfma_f32_16x16x32_bf16 v[132:135], v[248:251], v[176:179], v[132:135]
ds_read_b128 v[176:179], v254 offset:1024
v_mfma_f32_16x16x32_bf16 v[136:139], v[240:243], v[180:183], v[136:139]
v_mfma_f32_16x16x32_bf16 v[140:143], v[244:247], v[180:183], v[140:143]
v_mfma_f32_16x16x32_bf16 v[144:147], v[248:251], v[180:183], v[144:147]
ds_read_b128 v[180:183], v254 offset:2048
s_waitcnt lgkmcnt(3)
v_mfma_f32_16x16x32_bf16 v[148:151], v[240:243], v[184:187], v[148:151]
v_mfma_f32_16x16x32_bf16 v[152:155], v[244:247], v[184:187], v[152:155]
v_mfma_f32_16x16x32_bf16 v[156:159], v[248:251], v[184:187], v[156:159]
ds_read_b128 v[184:187], v254 offset:3072
v_mfma_f32_16x16x32_bf16 v[160:163], v[240:243], v[188:191], v[160:163]
v_mfma_f32_16x16x32_bf16 v[164:167], v[244:247], v[188:191], v[164:167]
v_mfma_f32_16x16x32_bf16 v[168:171], v[248:251], v[188:191], v[168:171]
ds_read_b128 v[188:191], v254 offset:4096
s_waitcnt vmcnt(9)
s_waitcnt lgkmcnt(3)
v_mfma_f32_16x16x32_bf16 v[88:91], v[192:195], v[172:175], v[88:91]
s_mov_b32 s34, 294912
v_mfma_f32_16x16x32_bf16 v[92:95], v[196:199], v[172:175], v[92:95]
buffer_load_dwordx4 v[240:243], v255, s[12:15], s34 offen offset:0 sc1
v_mfma_f32_16x16x32_bf16 v[96:99], v[200:203], v[172:175], v[96:99]
ds_read_b128 v[172:175], v254 offset:5120
v_mfma_f32_16x16x32_bf16 v[100:103], v[192:195], v[176:179], v[100:103]
v_mfma_f32_16x16x32_bf16 v[104:107], v[196:199], v[176:179], v[104:107]
buffer_load_dwordx4 v[244:247], v255, s[12:15], s34 offen offset:1024 sc1
v_mfma_f32_16x16x32_bf16 v[108:111], v[200:203], v[176:179], v[108:111]
ds_read_b128 v[176:179], v254 offset:6144
s_waitcnt lgkmcnt(3)
v_mfma_f32_16x16x32_bf16 v[112:115], v[192:195], v[180:183], v[112:115]
buffer_load_dwordx4 v[248:251], v255, s[12:15], s34 offen offset:2048 sc1
v_mfma_f32_16x16x32_bf16 v[116:119], v[196:199], v[180:183], v[116:119]
v_mfma_f32_16x16x32_bf16 v[120:123], v[200:203], v[180:183], v[120:123]
ds_read_b128 v[180:183], v252 offset:8128
v_mfma_f32_16x16x32_bf16 v[124:127], v[192:195], v[184:187], v[124:127]
v_mfma_f32_16x16x32_bf16 v[128:131], v[196:199], v[184:187], v[128:131]
v_mfma_f32_16x16x32_bf16 v[132:135], v[200:203], v[184:187], v[132:135]
ds_read_b128 v[184:187], v252 offset:9152
s_waitcnt lgkmcnt(3)
v_mfma_f32_16x16x32_bf16 v[136:139], v[192:195], v[188:191], v[136:139]
v_mfma_f32_16x16x32_bf16 v[140:143], v[196:199], v[188:191], v[140:143]
v_mfma_f32_16x16x32_bf16 v[144:147], v[200:203], v[188:191], v[144:147]
ds_read_b128 v[188:191], v252 offset:10176
v_mfma_f32_16x16x32_bf16 v[148:151], v[192:195], v[172:175], v[148:151]
v_mfma_f32_16x16x32_bf16 v[152:155], v[196:199], v[172:175], v[152:155]
v_mfma_f32_16x16x32_bf16 v[156:159], v[200:203], v[172:175], v[156:159]
ds_read_b128 v[172:175], v252 offset:11200
s_waitcnt lgkmcnt(3)
v_mfma_f32_16x16x32_bf16 v[160:163], v[192:195], v[176:179], v[160:163]
v_mfma_f32_16x16x32_bf16 v[164:167], v[196:199], v[176:179], v[164:167]
v_mfma_f32_16x16x32_bf16 v[168:171], v[200:203], v[176:179], v[168:171]
ds_read_b128 v[176:179], v252 offset:12224
s_waitcnt vmcnt(9)
v_mfma_f32_16x16x32_bf16 v[88:91], v[204:207], v[180:183], v[88:91]
s_mov_b32 s37, 307200
v_mfma_f32_16x16x32_bf16 v[92:95], v[208:211], v[180:183], v[92:95]
buffer_load_dwordx4 v[192:195], v255, s[12:15], s37 offen offset:0 sc1
v_mfma_f32_16x16x32_bf16 v[96:99], v[212:215], v[180:183], v[96:99]
ds_read_b128 v[180:183], v252 offset:13248
s_waitcnt lgkmcnt(3)
v_mfma_f32_16x16x32_bf16 v[100:103], v[204:207], v[184:187], v[100:103]
v_mfma_f32_16x16x32_bf16 v[104:107], v[208:211], v[184:187], v[104:107]
buffer_load_dwordx4 v[196:199], v255, s[12:15], s37 offen offset:1024 sc1
v_mfma_f32_16x16x32_bf16 v[108:111], v[212:215], v[184:187], v[108:111]
ds_read_b128 v[184:187], v252 offset:14272
v_mfma_f32_16x16x32_bf16 v[112:115], v[204:207], v[188:191], v[112:115]
buffer_load_dwordx4 v[200:203], v255, s[12:15], s37 offen offset:2048 sc1
v_mfma_f32_16x16x32_bf16 v[116:119], v[208:211], v[188:191], v[116:119]
v_mfma_f32_16x16x32_bf16 v[120:123], v[212:215], v[188:191], v[120:123]
ds_read_b128 v[188:191], v253 offset:8128
s_waitcnt lgkmcnt(3)
v_mfma_f32_16x16x32_bf16 v[124:127], v[204:207], v[172:175], v[124:127]
v_mfma_f32_16x16x32_bf16 v[128:131], v[208:211], v[172:175], v[128:131]
v_mfma_f32_16x16x32_bf16 v[132:135], v[212:215], v[172:175], v[132:135]
ds_read_b128 v[172:175], v253 offset:9152
v_mfma_f32_16x16x32_bf16 v[136:139], v[204:207], v[176:179], v[136:139]
v_mfma_f32_16x16x32_bf16 v[140:143], v[208:211], v[176:179], v[140:143]
v_mfma_f32_16x16x32_bf16 v[144:147], v[212:215], v[176:179], v[144:147]
ds_read_b128 v[176:179], v253 offset:10176
s_waitcnt lgkmcnt(3)
v_mfma_f32_16x16x32_bf16 v[148:151], v[204:207], v[180:183], v[148:151]
v_mfma_f32_16x16x32_bf16 v[152:155], v[208:211], v[180:183], v[152:155]
v_mfma_f32_16x16x32_bf16 v[156:159], v[212:215], v[180:183], v[156:159]
ds_read_b128 v[180:183], v253 offset:11200
v_mfma_f32_16x16x32_bf16 v[160:163], v[204:207], v[184:187], v[160:163]
v_mfma_f32_16x16x32_bf16 v[164:167], v[208:211], v[184:187], v[164:167]
v_mfma_f32_16x16x32_bf16 v[168:171], v[212:215], v[184:187], v[168:171]
ds_read_b128 v[184:187], v253 offset:12224
s_waitcnt vmcnt(9)
s_waitcnt lgkmcnt(3)
v_mfma_f32_16x16x32_bf16 v[88:91], v[216:219], v[188:191], v[88:91]
s_mov_b32 s34, 319488
v_mfma_f32_16x16x32_bf16 v[92:95], v[220:223], v[188:191], v[92:95]
buffer_load_dwordx4 v[204:207], v255, s[12:15], s34 offen offset:0 sc1
v_mfma_f32_16x16x32_bf16 v[96:99], v[224:227], v[188:191], v[96:99]
ds_read_b128 v[188:191], v253 offset:13248
v_mfma_f32_16x16x32_bf16 v[100:103], v[216:219], v[172:175], v[100:103]
v_mfma_f32_16x16x32_bf16 v[104:107], v[220:223], v[172:175], v[104:107]
buffer_load_dwordx4 v[208:211], v255, s[12:15], s34 offen offset:1024 sc1
v_mfma_f32_16x16x32_bf16 v[108:111], v[224:227], v[172:175], v[108:111]
ds_read_b128 v[172:175], v253 offset:14272
s_waitcnt lgkmcnt(3)
v_mfma_f32_16x16x32_bf16 v[112:115], v[216:219], v[176:179], v[112:115]
buffer_load_dwordx4 v[212:215], v255, s[12:15], s34 offen offset:2048 sc1
v_mfma_f32_16x16x32_bf16 v[116:119], v[220:223], v[176:179], v[116:119]
v_mfma_f32_16x16x32_bf16 v[120:123], v[224:227], v[176:179], v[120:123]
ds_read_b128 v[176:179], v254 offset:8128
v_mfma_f32_16x16x32_bf16 v[124:127], v[216:219], v[180:183], v[124:127]
v_mfma_f32_16x16x32_bf16 v[128:131], v[220:223], v[180:183], v[128:131]
v_mfma_f32_16x16x32_bf16 v[132:135], v[224:227], v[180:183], v[132:135]
ds_read_b128 v[180:183], v254 offset:9152
s_waitcnt lgkmcnt(3)
v_mfma_f32_16x16x32_bf16 v[136:139], v[216:219], v[184:187], v[136:139]
v_mfma_f32_16x16x32_bf16 v[140:143], v[220:223], v[184:187], v[140:143]
v_mfma_f32_16x16x32_bf16 v[144:147], v[224:227], v[184:187], v[144:147]
ds_read_b128 v[184:187], v254 offset:10176
v_mfma_f32_16x16x32_bf16 v[148:151], v[216:219], v[188:191], v[148:151]
v_mfma_f32_16x16x32_bf16 v[152:155], v[220:223], v[188:191], v[152:155]
v_mfma_f32_16x16x32_bf16 v[156:159], v[224:227], v[188:191], v[156:159]
ds_read_b128 v[188:191], v254 offset:11200
s_waitcnt lgkmcnt(3)
v_mfma_f32_16x16x32_bf16 v[160:163], v[216:219], v[172:175], v[160:163]
v_mfma_f32_16x16x32_bf16 v[164:167], v[220:223], v[172:175], v[164:167]
v_mfma_f32_16x16x32_bf16 v[168:171], v[224:227], v[172:175], v[168:171]
ds_read_b128 v[172:175], v254 offset:12224
s_barrier
s_waitcnt vmcnt(9)
v_mfma_f32_16x16x32_bf16 v[88:91], v[228:231], v[176:179], v[88:91]
s_mov_b32 s37, 331776
v_mfma_f32_16x16x32_bf16 v[92:95], v[232:235], v[176:179], v[92:95]
buffer_load_dwordx4 v[216:219], v255, s[12:15], s37 offen offset:0 sc1
v_mfma_f32_16x16x32_bf16 v[96:99], v[236:239], v[176:179], v[96:99]
ds_read_b128 v[176:179], v254 offset:13248
s_waitcnt lgkmcnt(3)
v_mfma_f32_16x16x32_bf16 v[100:103], v[228:231], v[180:183], v[100:103]
v_mfma_f32_16x16x32_bf16 v[104:107], v[232:235], v[180:183], v[104:107]
buffer_load_dwordx4 v[220:223], v255, s[12:15], s37 offen offset:1024 sc1
v_mfma_f32_16x16x32_bf16 v[108:111], v[236:239], v[180:183], v[108:111]
ds_read_b128 v[180:183], v254 offset:14272
v_mfma_f32_16x16x32_bf16 v[112:115], v[228:231], v[184:187], v[112:115]
buffer_load_dwordx4 v[224:227], v255, s[12:15], s37 offen offset:2048 sc1
v_mfma_f32_16x16x32_bf16 v[116:119], v[232:235], v[184:187], v[116:119]
v_mfma_f32_16x16x32_bf16 v[120:123], v[236:239], v[184:187], v[120:123]
ds_read_b128 v[184:187], v252 offset:16256
s_waitcnt lgkmcnt(3)
v_mfma_f32_16x16x32_bf16 v[124:127], v[228:231], v[188:191], v[124:127]
v_mfma_f32_16x16x32_bf16 v[128:131], v[232:235], v[188:191], v[128:131]
v_mfma_f32_16x16x32_bf16 v[132:135], v[236:239], v[188:191], v[132:135]
ds_read_b128 v[188:191], v252 offset:17280
v_mfma_f32_16x16x32_bf16 v[136:139], v[228:231], v[172:175], v[136:139]
v_mfma_f32_16x16x32_bf16 v[140:143], v[232:235], v[172:175], v[140:143]
v_mfma_f32_16x16x32_bf16 v[144:147], v[236:239], v[172:175], v[144:147]
ds_read_b128 v[172:175], v252 offset:18304
s_waitcnt lgkmcnt(3)
v_mfma_f32_16x16x32_bf16 v[148:151], v[228:231], v[176:179], v[148:151]
v_mfma_f32_16x16x32_bf16 v[152:155], v[232:235], v[176:179], v[152:155]
v_mfma_f32_16x16x32_bf16 v[156:159], v[236:239], v[176:179], v[156:159]
ds_read_b128 v[176:179], v252 offset:19328
v_mfma_f32_16x16x32_bf16 v[160:163], v[228:231], v[180:183], v[160:163]
v_mfma_f32_16x16x32_bf16 v[164:167], v[232:235], v[180:183], v[164:167]
v_mfma_f32_16x16x32_bf16 v[168:171], v[236:239], v[180:183], v[168:171]
ds_read_b128 v[180:183], v252 offset:20352
s_waitcnt vmcnt(9)
s_waitcnt lgkmcnt(3)
v_mfma_f32_16x16x32_bf16 v[88:91], v[240:243], v[184:187], v[88:91]
s_mov_b32 s34, 344064
v_mfma_f32_16x16x32_bf16 v[92:95], v[244:247], v[184:187], v[92:95]
buffer_load_dwordx4 v[228:231], v255, s[12:15], s34 offen offset:0 sc1
v_mfma_f32_16x16x32_bf16 v[96:99], v[248:251], v[184:187], v[96:99]
ds_read_b128 v[184:187], v252 offset:21376
v_mfma_f32_16x16x32_bf16 v[100:103], v[240:243], v[188:191], v[100:103]
v_mfma_f32_16x16x32_bf16 v[104:107], v[244:247], v[188:191], v[104:107]
buffer_load_dwordx4 v[232:235], v255, s[12:15], s34 offen offset:1024 sc1
v_mfma_f32_16x16x32_bf16 v[108:111], v[248:251], v[188:191], v[108:111]
ds_read_b128 v[188:191], v252 offset:22400
s_waitcnt lgkmcnt(3)
v_mfma_f32_16x16x32_bf16 v[112:115], v[240:243], v[172:175], v[112:115]
buffer_load_dwordx4 v[236:239], v255, s[12:15], s34 offen offset:2048 sc1
v_mfma_f32_16x16x32_bf16 v[116:119], v[244:247], v[172:175], v[116:119]
v_mfma_f32_16x16x32_bf16 v[120:123], v[248:251], v[172:175], v[120:123]
ds_read_b128 v[172:175], v253 offset:16256
v_mfma_f32_16x16x32_bf16 v[124:127], v[240:243], v[176:179], v[124:127]
v_mfma_f32_16x16x32_bf16 v[128:131], v[244:247], v[176:179], v[128:131]
v_mfma_f32_16x16x32_bf16 v[132:135], v[248:251], v[176:179], v[132:135]
ds_read_b128 v[176:179], v253 offset:17280
s_waitcnt lgkmcnt(3)
v_mfma_f32_16x16x32_bf16 v[136:139], v[240:243], v[180:183], v[136:139]
v_mfma_f32_16x16x32_bf16 v[140:143], v[244:247], v[180:183], v[140:143]
v_mfma_f32_16x16x32_bf16 v[144:147], v[248:251], v[180:183], v[144:147]
ds_read_b128 v[180:183], v253 offset:18304
v_mfma_f32_16x16x32_bf16 v[148:151], v[240:243], v[184:187], v[148:151]
v_mfma_f32_16x16x32_bf16 v[152:155], v[244:247], v[184:187], v[152:155]
v_mfma_f32_16x16x32_bf16 v[156:159], v[248:251], v[184:187], v[156:159]
ds_read_b128 v[184:187], v253 offset:19328
s_waitcnt lgkmcnt(3)
v_mfma_f32_16x16x32_bf16 v[160:163], v[240:243], v[188:191], v[160:163]
v_mfma_f32_16x16x32_bf16 v[164:167], v[244:247], v[188:191], v[164:167]
v_mfma_f32_16x16x32_bf16 v[168:171], v[248:251], v[188:191], v[168:171]
ds_read_b128 v[188:191], v253 offset:20352
s_waitcnt vmcnt(9)
v_mfma_f32_16x16x32_bf16 v[88:91], v[192:195], v[172:175], v[88:91]
s_mov_b32 s37, 356352
v_mfma_f32_16x16x32_bf16 v[92:95], v[196:199], v[172:175], v[92:95]
buffer_load_dwordx4 v[240:243], v255, s[12:15], s37 offen offset:0 sc1
v_mfma_f32_16x16x32_bf16 v[96:99], v[200:203], v[172:175], v[96:99]
ds_read_b128 v[172:175], v253 offset:21376
s_waitcnt lgkmcnt(3)
v_mfma_f32_16x16x32_bf16 v[100:103], v[192:195], v[176:179], v[100:103]
v_mfma_f32_16x16x32_bf16 v[104:107], v[196:199], v[176:179], v[104:107]
buffer_load_dwordx4 v[244:247], v255, s[12:15], s37 offen offset:1024 sc1
v_mfma_f32_16x16x32_bf16 v[108:111], v[200:203], v[176:179], v[108:111]
ds_read_b128 v[176:179], v253 offset:22400
v_mfma_f32_16x16x32_bf16 v[112:115], v[192:195], v[180:183], v[112:115]
buffer_load_dwordx4 v[248:251], v255, s[12:15], s37 offen offset:2048 sc1
v_mfma_f32_16x16x32_bf16 v[116:119], v[196:199], v[180:183], v[116:119]
v_mfma_f32_16x16x32_bf16 v[120:123], v[200:203], v[180:183], v[120:123]
ds_read_b128 v[180:183], v254 offset:16256
s_waitcnt lgkmcnt(3)
v_mfma_f32_16x16x32_bf16 v[124:127], v[192:195], v[184:187], v[124:127]
v_mfma_f32_16x16x32_bf16 v[128:131], v[196:199], v[184:187], v[128:131]
v_mfma_f32_16x16x32_bf16 v[132:135], v[200:203], v[184:187], v[132:135]
ds_read_b128 v[184:187], v254 offset:17280
v_mfma_f32_16x16x32_bf16 v[136:139], v[192:195], v[188:191], v[136:139]
v_mfma_f32_16x16x32_bf16 v[140:143], v[196:199], v[188:191], v[140:143]
v_mfma_f32_16x16x32_bf16 v[144:147], v[200:203], v[188:191], v[144:147]
ds_read_b128 v[188:191], v254 offset:18304
s_waitcnt lgkmcnt(3)
v_mfma_f32_16x16x32_bf16 v[148:151], v[192:195], v[172:175], v[148:151]
v_mfma_f32_16x16x32_bf16 v[152:155], v[196:199], v[172:175], v[152:155]
v_mfma_f32_16x16x32_bf16 v[156:159], v[200:203], v[172:175], v[156:159]
ds_read_b128 v[172:175], v254 offset:19328
v_mfma_f32_16x16x32_bf16 v[160:163], v[192:195], v[176:179], v[160:163]
v_mfma_f32_16x16x32_bf16 v[164:167], v[196:199], v[176:179], v[164:167]
v_mfma_f32_16x16x32_bf16 v[168:171], v[200:203], v[176:179], v[168:171]
ds_read_b128 v[176:179], v254 offset:20352
s_waitcnt vmcnt(9)
s_waitcnt lgkmcnt(3)
v_mfma_f32_16x16x32_bf16 v[88:91], v[204:207], v[180:183], v[88:91]
s_mov_b32 s34, 368640
v_mfma_f32_16x16x32_bf16 v[92:95], v[208:211], v[180:183], v[92:95]
buffer_load_dwordx4 v[192:195], v255, s[12:15], s34 offen offset:0 sc1
v_mfma_f32_16x16x32_bf16 v[96:99], v[212:215], v[180:183], v[96:99]
ds_read_b128 v[180:183], v254 offset:21376
v_mfma_f32_16x16x32_bf16 v[100:103], v[204:207], v[184:187], v[100:103]
v_mfma_f32_16x16x32_bf16 v[104:107], v[208:211], v[184:187], v[104:107]
buffer_load_dwordx4 v[196:199], v255, s[12:15], s34 offen offset:1024 sc1
v_mfma_f32_16x16x32_bf16 v[108:111], v[212:215], v[184:187], v[108:111]
ds_read_b128 v[184:187], v254 offset:22400
s_waitcnt lgkmcnt(3)
v_mfma_f32_16x16x32_bf16 v[112:115], v[204:207], v[188:191], v[112:115]
buffer_load_dwordx4 v[200:203], v255, s[12:15], s34 offen offset:2048 sc1
v_mfma_f32_16x16x32_bf16 v[116:119], v[208:211], v[188:191], v[116:119]
v_mfma_f32_16x16x32_bf16 v[120:123], v[212:215], v[188:191], v[120:123]
ds_read_b128 v[188:191], v252 offset:24384
v_mfma_f32_16x16x32_bf16 v[124:127], v[204:207], v[172:175], v[124:127]
v_mfma_f32_16x16x32_bf16 v[128:131], v[208:211], v[172:175], v[128:131]
v_mfma_f32_16x16x32_bf16 v[132:135], v[212:215], v[172:175], v[132:135]
ds_read_b128 v[172:175], v252 offset:25408
s_waitcnt lgkmcnt(3)
v_mfma_f32_16x16x32_bf16 v[136:139], v[204:207], v[176:179], v[136:139]
v_mfma_f32_16x16x32_bf16 v[140:143], v[208:211], v[176:179], v[140:143]
v_mfma_f32_16x16x32_bf16 v[144:147], v[212:215], v[176:179], v[144:147]
ds_read_b128 v[176:179], v252 offset:26432
v_mfma_f32_16x16x32_bf16 v[148:151], v[204:207], v[180:183], v[148:151]
v_mfma_f32_16x16x32_bf16 v[152:155], v[208:211], v[180:183], v[152:155]
v_mfma_f32_16x16x32_bf16 v[156:159], v[212:215], v[180:183], v[156:159]
ds_read_b128 v[180:183], v252 offset:27456
s_waitcnt lgkmcnt(3)
v_mfma_f32_16x16x32_bf16 v[160:163], v[204:207], v[184:187], v[160:163]
v_mfma_f32_16x16x32_bf16 v[164:167], v[208:211], v[184:187], v[164:167]
v_mfma_f32_16x16x32_bf16 v[168:171], v[212:215], v[184:187], v[168:171]
ds_read_b128 v[184:187], v252 offset:28480
s_waitcnt vmcnt(9)
v_mfma_f32_16x16x32_bf16 v[88:91], v[216:219], v[188:191], v[88:91]
s_mov_b32 s37, 380928
v_mfma_f32_16x16x32_bf16 v[92:95], v[220:223], v[188:191], v[92:95]
buffer_load_dwordx4 v[204:207], v255, s[12:15], s37 offen offset:0 sc1
v_mfma_f32_16x16x32_bf16 v[96:99], v[224:227], v[188:191], v[96:99]
ds_read_b128 v[188:191], v252 offset:29504
s_waitcnt lgkmcnt(3)
v_mfma_f32_16x16x32_bf16 v[100:103], v[216:219], v[172:175], v[100:103]
v_mfma_f32_16x16x32_bf16 v[104:107], v[220:223], v[172:175], v[104:107]
buffer_load_dwordx4 v[208:211], v255, s[12:15], s37 offen offset:1024 sc1
v_mfma_f32_16x16x32_bf16 v[108:111], v[224:227], v[172:175], v[108:111]
ds_read_b128 v[172:175], v252 offset:30528
v_mfma_f32_16x16x32_bf16 v[112:115], v[216:219], v[176:179], v[112:115]
buffer_load_dwordx4 v[212:215], v255, s[12:15], s37 offen offset:2048 sc1
v_mfma_f32_16x16x32_bf16 v[116:119], v[220:223], v[176:179], v[116:119]
v_mfma_f32_16x16x32_bf16 v[120:123], v[224:227], v[176:179], v[120:123]
ds_read_b128 v[176:179], v253 offset:24384
s_waitcnt lgkmcnt(3)
v_mfma_f32_16x16x32_bf16 v[124:127], v[216:219], v[180:183], v[124:127]
v_mfma_f32_16x16x32_bf16 v[128:131], v[220:223], v[180:183], v[128:131]
v_mfma_f32_16x16x32_bf16 v[132:135], v[224:227], v[180:183], v[132:135]
ds_read_b128 v[180:183], v253 offset:25408
v_mfma_f32_16x16x32_bf16 v[136:139], v[216:219], v[184:187], v[136:139]
v_mfma_f32_16x16x32_bf16 v[140:143], v[220:223], v[184:187], v[140:143]
v_mfma_f32_16x16x32_bf16 v[144:147], v[224:227], v[184:187], v[144:147]
ds_read_b128 v[184:187], v253 offset:26432
s_waitcnt lgkmcnt(3)
v_mfma_f32_16x16x32_bf16 v[148:151], v[216:219], v[188:191], v[148:151]
v_mfma_f32_16x16x32_bf16 v[152:155], v[220:223], v[188:191], v[152:155]
v_mfma_f32_16x16x32_bf16 v[156:159], v[224:227], v[188:191], v[156:159]
ds_read_b128 v[188:191], v253 offset:27456
v_mfma_f32_16x16x32_bf16 v[160:163], v[216:219], v[172:175], v[160:163]
v_mfma_f32_16x16x32_bf16 v[164:167], v[220:223], v[172:175], v[164:167]
v_mfma_f32_16x16x32_bf16 v[168:171], v[224:227], v[172:175], v[168:171]
ds_read_b128 v[172:175], v253 offset:28480
s_waitcnt vmcnt(9)
s_waitcnt lgkmcnt(3)
v_mfma_f32_16x16x32_bf16 v[88:91], v[228:231], v[176:179], v[88:91]
s_mov_b32 s34, 393216
v_mfma_f32_16x16x32_bf16 v[92:95], v[232:235], v[176:179], v[92:95]
buffer_load_dwordx4 v[216:219], v255, s[12:15], s34 offen offset:0 sc1
v_mfma_f32_16x16x32_bf16 v[96:99], v[236:239], v[176:179], v[96:99]
ds_read_b128 v[176:179], v253 offset:29504
v_mfma_f32_16x16x32_bf16 v[100:103], v[228:231], v[180:183], v[100:103]
v_mfma_f32_16x16x32_bf16 v[104:107], v[232:235], v[180:183], v[104:107]
buffer_load_dwordx4 v[220:223], v255, s[12:15], s34 offen offset:1024 sc1
v_mfma_f32_16x16x32_bf16 v[108:111], v[236:239], v[180:183], v[108:111]
ds_read_b128 v[180:183], v253 offset:30528
s_waitcnt lgkmcnt(3)
v_mfma_f32_16x16x32_bf16 v[112:115], v[228:231], v[184:187], v[112:115]
buffer_load_dwordx4 v[224:227], v255, s[12:15], s34 offen offset:2048 sc1
v_mfma_f32_16x16x32_bf16 v[116:119], v[232:235], v[184:187], v[116:119]
v_mfma_f32_16x16x32_bf16 v[120:123], v[236:239], v[184:187], v[120:123]
ds_read_b128 v[184:187], v254 offset:24384
v_mfma_f32_16x16x32_bf16 v[124:127], v[228:231], v[188:191], v[124:127]
v_mfma_f32_16x16x32_bf16 v[128:131], v[232:235], v[188:191], v[128:131]
v_mfma_f32_16x16x32_bf16 v[132:135], v[236:239], v[188:191], v[132:135]
ds_read_b128 v[188:191], v254 offset:25408
s_waitcnt lgkmcnt(3)
v_mfma_f32_16x16x32_bf16 v[136:139], v[228:231], v[172:175], v[136:139]
v_mfma_f32_16x16x32_bf16 v[140:143], v[232:235], v[172:175], v[140:143]
v_mfma_f32_16x16x32_bf16 v[144:147], v[236:239], v[172:175], v[144:147]
ds_read_b128 v[172:175], v254 offset:26432
v_mfma_f32_16x16x32_bf16 v[148:151], v[228:231], v[176:179], v[148:151]
v_mfma_f32_16x16x32_bf16 v[152:155], v[232:235], v[176:179], v[152:155]
v_mfma_f32_16x16x32_bf16 v[156:159], v[236:239], v[176:179], v[156:159]
ds_read_b128 v[176:179], v254 offset:27456
s_waitcnt lgkmcnt(3)
v_mfma_f32_16x16x32_bf16 v[160:163], v[228:231], v[180:183], v[160:163]
v_mfma_f32_16x16x32_bf16 v[164:167], v[232:235], v[180:183], v[164:167]
v_mfma_f32_16x16x32_bf16 v[168:171], v[236:239], v[180:183], v[168:171]
ds_read_b128 v[180:183], v254 offset:28480
s_barrier
s_waitcnt vmcnt(9)
v_mfma_f32_16x16x32_bf16 v[88:91], v[240:243], v[184:187], v[88:91]
s_mov_b32 s37, 405504
v_mfma_f32_16x16x32_bf16 v[92:95], v[244:247], v[184:187], v[92:95]
buffer_load_dwordx4 v[228:231], v255, s[12:15], s37 offen offset:0 sc1
v_mfma_f32_16x16x32_bf16 v[96:99], v[248:251], v[184:187], v[96:99]
ds_read_b128 v[184:187], v254 offset:29504
s_waitcnt lgkmcnt(3)
v_mfma_f32_16x16x32_bf16 v[100:103], v[240:243], v[188:191], v[100:103]
v_mfma_f32_16x16x32_bf16 v[104:107], v[244:247], v[188:191], v[104:107]
buffer_load_dwordx4 v[232:235], v255, s[12:15], s37 offen offset:1024 sc1
v_mfma_f32_16x16x32_bf16 v[108:111], v[248:251], v[188:191], v[108:111]
ds_read_b128 v[188:191], v254 offset:30528
v_mfma_f32_16x16x32_bf16 v[112:115], v[240:243], v[172:175], v[112:115]
buffer_load_dwordx4 v[236:239], v255, s[12:15], s37 offen offset:2048 sc1
v_mfma_f32_16x16x32_bf16 v[116:119], v[244:247], v[172:175], v[116:119]
v_mfma_f32_16x16x32_bf16 v[120:123], v[248:251], v[172:175], v[120:123]
ds_read_b128 v[172:175], v252 offset:32512
s_waitcnt lgkmcnt(3)
v_mfma_f32_16x16x32_bf16 v[124:127], v[240:243], v[176:179], v[124:127]
v_mfma_f32_16x16x32_bf16 v[128:131], v[244:247], v[176:179], v[128:131]
v_mfma_f32_16x16x32_bf16 v[132:135], v[248:251], v[176:179], v[132:135]
ds_read_b128 v[176:179], v252 offset:33536
v_mfma_f32_16x16x32_bf16 v[136:139], v[240:243], v[180:183], v[136:139]
v_mfma_f32_16x16x32_bf16 v[140:143], v[244:247], v[180:183], v[140:143]
v_mfma_f32_16x16x32_bf16 v[144:147], v[248:251], v[180:183], v[144:147]
ds_read_b128 v[180:183], v252 offset:34560
s_waitcnt lgkmcnt(3)
v_mfma_f32_16x16x32_bf16 v[148:151], v[240:243], v[184:187], v[148:151]
v_mfma_f32_16x16x32_bf16 v[152:155], v[244:247], v[184:187], v[152:155]
v_mfma_f32_16x16x32_bf16 v[156:159], v[248:251], v[184:187], v[156:159]
ds_read_b128 v[184:187], v252 offset:35584
v_mfma_f32_16x16x32_bf16 v[160:163], v[240:243], v[188:191], v[160:163]
v_mfma_f32_16x16x32_bf16 v[164:167], v[244:247], v[188:191], v[164:167]
v_mfma_f32_16x16x32_bf16 v[168:171], v[248:251], v[188:191], v[168:171]
ds_read_b128 v[188:191], v252 offset:36608
s_waitcnt vmcnt(9)
s_waitcnt lgkmcnt(3)
v_mfma_f32_16x16x32_bf16 v[88:91], v[192:195], v[172:175], v[88:91]
s_mov_b32 s34, 417792
v_mfma_f32_16x16x32_bf16 v[92:95], v[196:199], v[172:175], v[92:95]
buffer_load_dwordx4 v[240:243], v255, s[12:15], s34 offen offset:0 sc1
v_mfma_f32_16x16x32_bf16 v[96:99], v[200:203], v[172:175], v[96:99]
ds_read_b128 v[172:175], v252 offset:37632
v_mfma_f32_16x16x32_bf16 v[100:103], v[192:195], v[176:179], v[100:103]
v_mfma_f32_16x16x32_bf16 v[104:107], v[196:199], v[176:179], v[104:107]
buffer_load_dwordx4 v[244:247], v255, s[12:15], s34 offen offset:1024 sc1
v_mfma_f32_16x16x32_bf16 v[108:111], v[200:203], v[176:179], v[108:111]
ds_read_b128 v[176:179], v252 offset:38656
s_waitcnt lgkmcnt(3)
v_mfma_f32_16x16x32_bf16 v[112:115], v[192:195], v[180:183], v[112:115]
buffer_load_dwordx4 v[248:251], v255, s[12:15], s34 offen offset:2048 sc1
v_mfma_f32_16x16x32_bf16 v[116:119], v[196:199], v[180:183], v[116:119]
v_mfma_f32_16x16x32_bf16 v[120:123], v[200:203], v[180:183], v[120:123]
ds_read_b128 v[180:183], v253 offset:32512
v_mfma_f32_16x16x32_bf16 v[124:127], v[192:195], v[184:187], v[124:127]
v_mfma_f32_16x16x32_bf16 v[128:131], v[196:199], v[184:187], v[128:131]
v_mfma_f32_16x16x32_bf16 v[132:135], v[200:203], v[184:187], v[132:135]
ds_read_b128 v[184:187], v253 offset:33536
s_waitcnt lgkmcnt(3)
v_mfma_f32_16x16x32_bf16 v[136:139], v[192:195], v[188:191], v[136:139]
v_mfma_f32_16x16x32_bf16 v[140:143], v[196:199], v[188:191], v[140:143]
v_mfma_f32_16x16x32_bf16 v[144:147], v[200:203], v[188:191], v[144:147]
ds_read_b128 v[188:191], v253 offset:34560
v_mfma_f32_16x16x32_bf16 v[148:151], v[192:195], v[172:175], v[148:151]
v_mfma_f32_16x16x32_bf16 v[152:155], v[196:199], v[172:175], v[152:155]
v_mfma_f32_16x16x32_bf16 v[156:159], v[200:203], v[172:175], v[156:159]
ds_read_b128 v[172:175], v253 offset:35584
s_waitcnt lgkmcnt(3)
v_mfma_f32_16x16x32_bf16 v[160:163], v[192:195], v[176:179], v[160:163]
v_mfma_f32_16x16x32_bf16 v[164:167], v[196:199], v[176:179], v[164:167]
v_mfma_f32_16x16x32_bf16 v[168:171], v[200:203], v[176:179], v[168:171]
ds_read_b128 v[176:179], v253 offset:36608
s_waitcnt vmcnt(9)
v_mfma_f32_16x16x32_bf16 v[88:91], v[204:207], v[180:183], v[88:91]
s_mov_b32 s37, 430080
v_mfma_f32_16x16x32_bf16 v[92:95], v[208:211], v[180:183], v[92:95]
buffer_load_dwordx4 v[192:195], v255, s[12:15], s37 offen offset:0 sc1
v_mfma_f32_16x16x32_bf16 v[96:99], v[212:215], v[180:183], v[96:99]
ds_read_b128 v[180:183], v253 offset:37632
s_waitcnt lgkmcnt(3)
v_mfma_f32_16x16x32_bf16 v[100:103], v[204:207], v[184:187], v[100:103]
v_mfma_f32_16x16x32_bf16 v[104:107], v[208:211], v[184:187], v[104:107]
buffer_load_dwordx4 v[196:199], v255, s[12:15], s37 offen offset:1024 sc1
v_mfma_f32_16x16x32_bf16 v[108:111], v[212:215], v[184:187], v[108:111]
ds_read_b128 v[184:187], v253 offset:38656
v_mfma_f32_16x16x32_bf16 v[112:115], v[204:207], v[188:191], v[112:115]
buffer_load_dwordx4 v[200:203], v255, s[12:15], s37 offen offset:2048 sc1
v_mfma_f32_16x16x32_bf16 v[116:119], v[208:211], v[188:191], v[116:119]
v_mfma_f32_16x16x32_bf16 v[120:123], v[212:215], v[188:191], v[120:123]
ds_read_b128 v[188:191], v254 offset:32512
s_waitcnt lgkmcnt(3)
v_mfma_f32_16x16x32_bf16 v[124:127], v[204:207], v[172:175], v[124:127]
v_mfma_f32_16x16x32_bf16 v[128:131], v[208:211], v[172:175], v[128:131]
v_mfma_f32_16x16x32_bf16 v[132:135], v[212:215], v[172:175], v[132:135]
ds_read_b128 v[172:175], v254 offset:33536
v_mfma_f32_16x16x32_bf16 v[136:139], v[204:207], v[176:179], v[136:139]
v_mfma_f32_16x16x32_bf16 v[140:143], v[208:211], v[176:179], v[140:143]
v_mfma_f32_16x16x32_bf16 v[144:147], v[212:215], v[176:179], v[144:147]
ds_read_b128 v[176:179], v254 offset:34560
s_waitcnt lgkmcnt(3)
v_mfma_f32_16x16x32_bf16 v[148:151], v[204:207], v[180:183], v[148:151]
v_mfma_f32_16x16x32_bf16 v[152:155], v[208:211], v[180:183], v[152:155]
v_mfma_f32_16x16x32_bf16 v[156:159], v[212:215], v[180:183], v[156:159]
ds_read_b128 v[180:183], v254 offset:35584
v_mfma_f32_16x16x32_bf16 v[160:163], v[204:207], v[184:187], v[160:163]
v_mfma_f32_16x16x32_bf16 v[164:167], v[208:211], v[184:187], v[164:167]
v_mfma_f32_16x16x32_bf16 v[168:171], v[212:215], v[184:187], v[168:171]
ds_read_b128 v[184:187], v254 offset:36608
s_waitcnt vmcnt(9)
s_waitcnt lgkmcnt(3)
v_mfma_f32_16x16x32_bf16 v[88:91], v[216:219], v[188:191], v[88:91]
s_mov_b32 s34, 442368
v_mfma_f32_16x16x32_bf16 v[92:95], v[220:223], v[188:191], v[92:95]
buffer_load_dwordx4 v[204:207], v255, s[12:15], s34 offen offset:0 sc1
v_mfma_f32_16x16x32_bf16 v[96:99], v[224:227], v[188:191], v[96:99]
ds_read_b128 v[188:191], v254 offset:37632
v_mfma_f32_16x16x32_bf16 v[100:103], v[216:219], v[172:175], v[100:103]
v_mfma_f32_16x16x32_bf16 v[104:107], v[220:223], v[172:175], v[104:107]
buffer_load_dwordx4 v[208:211], v255, s[12:15], s34 offen offset:1024 sc1
v_mfma_f32_16x16x32_bf16 v[108:111], v[224:227], v[172:175], v[108:111]
ds_read_b128 v[172:175], v254 offset:38656
s_waitcnt lgkmcnt(3)
v_mfma_f32_16x16x32_bf16 v[112:115], v[216:219], v[176:179], v[112:115]
buffer_load_dwordx4 v[212:215], v255, s[12:15], s34 offen offset:2048 sc1
v_mfma_f32_16x16x32_bf16 v[116:119], v[220:223], v[176:179], v[116:119]
v_mfma_f32_16x16x32_bf16 v[120:123], v[224:227], v[176:179], v[120:123]
ds_read_b128 v[176:179], v252 offset:40640
v_mfma_f32_16x16x32_bf16 v[124:127], v[216:219], v[180:183], v[124:127]
v_mfma_f32_16x16x32_bf16 v[128:131], v[220:223], v[180:183], v[128:131]
v_mfma_f32_16x16x32_bf16 v[132:135], v[224:227], v[180:183], v[132:135]
ds_read_b128 v[180:183], v252 offset:41664
s_waitcnt lgkmcnt(3)
v_mfma_f32_16x16x32_bf16 v[136:139], v[216:219], v[184:187], v[136:139]
v_mfma_f32_16x16x32_bf16 v[140:143], v[220:223], v[184:187], v[140:143]
v_mfma_f32_16x16x32_bf16 v[144:147], v[224:227], v[184:187], v[144:147]
ds_read_b128 v[184:187], v252 offset:42688
v_mfma_f32_16x16x32_bf16 v[148:151], v[216:219], v[188:191], v[148:151]
v_mfma_f32_16x16x32_bf16 v[152:155], v[220:223], v[188:191], v[152:155]
v_mfma_f32_16x16x32_bf16 v[156:159], v[224:227], v[188:191], v[156:159]
ds_read_b128 v[188:191], v252 offset:43712
s_waitcnt lgkmcnt(3)
v_mfma_f32_16x16x32_bf16 v[160:163], v[216:219], v[172:175], v[160:163]
v_mfma_f32_16x16x32_bf16 v[164:167], v[220:223], v[172:175], v[164:167]
v_mfma_f32_16x16x32_bf16 v[168:171], v[224:227], v[172:175], v[168:171]
ds_read_b128 v[172:175], v252 offset:44736
s_waitcnt vmcnt(9)
v_mfma_f32_16x16x32_bf16 v[88:91], v[228:231], v[176:179], v[88:91]
s_mov_b32 s37, 454656
v_mfma_f32_16x16x32_bf16 v[92:95], v[232:235], v[176:179], v[92:95]
buffer_load_dwordx4 v[216:219], v255, s[12:15], s37 offen offset:0 sc1
v_mfma_f32_16x16x32_bf16 v[96:99], v[236:239], v[176:179], v[96:99]
ds_read_b128 v[176:179], v252 offset:45760
s_waitcnt lgkmcnt(3)
v_mfma_f32_16x16x32_bf16 v[100:103], v[228:231], v[180:183], v[100:103]
v_mfma_f32_16x16x32_bf16 v[104:107], v[232:235], v[180:183], v[104:107]
buffer_load_dwordx4 v[220:223], v255, s[12:15], s37 offen offset:1024 sc1
v_mfma_f32_16x16x32_bf16 v[108:111], v[236:239], v[180:183], v[108:111]
ds_read_b128 v[180:183], v252 offset:46784
v_mfma_f32_16x16x32_bf16 v[112:115], v[228:231], v[184:187], v[112:115]
buffer_load_dwordx4 v[224:227], v255, s[12:15], s37 offen offset:2048 sc1
v_mfma_f32_16x16x32_bf16 v[116:119], v[232:235], v[184:187], v[116:119]
v_mfma_f32_16x16x32_bf16 v[120:123], v[236:239], v[184:187], v[120:123]
ds_read_b128 v[184:187], v253 offset:40640
s_waitcnt lgkmcnt(3)
v_mfma_f32_16x16x32_bf16 v[124:127], v[228:231], v[188:191], v[124:127]
v_mfma_f32_16x16x32_bf16 v[128:131], v[232:235], v[188:191], v[128:131]
v_mfma_f32_16x16x32_bf16 v[132:135], v[236:239], v[188:191], v[132:135]
ds_read_b128 v[188:191], v253 offset:41664
v_mfma_f32_16x16x32_bf16 v[136:139], v[228:231], v[172:175], v[136:139]
v_mfma_f32_16x16x32_bf16 v[140:143], v[232:235], v[172:175], v[140:143]
v_mfma_f32_16x16x32_bf16 v[144:147], v[236:239], v[172:175], v[144:147]
ds_read_b128 v[172:175], v253 offset:42688
s_waitcnt lgkmcnt(3)
v_mfma_f32_16x16x32_bf16 v[148:151], v[228:231], v[176:179], v[148:151]
v_mfma_f32_16x16x32_bf16 v[152:155], v[232:235], v[176:179], v[152:155]
v_mfma_f32_16x16x32_bf16 v[156:159], v[236:239], v[176:179], v[156:159]
ds_read_b128 v[176:179], v253 offset:43712
v_mfma_f32_16x16x32_bf16 v[160:163], v[228:231], v[180:183], v[160:163]
v_mfma_f32_16x16x32_bf16 v[164:167], v[232:235], v[180:183], v[164:167]
v_mfma_f32_16x16x32_bf16 v[168:171], v[236:239], v[180:183], v[168:171]
ds_read_b128 v[180:183], v253 offset:44736
s_waitcnt vmcnt(9)
s_waitcnt lgkmcnt(3)
v_mfma_f32_16x16x32_bf16 v[88:91], v[240:243], v[184:187], v[88:91]
s_mov_b32 s34, 466944
v_mfma_f32_16x16x32_bf16 v[92:95], v[244:247], v[184:187], v[92:95]
buffer_load_dwordx4 v[228:231], v255, s[12:15], s34 offen offset:0 sc1
v_mfma_f32_16x16x32_bf16 v[96:99], v[248:251], v[184:187], v[96:99]
ds_read_b128 v[184:187], v253 offset:45760
v_mfma_f32_16x16x32_bf16 v[100:103], v[240:243], v[188:191], v[100:103]
v_mfma_f32_16x16x32_bf16 v[104:107], v[244:247], v[188:191], v[104:107]
buffer_load_dwordx4 v[232:235], v255, s[12:15], s34 offen offset:1024 sc1
v_mfma_f32_16x16x32_bf16 v[108:111], v[248:251], v[188:191], v[108:111]
ds_read_b128 v[188:191], v253 offset:46784
s_waitcnt lgkmcnt(3)
v_mfma_f32_16x16x32_bf16 v[112:115], v[240:243], v[172:175], v[112:115]
buffer_load_dwordx4 v[236:239], v255, s[12:15], s34 offen offset:2048 sc1
v_mfma_f32_16x16x32_bf16 v[116:119], v[244:247], v[172:175], v[116:119]
v_mfma_f32_16x16x32_bf16 v[120:123], v[248:251], v[172:175], v[120:123]
ds_read_b128 v[172:175], v254 offset:40640
v_mfma_f32_16x16x32_bf16 v[124:127], v[240:243], v[176:179], v[124:127]
v_mfma_f32_16x16x32_bf16 v[128:131], v[244:247], v[176:179], v[128:131]
v_mfma_f32_16x16x32_bf16 v[132:135], v[248:251], v[176:179], v[132:135]
ds_read_b128 v[176:179], v254 offset:41664
s_waitcnt lgkmcnt(3)
v_mfma_f32_16x16x32_bf16 v[136:139], v[240:243], v[180:183], v[136:139]
v_mfma_f32_16x16x32_bf16 v[140:143], v[244:247], v[180:183], v[140:143]
v_mfma_f32_16x16x32_bf16 v[144:147], v[248:251], v[180:183], v[144:147]
ds_read_b128 v[180:183], v254 offset:42688
v_mfma_f32_16x16x32_bf16 v[148:151], v[240:243], v[184:187], v[148:151]
v_mfma_f32_16x16x32_bf16 v[152:155], v[244:247], v[184:187], v[152:155]
v_mfma_f32_16x16x32_bf16 v[156:159], v[248:251], v[184:187], v[156:159]
ds_read_b128 v[184:187], v254 offset:43712
s_waitcnt lgkmcnt(3)
v_mfma_f32_16x16x32_bf16 v[160:163], v[240:243], v[188:191], v[160:163]
v_mfma_f32_16x16x32_bf16 v[164:167], v[244:247], v[188:191], v[164:167]
v_mfma_f32_16x16x32_bf16 v[168:171], v[248:251], v[188:191], v[168:171]
ds_read_b128 v[188:191], v254 offset:44736
s_waitcnt vmcnt(9)
v_mfma_f32_16x16x32_bf16 v[88:91], v[192:195], v[172:175], v[88:91]
s_mov_b32 s37, 479232
v_mfma_f32_16x16x32_bf16 v[92:95], v[196:199], v[172:175], v[92:95]
buffer_load_dwordx4 v[240:243], v255, s[12:15], s37 offen offset:0 sc1
v_mfma_f32_16x16x32_bf16 v[96:99], v[200:203], v[172:175], v[96:99]
ds_read_b128 v[172:175], v254 offset:45760
s_waitcnt lgkmcnt(3)
v_mfma_f32_16x16x32_bf16 v[100:103], v[192:195], v[176:179], v[100:103]
v_mfma_f32_16x16x32_bf16 v[104:107], v[196:199], v[176:179], v[104:107]
buffer_load_dwordx4 v[244:247], v255, s[12:15], s37 offen offset:1024 sc1
v_mfma_f32_16x16x32_bf16 v[108:111], v[200:203], v[176:179], v[108:111]
ds_read_b128 v[176:179], v254 offset:46784
s_barrier
v_mfma_f32_16x16x32_bf16 v[112:115], v[192:195], v[180:183], v[112:115]
buffer_load_dwordx4 v[248:251], v255, s[12:15], s37 offen offset:2048 sc1
v_mfma_f32_16x16x32_bf16 v[116:119], v[196:199], v[180:183], v[116:119]
v_subrev_u32 v252, 48768, v252
v_mfma_f32_16x16x32_bf16 v[120:123], v[200:203], v[180:183], v[120:123]
ds_read_b128 v[180:183], v252 offset:0
s_waitcnt lgkmcnt(3)
v_mfma_f32_16x16x32_bf16 v[124:127], v[192:195], v[184:187], v[124:127]
v_fma_f32 v4, v88, 2.0, v4
v_mfma_f32_16x16x32_bf16 v[128:131], v[196:199], v[184:187], v[128:131]
v_subrev_u32 v253, 48768, v253
v_mfma_f32_16x16x32_bf16 v[132:135], v[200:203], v[184:187], v[132:135]
ds_read_b128 v[184:187], v253 offset:0
v_fma_f32 v16, v100, 2.0, v16
v_mfma_f32_16x16x32_bf16 v[136:139], v[192:195], v[188:191], v[136:139]
v_fma_f32 v5, v89, 2.0, v5
v_fma_f32 v17, v101, 2.0, v17
v_mfma_f32_16x16x32_bf16 v[140:143], v[196:199], v[188:191], v[140:143]
v_fma_f32 v6, v90, 2.0, v6
v_fma_f32 v18, v102, 2.0, v18
v_mfma_f32_16x16x32_bf16 v[144:147], v[200:203], v[188:191], v[144:147]
ds_read_b128 v[188:191], v252 offset:1024
v_fma_f32 v19, v103, 2.0, v19
s_waitcnt lgkmcnt(3)
v_mfma_f32_16x16x32_bf16 v[148:151], v[192:195], v[172:175], v[148:151]
v_fma_f32 v7, v91, 2.0, v7
v_fma_f32 v28, v112, 2.0, v28
v_mfma_f32_16x16x32_bf16 v[152:155], v[196:199], v[172:175], v[152:155]
v_fma_f32 v8, v92, 2.0, v8
v_fma_f32 v20, v104, 2.0, v20
v_mfma_f32_16x16x32_bf16 v[156:159], v[200:203], v[172:175], v[156:159]
ds_read_b128 v[172:175], v253 offset:1024
v_fma_f32 v29, v113, 2.0, v29
v_fma_f32 v40, v124, 2.0, v40
v_mfma_f32_16x16x32_bf16 v[160:163], v[192:195], v[176:179], v[160:163]
v_fma_f32 v9, v93, 2.0, v9
v_fma_f32 v30, v114, 2.0, v30
v_fma_f32 v41, v125, 2.0, v41
v_mfma_f32_16x16x32_bf16 v[164:167], v[196:199], v[176:179], v[164:167]
v_fma_f32 v10, v94, 2.0, v10
v_fma_f32 v11, v95, 2.0, v11
v_mfma_f32_16x16x32_bf16 v[168:171], v[200:203], v[176:179], v[168:171]
ds_read_b128 v[176:179], v252 offset:2048
v_fma_f32 v12, v96, 2.0, v12
v_fma_f32 v13, v97, 2.0, v13
v_fma_f32 v14, v98, 2.0, v14
v_fma_f32 v15, v99, 2.0, v15
s_waitcnt vmcnt(9)
s_waitcnt lgkmcnt(3)
v_mfma_f32_16x16x32_bf16 v[88:91], v[204:207], v[180:183], v[88:91]
s_mov_b32 s34, 491520
v_fma_f32 v31, v115, 2.0, v31
v_fma_f32 v52, v136, 2.0, v52
v_mfma_f32_16x16x32_bf16 v[92:95], v[208:211], v[180:183], v[92:95]
buffer_load_dwordx4 v[192:195], v255, s[12:15], s34 offen offset:0 sc1
v_fma_f32 v42, v126, 2.0, v42
v_fma_f32 v53, v137, 2.0, v53
v_mfma_f32_16x16x32_bf16 v[96:99], v[212:215], v[180:183], v[96:99]
ds_read_b128 v[180:183], v253 offset:2048
v_fma_f32 v43, v127, 2.0, v43
v_fma_f32 v64, v148, 2.0, v64
s_waitcnt vmcnt(7)
v_mfma_f32_16x16x32_bf16 v[88:91], v[216:219], v[184:187], v[88:91]
v_fma_f32 v21, v105, 2.0, v21
v_fma_f32 v22, v106, 2.0, v22
v_fma_f32 v54, v138, 2.0, v54
v_mfma_f32_16x16x32_bf16 v[92:95], v[220:223], v[184:187], v[92:95]
buffer_load_dwordx4 v[196:199], v255, s[12:15], s34 offen offset:1024 sc1
v_fma_f32 v23, v107, 2.0, v23
v_fma_f32 v65, v149, 2.0, v65
v_mfma_f32_16x16x32_bf16 v[96:99], v[224:227], v[184:187], v[96:99]
ds_read_b128 v[184:187], v252 offset:3072
v_fma_f32 v24, v108, 2.0, v24
v_fma_f32 v25, v109, 2.0, v25
v_fma_f32 v26, v110, 2.0, v26
v_fma_f32 v27, v111, 2.0, v27
s_waitcnt lgkmcnt(3)
v_mfma_f32_16x16x32_bf16 v[100:103], v[204:207], v[188:191], v[100:103]
buffer_load_dwordx4 v[200:203], v255, s[12:15], s34 offen offset:2048 sc1
v_fma_f32 v44, v128, 2.0, v44
v_fma_f32 v66, v150, 2.0, v66
v_mfma_f32_16x16x32_bf16 v[104:107], v[208:211], v[188:191], v[104:107]
v_fma_f32 v32, v116, 2.0, v32
v_fma_f32 v55, v139, 2.0, v55
v_fma_f32 v76, v160, 2.0, v76
v_mfma_f32_16x16x32_bf16 v[108:111], v[212:215], v[188:191], v[108:111]
ds_read_b128 v[188:191], v253 offset:3072
v_fma_f32 v56, v140, 2.0, v56
v_fma_f32 v67, v151, 2.0, v67
v_mfma_f32_16x16x32_bf16 v[100:103], v[216:219], v[172:175], v[100:103]
v_fma_f32 v33, v117, 2.0, v33
v_fma_f32 v57, v141, 2.0, v57
v_fma_f32 v77, v161, 2.0, v77
v_mfma_f32_16x16x32_bf16 v[104:107], v[220:223], v[172:175], v[104:107]
v_fma_f32 v34, v118, 2.0, v34
v_fma_f32 v35, v119, 2.0, v35
v_fma_f32 v78, v162, 2.0, v78
v_mfma_f32_16x16x32_bf16 v[108:111], v[224:227], v[172:175], v[108:111]
ds_read_b128 v[172:175], v252 offset:4096
v_fma_f32 v36, v120, 2.0, v36
v_fma_f32 v37, v121, 2.0, v37
v_fma_f32 v38, v122, 2.0, v38
v_fma_f32 v39, v123, 2.0, v39
s_waitcnt lgkmcnt(3)
v_mfma_f32_16x16x32_bf16 v[112:115], v[204:207], v[176:179], v[112:115]
v_fma_f32 v45, v129, 2.0, v45
v_fma_f32 v58, v142, 2.0, v58
v_fma_f32 v79, v163, 2.0, v79
v_mfma_f32_16x16x32_bf16 v[116:119], v[208:211], v[176:179], v[116:119]
v_fma_f32 v46, v130, 2.0, v46
v_fma_f32 v68, v152, 2.0, v68
v_mfma_f32_16x16x32_bf16 v[120:123], v[212:215], v[176:179], v[120:123]
ds_read_b128 v[176:179], v253 offset:4096
v_fma_f32 v69, v153, 2.0, v69
v_mfma_f32_16x16x32_bf16 v[112:115], v[216:219], v[180:183], v[112:115]
v_fma_f32 v47, v131, 2.0, v47
v_fma_f32 v70, v154, 2.0, v70
v_fma_f32 v80, v164, 2.0, v80
v_mfma_f32_16x16x32_bf16 v[116:119], v[220:223], v[180:183], v[116:119]
v_fma_f32 v48, v132, 2.0, v48
v_fma_f32 v49, v133, 2.0, v49
v_mfma_f32_16x16x32_bf16 v[120:123], v[224:227], v[180:183], v[120:123]
ds_read_b128 v[180:183], v252 offset:5120
v_fma_f32 v50, v134, 2.0, v50
v_fma_f32 v51, v135, 2.0, v51
s_waitcnt lgkmcnt(3)
v_mfma_f32_16x16x32_bf16 v[124:127], v[204:207], v[184:187], v[124:127]
v_fma_f32 v59, v143, 2.0, v59
v_fma_f32 v71, v155, 2.0, v71
v_mfma_f32_16x16x32_bf16 v[128:131], v[208:211], v[184:187], v[128:131]
v_fma_f32 v60, v144, 2.0, v60
v_fma_f32 v81, v165, 2.0, v81
v_mfma_f32_16x16x32_bf16 v[132:135], v[212:215], v[184:187], v[132:135]
ds_read_b128 v[184:187], v253 offset:5120
v_fma_f32 v82, v166, 2.0, v82
v_mfma_f32_16x16x32_bf16 v[124:127], v[216:219], v[188:191], v[124:127]
v_fma_f32 v61, v145, 2.0, v61
v_fma_f32 v83, v167, 2.0, v83
v_mfma_f32_16x16x32_bf16 v[128:131], v[220:223], v[188:191], v[128:131]
v_fma_f32 v62, v146, 2.0, v62
v_fma_f32 v63, v147, 2.0, v63
v_mfma_f32_16x16x32_bf16 v[132:135], v[224:227], v[188:191], v[132:135]
ds_read_b128 v[188:191], v252 offset:6144
s_waitcnt lgkmcnt(3)
v_mfma_f32_16x16x32_bf16 v[136:139], v[204:207], v[172:175], v[136:139]
v_fma_f32 v72, v156, 2.0, v72
v_mfma_f32_16x16x32_bf16 v[140:143], v[208:211], v[172:175], v[140:143]
v_fma_f32 v73, v157, 2.0, v73
v_fma_f32 v84, v168, 2.0, v84
v_mfma_f32_16x16x32_bf16 v[144:147], v[212:215], v[172:175], v[144:147]
ds_read_b128 v[172:175], v253 offset:6144
v_mfma_f32_16x16x32_bf16 v[136:139], v[216:219], v[176:179], v[136:139]
v_fma_f32 v74, v158, 2.0, v74
v_fma_f32 v75, v159, 2.0, v75
v_mfma_f32_16x16x32_bf16 v[140:143], v[220:223], v[176:179], v[140:143]
v_subrev_u32 v254, 48768, v254
v_mfma_f32_16x16x32_bf16 v[144:147], v[224:227], v[176:179], v[144:147]
ds_read_b128 v[176:179], v254 offset:0
s_waitcnt lgkmcnt(3)
v_mfma_f32_16x16x32_bf16 v[148:151], v[204:207], v[180:183], v[148:151]
v_fma_f32 v85, v169, 2.0, v85
v_mfma_f32_16x16x32_bf16 v[152:155], v[208:211], v[180:183], v[152:155]
v_fma_f32 v86, v170, 2.0, v86
v_mfma_f32_16x16x32_bf16 v[156:159], v[212:215], v[180:183], v[156:159]
ds_read_b128 v[180:183], v254 offset:1024
v_mfma_f32_16x16x32_bf16 v[148:151], v[216:219], v[184:187], v[148:151]
v_fma_f32 v87, v171, 2.0, v87
v_mfma_f32_16x16x32_bf16 v[152:155], v[220:223], v[184:187], v[152:155]
v_mfma_f32_16x16x32_bf16 v[156:159], v[224:227], v[184:187], v[156:159]
ds_read_b128 v[184:187], v254 offset:2048
s_waitcnt lgkmcnt(3)
v_mfma_f32_16x16x32_bf16 v[160:163], v[204:207], v[188:191], v[160:163]
v_mfma_f32_16x16x32_bf16 v[164:167], v[208:211], v[188:191], v[164:167]
v_mfma_f32_16x16x32_bf16 v[168:171], v[212:215], v[188:191], v[168:171]
ds_read_b128 v[188:191], v254 offset:3072
v_mfma_f32_16x16x32_bf16 v[160:163], v[216:219], v[172:175], v[160:163]
s_mov_b32 s37, 503808
v_mfma_f32_16x16x32_bf16 v[164:167], v[220:223], v[172:175], v[164:167]
buffer_load_dwordx4 v[204:207], v255, s[12:15], s37 offen offset:0 sc1
v_mfma_f32_16x16x32_bf16 v[168:171], v[224:227], v[172:175], v[168:171]
ds_read_b128 v[172:175], v254 offset:4096
s_waitcnt vmcnt(7)
s_waitcnt lgkmcnt(3)
v_mfma_f32_16x16x32_bf16 v[88:91], v[228:231], v[176:179], v[88:91]
v_mfma_f32_16x16x32_bf16 v[92:95], v[232:235], v[176:179], v[92:95]
buffer_load_dwordx4 v[208:211], v255, s[12:15], s37 offen offset:1024 sc1
v_mfma_f32_16x16x32_bf16 v[96:99], v[236:239], v[176:179], v[96:99]
ds_read_b128 v[176:179], v254 offset:5120
v_mfma_f32_16x16x32_bf16 v[100:103], v[228:231], v[180:183], v[100:103]
buffer_load_dwordx4 v[212:215], v255, s[12:15], s37 offen offset:2048 sc1
v_mfma_f32_16x16x32_bf16 v[104:107], v[232:235], v[180:183], v[104:107]
v_mfma_f32_16x16x32_bf16 v[108:111], v[236:239], v[180:183], v[108:111]
ds_read_b128 v[180:183], v254 offset:6144
s_waitcnt lgkmcnt(3)
v_mfma_f32_16x16x32_bf16 v[112:115], v[228:231], v[184:187], v[112:115]
v_mfma_f32_16x16x32_bf16 v[116:119], v[232:235], v[184:187], v[116:119]
s_mov_b32 s34, 516096
v_mfma_f32_16x16x32_bf16 v[120:123], v[236:239], v[184:187], v[120:123]
ds_read_b128 v[184:187], v252 offset:8128
v_mfma_f32_16x16x32_bf16 v[124:127], v[228:231], v[188:191], v[124:127]
buffer_load_dwordx4 v[216:219], v255, s[12:15], s34 offen offset:0 sc1
v_mfma_f32_16x16x32_bf16 v[128:131], v[232:235], v[188:191], v[128:131]
buffer_load_dwordx4 v[220:223], v255, s[12:15], s34 offen offset:1024 sc1
v_mfma_f32_16x16x32_bf16 v[132:135], v[236:239], v[188:191], v[132:135]
ds_read_b128 v[188:191], v252 offset:9152
s_waitcnt lgkmcnt(3)
v_mfma_f32_16x16x32_bf16 v[136:139], v[228:231], v[172:175], v[136:139]
v_mfma_f32_16x16x32_bf16 v[140:143], v[232:235], v[172:175], v[140:143]
buffer_load_dwordx4 v[224:227], v255, s[12:15], s34 offen offset:2048 sc1
v_mfma_f32_16x16x32_bf16 v[144:147], v[236:239], v[172:175], v[144:147]
ds_read_b128 v[172:175], v252 offset:10176
v_mfma_f32_16x16x32_bf16 v[148:151], v[228:231], v[176:179], v[148:151]
v_mfma_f32_16x16x32_bf16 v[152:155], v[232:235], v[176:179], v[152:155]
v_mfma_f32_16x16x32_bf16 v[156:159], v[236:239], v[176:179], v[156:159]
ds_read_b128 v[176:179], v252 offset:11200
s_waitcnt lgkmcnt(3)
v_mfma_f32_16x16x32_bf16 v[160:163], v[228:231], v[180:183], v[160:163]
v_mfma_f32_16x16x32_bf16 v[164:167], v[232:235], v[180:183], v[164:167]
v_mfma_f32_16x16x32_bf16 v[168:171], v[236:239], v[180:183], v[168:171]
ds_read_b128 v[180:183], v252 offset:12224
s_waitcnt vmcnt(9)
v_mfma_f32_16x16x32_bf16 v[88:91], v[240:243], v[184:187], v[88:91]
s_mov_b32 s37, 528384
v_mfma_f32_16x16x32_bf16 v[92:95], v[244:247], v[184:187], v[92:95]
buffer_load_dwordx4 v[228:231], v255, s[12:15], s37 offen offset:0 sc1
v_mfma_f32_16x16x32_bf16 v[96:99], v[248:251], v[184:187], v[96:99]
ds_read_b128 v[184:187], v252 offset:13248
s_waitcnt lgkmcnt(3)
v_mfma_f32_16x16x32_bf16 v[100:103], v[240:243], v[188:191], v[100:103]
v_mfma_f32_16x16x32_bf16 v[104:107], v[244:247], v[188:191], v[104:107]
buffer_load_dwordx4 v[232:235], v255, s[12:15], s37 offen offset:1024 sc1
v_mfma_f32_16x16x32_bf16 v[108:111], v[248:251], v[188:191], v[108:111]
ds_read_b128 v[188:191], v252 offset:14272
v_mfma_f32_16x16x32_bf16 v[112:115], v[240:243], v[172:175], v[112:115]
buffer_load_dwordx4 v[236:239], v255, s[12:15], s37 offen offset:2048 sc1
v_mfma_f32_16x16x32_bf16 v[116:119], v[244:247], v[172:175], v[116:119]
v_mfma_f32_16x16x32_bf16 v[120:123], v[248:251], v[172:175], v[120:123]
ds_read_b128 v[172:175], v253 offset:8128
s_waitcnt lgkmcnt(3)
v_mfma_f32_16x16x32_bf16 v[124:127], v[240:243], v[176:179], v[124:127]
v_mfma_f32_16x16x32_bf16 v[128:131], v[244:247], v[176:179], v[128:131]
v_mfma_f32_16x16x32_bf16 v[132:135], v[248:251], v[176:179], v[132:135]
ds_read_b128 v[176:179], v253 offset:9152
v_mfma_f32_16x16x32_bf16 v[136:139], v[240:243], v[180:183], v[136:139]
v_mfma_f32_16x16x32_bf16 v[140:143], v[244:247], v[180:183], v[140:143]
v_mfma_f32_16x16x32_bf16 v[144:147], v[248:251], v[180:183], v[144:147]
ds_read_b128 v[180:183], v253 offset:10176
s_waitcnt lgkmcnt(3)
v_mfma_f32_16x16x32_bf16 v[148:151], v[240:243], v[184:187], v[148:151]
v_mfma_f32_16x16x32_bf16 v[152:155], v[244:247], v[184:187], v[152:155]
v_mfma_f32_16x16x32_bf16 v[156:159], v[248:251], v[184:187], v[156:159]
ds_read_b128 v[184:187], v253 offset:11200
v_mfma_f32_16x16x32_bf16 v[160:163], v[240:243], v[188:191], v[160:163]
v_mfma_f32_16x16x32_bf16 v[164:167], v[244:247], v[188:191], v[164:167]
v_mfma_f32_16x16x32_bf16 v[168:171], v[248:251], v[188:191], v[168:171]
ds_read_b128 v[188:191], v253 offset:12224
s_waitcnt vmcnt(9)
s_waitcnt lgkmcnt(3)
v_mfma_f32_16x16x32_bf16 v[88:91], v[192:195], v[172:175], v[88:91]
s_mov_b32 s34, 540672
v_mfma_f32_16x16x32_bf16 v[92:95], v[196:199], v[172:175], v[92:95]
buffer_load_dwordx4 v[240:243], v255, s[12:15], s34 offen offset:0 sc1
v_mfma_f32_16x16x32_bf16 v[96:99], v[200:203], v[172:175], v[96:99]
ds_read_b128 v[172:175], v253 offset:13248
v_mfma_f32_16x16x32_bf16 v[100:103], v[192:195], v[176:179], v[100:103]
v_mfma_f32_16x16x32_bf16 v[104:107], v[196:199], v[176:179], v[104:107]
buffer_load_dwordx4 v[244:247], v255, s[12:15], s34 offen offset:1024 sc1
v_mfma_f32_16x16x32_bf16 v[108:111], v[200:203], v[176:179], v[108:111]
ds_read_b128 v[176:179], v253 offset:14272
s_waitcnt lgkmcnt(3)
v_mfma_f32_16x16x32_bf16 v[112:115], v[192:195], v[180:183], v[112:115]
buffer_load_dwordx4 v[248:251], v255, s[12:15], s34 offen offset:2048 sc1
v_mfma_f32_16x16x32_bf16 v[116:119], v[196:199], v[180:183], v[116:119]
v_mfma_f32_16x16x32_bf16 v[120:123], v[200:203], v[180:183], v[120:123]
ds_read_b128 v[180:183], v254 offset:8128
v_mfma_f32_16x16x32_bf16 v[124:127], v[192:195], v[184:187], v[124:127]
v_mfma_f32_16x16x32_bf16 v[128:131], v[196:199], v[184:187], v[128:131]
v_mfma_f32_16x16x32_bf16 v[132:135], v[200:203], v[184:187], v[132:135]
ds_read_b128 v[184:187], v254 offset:9152
s_waitcnt lgkmcnt(3)
v_mfma_f32_16x16x32_bf16 v[136:139], v[192:195], v[188:191], v[136:139]
v_mfma_f32_16x16x32_bf16 v[140:143], v[196:199], v[188:191], v[140:143]
v_mfma_f32_16x16x32_bf16 v[144:147], v[200:203], v[188:191], v[144:147]
ds_read_b128 v[188:191], v254 offset:10176
v_mfma_f32_16x16x32_bf16 v[148:151], v[192:195], v[172:175], v[148:151]
v_mfma_f32_16x16x32_bf16 v[152:155], v[196:199], v[172:175], v[152:155]
v_mfma_f32_16x16x32_bf16 v[156:159], v[200:203], v[172:175], v[156:159]
ds_read_b128 v[172:175], v254 offset:11200
s_waitcnt lgkmcnt(3)
v_mfma_f32_16x16x32_bf16 v[160:163], v[192:195], v[176:179], v[160:163]
v_mfma_f32_16x16x32_bf16 v[164:167], v[196:199], v[176:179], v[164:167]
v_mfma_f32_16x16x32_bf16 v[168:171], v[200:203], v[176:179], v[168:171]
ds_read_b128 v[176:179], v254 offset:12224
s_waitcnt vmcnt(9)
v_mfma_f32_16x16x32_bf16 v[88:91], v[204:207], v[180:183], v[88:91]
s_mov_b32 s37, 552960
v_mfma_f32_16x16x32_bf16 v[92:95], v[208:211], v[180:183], v[92:95]
buffer_load_dwordx4 v[192:195], v255, s[12:15], s37 offen offset:0 sc1
v_mfma_f32_16x16x32_bf16 v[96:99], v[212:215], v[180:183], v[96:99]
ds_read_b128 v[180:183], v254 offset:13248
s_waitcnt lgkmcnt(3)
v_mfma_f32_16x16x32_bf16 v[100:103], v[204:207], v[184:187], v[100:103]
v_mfma_f32_16x16x32_bf16 v[104:107], v[208:211], v[184:187], v[104:107]
buffer_load_dwordx4 v[196:199], v255, s[12:15], s37 offen offset:1024 sc1
v_mfma_f32_16x16x32_bf16 v[108:111], v[212:215], v[184:187], v[108:111]
ds_read_b128 v[184:187], v254 offset:14272
v_mfma_f32_16x16x32_bf16 v[112:115], v[204:207], v[188:191], v[112:115]
buffer_load_dwordx4 v[200:203], v255, s[12:15], s37 offen offset:2048 sc1
v_mfma_f32_16x16x32_bf16 v[116:119], v[208:211], v[188:191], v[116:119]
v_mfma_f32_16x16x32_bf16 v[120:123], v[212:215], v[188:191], v[120:123]
ds_read_b128 v[188:191], v252 offset:16256
s_waitcnt lgkmcnt(3)
v_mfma_f32_16x16x32_bf16 v[124:127], v[204:207], v[172:175], v[124:127]
v_mfma_f32_16x16x32_bf16 v[128:131], v[208:211], v[172:175], v[128:131]
v_mfma_f32_16x16x32_bf16 v[132:135], v[212:215], v[172:175], v[132:135]
ds_read_b128 v[172:175], v252 offset:17280
v_mfma_f32_16x16x32_bf16 v[136:139], v[204:207], v[176:179], v[136:139]
v_mfma_f32_16x16x32_bf16 v[140:143], v[208:211], v[176:179], v[140:143]
v_mfma_f32_16x16x32_bf16 v[144:147], v[212:215], v[176:179], v[144:147]
ds_read_b128 v[176:179], v252 offset:18304
s_waitcnt lgkmcnt(3)
v_mfma_f32_16x16x32_bf16 v[148:151], v[204:207], v[180:183], v[148:151]
v_mfma_f32_16x16x32_bf16 v[152:155], v[208:211], v[180:183], v[152:155]
v_mfma_f32_16x16x32_bf16 v[156:159], v[212:215], v[180:183], v[156:159]
ds_read_b128 v[180:183], v252 offset:19328
v_mfma_f32_16x16x32_bf16 v[160:163], v[204:207], v[184:187], v[160:163]
v_mfma_f32_16x16x32_bf16 v[164:167], v[208:211], v[184:187], v[164:167]
v_mfma_f32_16x16x32_bf16 v[168:171], v[212:215], v[184:187], v[168:171]
ds_read_b128 v[184:187], v252 offset:20352
s_waitcnt vmcnt(9)
s_waitcnt lgkmcnt(3)
v_mfma_f32_16x16x32_bf16 v[88:91], v[216:219], v[188:191], v[88:91]
s_mov_b32 s34, 565248
v_mfma_f32_16x16x32_bf16 v[92:95], v[220:223], v[188:191], v[92:95]
buffer_load_dwordx4 v[204:207], v255, s[12:15], s34 offen offset:0 sc1
v_mfma_f32_16x16x32_bf16 v[96:99], v[224:227], v[188:191], v[96:99]
ds_read_b128 v[188:191], v252 offset:21376
v_mfma_f32_16x16x32_bf16 v[100:103], v[216:219], v[172:175], v[100:103]
v_mfma_f32_16x16x32_bf16 v[104:107], v[220:223], v[172:175], v[104:107]
buffer_load_dwordx4 v[208:211], v255, s[12:15], s34 offen offset:1024 sc1
v_mfma_f32_16x16x32_bf16 v[108:111], v[224:227], v[172:175], v[108:111]
ds_read_b128 v[172:175], v252 offset:22400
s_waitcnt lgkmcnt(3)
v_mfma_f32_16x16x32_bf16 v[112:115], v[216:219], v[176:179], v[112:115]
buffer_load_dwordx4 v[212:215], v255, s[12:15], s34 offen offset:2048 sc1
v_mfma_f32_16x16x32_bf16 v[116:119], v[220:223], v[176:179], v[116:119]
v_mfma_f32_16x16x32_bf16 v[120:123], v[224:227], v[176:179], v[120:123]
ds_read_b128 v[176:179], v253 offset:16256
v_mfma_f32_16x16x32_bf16 v[124:127], v[216:219], v[180:183], v[124:127]
v_mfma_f32_16x16x32_bf16 v[128:131], v[220:223], v[180:183], v[128:131]
v_mfma_f32_16x16x32_bf16 v[132:135], v[224:227], v[180:183], v[132:135]
ds_read_b128 v[180:183], v253 offset:17280
s_waitcnt lgkmcnt(3)
v_mfma_f32_16x16x32_bf16 v[136:139], v[216:219], v[184:187], v[136:139]
v_mfma_f32_16x16x32_bf16 v[140:143], v[220:223], v[184:187], v[140:143]
v_mfma_f32_16x16x32_bf16 v[144:147], v[224:227], v[184:187], v[144:147]
ds_read_b128 v[184:187], v253 offset:18304
v_mfma_f32_16x16x32_bf16 v[148:151], v[216:219], v[188:191], v[148:151]
v_mfma_f32_16x16x32_bf16 v[152:155], v[220:223], v[188:191], v[152:155]
v_mfma_f32_16x16x32_bf16 v[156:159], v[224:227], v[188:191], v[156:159]
ds_read_b128 v[188:191], v253 offset:19328
s_waitcnt lgkmcnt(3)
v_mfma_f32_16x16x32_bf16 v[160:163], v[216:219], v[172:175], v[160:163]
v_mfma_f32_16x16x32_bf16 v[164:167], v[220:223], v[172:175], v[164:167]
v_mfma_f32_16x16x32_bf16 v[168:171], v[224:227], v[172:175], v[168:171]
ds_read_b128 v[172:175], v253 offset:20352
s_waitcnt vmcnt(9)
v_mfma_f32_16x16x32_bf16 v[88:91], v[228:231], v[176:179], v[88:91]
s_mov_b32 s37, 577536
v_mfma_f32_16x16x32_bf16 v[92:95], v[232:235], v[176:179], v[92:95]
buffer_load_dwordx4 v[216:219], v255, s[12:15], s37 offen offset:0 sc1
v_mfma_f32_16x16x32_bf16 v[96:99], v[236:239], v[176:179], v[96:99]
ds_read_b128 v[176:179], v253 offset:21376
s_waitcnt lgkmcnt(3)
v_mfma_f32_16x16x32_bf16 v[100:103], v[228:231], v[180:183], v[100:103]
v_mfma_f32_16x16x32_bf16 v[104:107], v[232:235], v[180:183], v[104:107]
buffer_load_dwordx4 v[220:223], v255, s[12:15], s37 offen offset:1024 sc1
v_mfma_f32_16x16x32_bf16 v[108:111], v[236:239], v[180:183], v[108:111]
ds_read_b128 v[180:183], v253 offset:22400
v_mfma_f32_16x16x32_bf16 v[112:115], v[228:231], v[184:187], v[112:115]
buffer_load_dwordx4 v[224:227], v255, s[12:15], s37 offen offset:2048 sc1
v_mfma_f32_16x16x32_bf16 v[116:119], v[232:235], v[184:187], v[116:119]
v_mfma_f32_16x16x32_bf16 v[120:123], v[236:239], v[184:187], v[120:123]
ds_read_b128 v[184:187], v254 offset:16256
s_waitcnt lgkmcnt(3)
v_mfma_f32_16x16x32_bf16 v[124:127], v[228:231], v[188:191], v[124:127]
v_mfma_f32_16x16x32_bf16 v[128:131], v[232:235], v[188:191], v[128:131]
v_mfma_f32_16x16x32_bf16 v[132:135], v[236:239], v[188:191], v[132:135]
ds_read_b128 v[188:191], v254 offset:17280
v_mfma_f32_16x16x32_bf16 v[136:139], v[228:231], v[172:175], v[136:139]
v_mfma_f32_16x16x32_bf16 v[140:143], v[232:235], v[172:175], v[140:143]
v_mfma_f32_16x16x32_bf16 v[144:147], v[236:239], v[172:175], v[144:147]
ds_read_b128 v[172:175], v254 offset:18304
s_waitcnt lgkmcnt(3)
v_mfma_f32_16x16x32_bf16 v[148:151], v[228:231], v[176:179], v[148:151]
v_mfma_f32_16x16x32_bf16 v[152:155], v[232:235], v[176:179], v[152:155]
v_mfma_f32_16x16x32_bf16 v[156:159], v[236:239], v[176:179], v[156:159]
ds_read_b128 v[176:179], v254 offset:19328
v_mfma_f32_16x16x32_bf16 v[160:163], v[228:231], v[180:183], v[160:163]
v_mfma_f32_16x16x32_bf16 v[164:167], v[232:235], v[180:183], v[164:167]
v_mfma_f32_16x16x32_bf16 v[168:171], v[236:239], v[180:183], v[168:171]
ds_read_b128 v[180:183], v254 offset:20352
s_waitcnt vmcnt(9)
s_waitcnt lgkmcnt(3)
v_mfma_f32_16x16x32_bf16 v[88:91], v[240:243], v[184:187], v[88:91]
s_mov_b32 s34, 589824
v_mfma_f32_16x16x32_bf16 v[92:95], v[244:247], v[184:187], v[92:95]
buffer_load_dwordx4 v[228:231], v255, s[12:15], s34 offen offset:0 sc1
v_mfma_f32_16x16x32_bf16 v[96:99], v[248:251], v[184:187], v[96:99]
ds_read_b128 v[184:187], v254 offset:21376
v_mfma_f32_16x16x32_bf16 v[100:103], v[240:243], v[188:191], v[100:103]
v_mfma_f32_16x16x32_bf16 v[104:107], v[244:247], v[188:191], v[104:107]
buffer_load_dwordx4 v[232:235], v255, s[12:15], s34 offen offset:1024 sc1
v_mfma_f32_16x16x32_bf16 v[108:111], v[248:251], v[188:191], v[108:111]
ds_read_b128 v[188:191], v254 offset:22400
s_waitcnt lgkmcnt(3)
v_mfma_f32_16x16x32_bf16 v[112:115], v[240:243], v[172:175], v[112:115]
buffer_load_dwordx4 v[236:239], v255, s[12:15], s34 offen offset:2048 sc1
v_mfma_f32_16x16x32_bf16 v[116:119], v[244:247], v[172:175], v[116:119]
v_mfma_f32_16x16x32_bf16 v[120:123], v[248:251], v[172:175], v[120:123]
ds_read_b128 v[172:175], v252 offset:24384
v_mfma_f32_16x16x32_bf16 v[124:127], v[240:243], v[176:179], v[124:127]
v_mfma_f32_16x16x32_bf16 v[128:131], v[244:247], v[176:179], v[128:131]
v_mfma_f32_16x16x32_bf16 v[132:135], v[248:251], v[176:179], v[132:135]
ds_read_b128 v[176:179], v252 offset:25408
s_waitcnt lgkmcnt(3)
v_mfma_f32_16x16x32_bf16 v[136:139], v[240:243], v[180:183], v[136:139]
v_mfma_f32_16x16x32_bf16 v[140:143], v[244:247], v[180:183], v[140:143]
v_mfma_f32_16x16x32_bf16 v[144:147], v[248:251], v[180:183], v[144:147]
ds_read_b128 v[180:183], v252 offset:26432
v_mfma_f32_16x16x32_bf16 v[148:151], v[240:243], v[184:187], v[148:151]
v_mfma_f32_16x16x32_bf16 v[152:155], v[244:247], v[184:187], v[152:155]
v_mfma_f32_16x16x32_bf16 v[156:159], v[248:251], v[184:187], v[156:159]
ds_read_b128 v[184:187], v252 offset:27456
s_waitcnt lgkmcnt(3)
v_mfma_f32_16x16x32_bf16 v[160:163], v[240:243], v[188:191], v[160:163]
v_mfma_f32_16x16x32_bf16 v[164:167], v[244:247], v[188:191], v[164:167]
v_mfma_f32_16x16x32_bf16 v[168:171], v[248:251], v[188:191], v[168:171]
ds_read_b128 v[188:191], v252 offset:28480
s_waitcnt vmcnt(9)
v_mfma_f32_16x16x32_bf16 v[88:91], v[192:195], v[172:175], v[88:91]
s_mov_b32 s37, 602112
v_mfma_f32_16x16x32_bf16 v[92:95], v[196:199], v[172:175], v[92:95]
buffer_load_dwordx4 v[240:243], v255, s[12:15], s37 offen offset:0 sc1
v_mfma_f32_16x16x32_bf16 v[96:99], v[200:203], v[172:175], v[96:99]
ds_read_b128 v[172:175], v252 offset:29504
s_waitcnt lgkmcnt(3)
v_mfma_f32_16x16x32_bf16 v[100:103], v[192:195], v[176:179], v[100:103]
v_mfma_f32_16x16x32_bf16 v[104:107], v[196:199], v[176:179], v[104:107]
buffer_load_dwordx4 v[244:247], v255, s[12:15], s37 offen offset:1024 sc1
v_mfma_f32_16x16x32_bf16 v[108:111], v[200:203], v[176:179], v[108:111]
ds_read_b128 v[176:179], v252 offset:30528
v_mfma_f32_16x16x32_bf16 v[112:115], v[192:195], v[180:183], v[112:115]
buffer_load_dwordx4 v[248:251], v255, s[12:15], s37 offen offset:2048 sc1
v_mfma_f32_16x16x32_bf16 v[116:119], v[196:199], v[180:183], v[116:119]
v_mfma_f32_16x16x32_bf16 v[120:123], v[200:203], v[180:183], v[120:123]
ds_read_b128 v[180:183], v253 offset:24384
s_waitcnt lgkmcnt(3)
v_mfma_f32_16x16x32_bf16 v[124:127], v[192:195], v[184:187], v[124:127]
v_mfma_f32_16x16x32_bf16 v[128:131], v[196:199], v[184:187], v[128:131]
v_mfma_f32_16x16x32_bf16 v[132:135], v[200:203], v[184:187], v[132:135]
ds_read_b128 v[184:187], v253 offset:25408
v_mfma_f32_16x16x32_bf16 v[136:139], v[192:195], v[188:191], v[136:139]
v_mfma_f32_16x16x32_bf16 v[140:143], v[196:199], v[188:191], v[140:143]
v_mfma_f32_16x16x32_bf16 v[144:147], v[200:203], v[188:191], v[144:147]
ds_read_b128 v[188:191], v253 offset:26432
s_waitcnt lgkmcnt(3)
v_mfma_f32_16x16x32_bf16 v[148:151], v[192:195], v[172:175], v[148:151]
v_mfma_f32_16x16x32_bf16 v[152:155], v[196:199], v[172:175], v[152:155]
v_mfma_f32_16x16x32_bf16 v[156:159], v[200:203], v[172:175], v[156:159]
ds_read_b128 v[172:175], v253 offset:27456
v_mfma_f32_16x16x32_bf16 v[160:163], v[192:195], v[176:179], v[160:163]
v_mfma_f32_16x16x32_bf16 v[164:167], v[196:199], v[176:179], v[164:167]
v_mfma_f32_16x16x32_bf16 v[168:171], v[200:203], v[176:179], v[168:171]
ds_read_b128 v[176:179], v253 offset:28480
s_waitcnt vmcnt(9)
s_waitcnt lgkmcnt(3)
v_mfma_f32_16x16x32_bf16 v[88:91], v[204:207], v[180:183], v[88:91]
s_mov_b32 s34, 614400
v_mfma_f32_16x16x32_bf16 v[92:95], v[208:211], v[180:183], v[92:95]
buffer_load_dwordx4 v[192:195], v255, s[12:15], s34 offen offset:0 sc1
v_mfma_f32_16x16x32_bf16 v[96:99], v[212:215], v[180:183], v[96:99]
ds_read_b128 v[180:183], v253 offset:29504
v_mfma_f32_16x16x32_bf16 v[100:103], v[204:207], v[184:187], v[100:103]
v_mfma_f32_16x16x32_bf16 v[104:107], v[208:211], v[184:187], v[104:107]
buffer_load_dwordx4 v[196:199], v255, s[12:15], s34 offen offset:1024 sc1
v_mfma_f32_16x16x32_bf16 v[108:111], v[212:215], v[184:187], v[108:111]
ds_read_b128 v[184:187], v253 offset:30528
s_waitcnt lgkmcnt(3)
v_mfma_f32_16x16x32_bf16 v[112:115], v[204:207], v[188:191], v[112:115]
buffer_load_dwordx4 v[200:203], v255, s[12:15], s34 offen offset:2048 sc1
v_mfma_f32_16x16x32_bf16 v[116:119], v[208:211], v[188:191], v[116:119]
v_mfma_f32_16x16x32_bf16 v[120:123], v[212:215], v[188:191], v[120:123]
ds_read_b128 v[188:191], v254 offset:24384
v_mfma_f32_16x16x32_bf16 v[124:127], v[204:207], v[172:175], v[124:127]
v_mfma_f32_16x16x32_bf16 v[128:131], v[208:211], v[172:175], v[128:131]
v_mfma_f32_16x16x32_bf16 v[132:135], v[212:215], v[172:175], v[132:135]
ds_read_b128 v[172:175], v254 offset:25408
s_waitcnt lgkmcnt(3)
v_mfma_f32_16x16x32_bf16 v[136:139], v[204:207], v[176:179], v[136:139]
v_mfma_f32_16x16x32_bf16 v[140:143], v[208:211], v[176:179], v[140:143]
v_mfma_f32_16x16x32_bf16 v[144:147], v[212:215], v[176:179], v[144:147]
ds_read_b128 v[176:179], v254 offset:26432
v_mfma_f32_16x16x32_bf16 v[148:151], v[204:207], v[180:183], v[148:151]
v_mfma_f32_16x16x32_bf16 v[152:155], v[208:211], v[180:183], v[152:155]
v_mfma_f32_16x16x32_bf16 v[156:159], v[212:215], v[180:183], v[156:159]
ds_read_b128 v[180:183], v254 offset:27456
s_waitcnt lgkmcnt(3)
v_mfma_f32_16x16x32_bf16 v[160:163], v[204:207], v[184:187], v[160:163]
v_mfma_f32_16x16x32_bf16 v[164:167], v[208:211], v[184:187], v[164:167]
v_mfma_f32_16x16x32_bf16 v[168:171], v[212:215], v[184:187], v[168:171]
ds_read_b128 v[184:187], v254 offset:28480
s_waitcnt vmcnt(9)
v_mfma_f32_16x16x32_bf16 v[88:91], v[216:219], v[188:191], v[88:91]
s_mov_b32 s37, 626688
v_mfma_f32_16x16x32_bf16 v[92:95], v[220:223], v[188:191], v[92:95]
buffer_load_dwordx4 v[204:207], v255, s[12:15], s37 offen offset:0 sc1
v_mfma_f32_16x16x32_bf16 v[96:99], v[224:227], v[188:191], v[96:99]
ds_read_b128 v[188:191], v254 offset:29504
s_waitcnt lgkmcnt(3)
v_mfma_f32_16x16x32_bf16 v[100:103], v[216:219], v[172:175], v[100:103]
v_mfma_f32_16x16x32_bf16 v[104:107], v[220:223], v[172:175], v[104:107]
buffer_load_dwordx4 v[208:211], v255, s[12:15], s37 offen offset:1024 sc1
v_mfma_f32_16x16x32_bf16 v[108:111], v[224:227], v[172:175], v[108:111]
ds_read_b128 v[172:175], v254 offset:30528
v_mfma_f32_16x16x32_bf16 v[112:115], v[216:219], v[176:179], v[112:115]
buffer_load_dwordx4 v[212:215], v255, s[12:15], s37 offen offset:2048 sc1
v_mfma_f32_16x16x32_bf16 v[116:119], v[220:223], v[176:179], v[116:119]
v_mfma_f32_16x16x32_bf16 v[120:123], v[224:227], v[176:179], v[120:123]
ds_read_b128 v[176:179], v252 offset:32512
s_waitcnt lgkmcnt(3)
v_mfma_f32_16x16x32_bf16 v[124:127], v[216:219], v[180:183], v[124:127]
v_mfma_f32_16x16x32_bf16 v[128:131], v[220:223], v[180:183], v[128:131]
v_mfma_f32_16x16x32_bf16 v[132:135], v[224:227], v[180:183], v[132:135]
ds_read_b128 v[180:183], v252 offset:33536
v_mfma_f32_16x16x32_bf16 v[136:139], v[216:219], v[184:187], v[136:139]
v_mfma_f32_16x16x32_bf16 v[140:143], v[220:223], v[184:187], v[140:143]
v_mfma_f32_16x16x32_bf16 v[144:147], v[224:227], v[184:187], v[144:147]
ds_read_b128 v[184:187], v252 offset:34560
s_waitcnt lgkmcnt(3)
v_mfma_f32_16x16x32_bf16 v[148:151], v[216:219], v[188:191], v[148:151]
v_mfma_f32_16x16x32_bf16 v[152:155], v[220:223], v[188:191], v[152:155]
v_mfma_f32_16x16x32_bf16 v[156:159], v[224:227], v[188:191], v[156:159]
ds_read_b128 v[188:191], v252 offset:35584
v_mfma_f32_16x16x32_bf16 v[160:163], v[216:219], v[172:175], v[160:163]
v_mfma_f32_16x16x32_bf16 v[164:167], v[220:223], v[172:175], v[164:167]
v_mfma_f32_16x16x32_bf16 v[168:171], v[224:227], v[172:175], v[168:171]
ds_read_b128 v[172:175], v252 offset:36608
s_waitcnt vmcnt(9)
s_waitcnt lgkmcnt(3)
v_mfma_f32_16x16x32_bf16 v[88:91], v[228:231], v[176:179], v[88:91]
s_mov_b32 s34, 638976
v_mfma_f32_16x16x32_bf16 v[92:95], v[232:235], v[176:179], v[92:95]
buffer_load_dwordx4 v[216:219], v255, s[12:15], s34 offen offset:0 sc1
v_mfma_f32_16x16x32_bf16 v[96:99], v[236:239], v[176:179], v[96:99]
ds_read_b128 v[176:179], v252 offset:37632
v_mfma_f32_16x16x32_bf16 v[100:103], v[228:231], v[180:183], v[100:103]
v_mfma_f32_16x16x32_bf16 v[104:107], v[232:235], v[180:183], v[104:107]
buffer_load_dwordx4 v[220:223], v255, s[12:15], s34 offen offset:1024 sc1
v_mfma_f32_16x16x32_bf16 v[108:111], v[236:239], v[180:183], v[108:111]
ds_read_b128 v[180:183], v252 offset:38656
s_waitcnt lgkmcnt(3)
v_mfma_f32_16x16x32_bf16 v[112:115], v[228:231], v[184:187], v[112:115]
buffer_load_dwordx4 v[224:227], v255, s[12:15], s34 offen offset:2048 sc1
v_mfma_f32_16x16x32_bf16 v[116:119], v[232:235], v[184:187], v[116:119]
v_mfma_f32_16x16x32_bf16 v[120:123], v[236:239], v[184:187], v[120:123]
ds_read_b128 v[184:187], v253 offset:32512
v_mfma_f32_16x16x32_bf16 v[124:127], v[228:231], v[188:191], v[124:127]
v_mfma_f32_16x16x32_bf16 v[128:131], v[232:235], v[188:191], v[128:131]
v_mfma_f32_16x16x32_bf16 v[132:135], v[236:239], v[188:191], v[132:135]
ds_read_b128 v[188:191], v253 offset:33536
s_waitcnt lgkmcnt(3)
v_mfma_f32_16x16x32_bf16 v[136:139], v[228:231], v[172:175], v[136:139]
v_mfma_f32_16x16x32_bf16 v[140:143], v[232:235], v[172:175], v[140:143]
v_mfma_f32_16x16x32_bf16 v[144:147], v[236:239], v[172:175], v[144:147]
ds_read_b128 v[172:175], v253 offset:34560
v_mfma_f32_16x16x32_bf16 v[148:151], v[228:231], v[176:179], v[148:151]
v_mfma_f32_16x16x32_bf16 v[152:155], v[232:235], v[176:179], v[152:155]
v_mfma_f32_16x16x32_bf16 v[156:159], v[236:239], v[176:179], v[156:159]
ds_read_b128 v[176:179], v253 offset:35584
s_waitcnt lgkmcnt(3)
v_mfma_f32_16x16x32_bf16 v[160:163], v[228:231], v[180:183], v[160:163]
v_mfma_f32_16x16x32_bf16 v[164:167], v[232:235], v[180:183], v[164:167]
v_mfma_f32_16x16x32_bf16 v[168:171], v[236:239], v[180:183], v[168:171]
ds_read_b128 v[180:183], v253 offset:36608
s_waitcnt vmcnt(9)
v_mfma_f32_16x16x32_bf16 v[88:91], v[240:243], v[184:187], v[88:91]
s_mov_b32 s37, 651264
v_mfma_f32_16x16x32_bf16 v[92:95], v[244:247], v[184:187], v[92:95]
buffer_load_dwordx4 v[228:231], v255, s[12:15], s37 offen offset:0 sc1
v_mfma_f32_16x16x32_bf16 v[96:99], v[248:251], v[184:187], v[96:99]
ds_read_b128 v[184:187], v253 offset:37632
s_waitcnt lgkmcnt(3)
v_mfma_f32_16x16x32_bf16 v[100:103], v[240:243], v[188:191], v[100:103]
v_mfma_f32_16x16x32_bf16 v[104:107], v[244:247], v[188:191], v[104:107]
buffer_load_dwordx4 v[232:235], v255, s[12:15], s37 offen offset:1024 sc1
v_mfma_f32_16x16x32_bf16 v[108:111], v[248:251], v[188:191], v[108:111]
ds_read_b128 v[188:191], v253 offset:38656
v_mfma_f32_16x16x32_bf16 v[112:115], v[240:243], v[172:175], v[112:115]
buffer_load_dwordx4 v[236:239], v255, s[12:15], s37 offen offset:2048 sc1
v_mfma_f32_16x16x32_bf16 v[116:119], v[244:247], v[172:175], v[116:119]
v_mfma_f32_16x16x32_bf16 v[120:123], v[248:251], v[172:175], v[120:123]
ds_read_b128 v[172:175], v254 offset:32512
s_waitcnt lgkmcnt(3)
v_mfma_f32_16x16x32_bf16 v[124:127], v[240:243], v[176:179], v[124:127]
v_mfma_f32_16x16x32_bf16 v[128:131], v[244:247], v[176:179], v[128:131]
v_mfma_f32_16x16x32_bf16 v[132:135], v[248:251], v[176:179], v[132:135]
ds_read_b128 v[176:179], v254 offset:33536
v_mfma_f32_16x16x32_bf16 v[136:139], v[240:243], v[180:183], v[136:139]
v_mfma_f32_16x16x32_bf16 v[140:143], v[244:247], v[180:183], v[140:143]
v_mfma_f32_16x16x32_bf16 v[144:147], v[248:251], v[180:183], v[144:147]
ds_read_b128 v[180:183], v254 offset:34560
s_waitcnt lgkmcnt(3)
v_mfma_f32_16x16x32_bf16 v[148:151], v[240:243], v[184:187], v[148:151]
v_mfma_f32_16x16x32_bf16 v[152:155], v[244:247], v[184:187], v[152:155]
v_mfma_f32_16x16x32_bf16 v[156:159], v[248:251], v[184:187], v[156:159]
ds_read_b128 v[184:187], v254 offset:35584
v_mfma_f32_16x16x32_bf16 v[160:163], v[240:243], v[188:191], v[160:163]
v_mfma_f32_16x16x32_bf16 v[164:167], v[244:247], v[188:191], v[164:167]
v_mfma_f32_16x16x32_bf16 v[168:171], v[248:251], v[188:191], v[168:171]
ds_read_b128 v[188:191], v254 offset:36608
s_waitcnt vmcnt(9)
s_waitcnt lgkmcnt(3)
v_mfma_f32_16x16x32_bf16 v[88:91], v[192:195], v[172:175], v[88:91]
s_mov_b32 s34, 663552
v_mfma_f32_16x16x32_bf16 v[92:95], v[196:199], v[172:175], v[92:95]
buffer_load_dwordx4 v[240:243], v255, s[12:15], s34 offen offset:0 sc1
v_mfma_f32_16x16x32_bf16 v[96:99], v[200:203], v[172:175], v[96:99]
ds_read_b128 v[172:175], v254 offset:37632
v_mfma_f32_16x16x32_bf16 v[100:103], v[192:195], v[176:179], v[100:103]
v_mfma_f32_16x16x32_bf16 v[104:107], v[196:199], v[176:179], v[104:107]
buffer_load_dwordx4 v[244:247], v255, s[12:15], s34 offen offset:1024 sc1
v_mfma_f32_16x16x32_bf16 v[108:111], v[200:203], v[176:179], v[108:111]
ds_read_b128 v[176:179], v254 offset:38656
s_waitcnt lgkmcnt(3)
v_mfma_f32_16x16x32_bf16 v[112:115], v[192:195], v[180:183], v[112:115]
buffer_load_dwordx4 v[248:251], v255, s[12:15], s34 offen offset:2048 sc1
v_mfma_f32_16x16x32_bf16 v[116:119], v[196:199], v[180:183], v[116:119]
v_mfma_f32_16x16x32_bf16 v[120:123], v[200:203], v[180:183], v[120:123]
ds_read_b128 v[180:183], v252 offset:40640
v_mfma_f32_16x16x32_bf16 v[124:127], v[192:195], v[184:187], v[124:127]
v_mfma_f32_16x16x32_bf16 v[128:131], v[196:199], v[184:187], v[128:131]
v_mfma_f32_16x16x32_bf16 v[132:135], v[200:203], v[184:187], v[132:135]
ds_read_b128 v[184:187], v252 offset:41664
s_waitcnt lgkmcnt(3)
v_mfma_f32_16x16x32_bf16 v[136:139], v[192:195], v[188:191], v[136:139]
v_mfma_f32_16x16x32_bf16 v[140:143], v[196:199], v[188:191], v[140:143]
v_mfma_f32_16x16x32_bf16 v[144:147], v[200:203], v[188:191], v[144:147]
ds_read_b128 v[188:191], v252 offset:42688
v_mfma_f32_16x16x32_bf16 v[148:151], v[192:195], v[172:175], v[148:151]
v_mfma_f32_16x16x32_bf16 v[152:155], v[196:199], v[172:175], v[152:155]
v_mfma_f32_16x16x32_bf16 v[156:159], v[200:203], v[172:175], v[156:159]
ds_read_b128 v[172:175], v252 offset:43712
s_waitcnt lgkmcnt(3)
v_mfma_f32_16x16x32_bf16 v[160:163], v[192:195], v[176:179], v[160:163]
v_mfma_f32_16x16x32_bf16 v[164:167], v[196:199], v[176:179], v[164:167]
v_mfma_f32_16x16x32_bf16 v[168:171], v[200:203], v[176:179], v[168:171]
ds_read_b128 v[176:179], v252 offset:44736
s_waitcnt vmcnt(9)
v_mfma_f32_16x16x32_bf16 v[88:91], v[204:207], v[180:183], v[88:91]
s_mov_b32 s37, 675840
v_mfma_f32_16x16x32_bf16 v[92:95], v[208:211], v[180:183], v[92:95]
buffer_load_dwordx4 v[192:195], v255, s[12:15], s37 offen offset:0 sc1
v_mfma_f32_16x16x32_bf16 v[96:99], v[212:215], v[180:183], v[96:99]
ds_read_b128 v[180:183], v252 offset:45760
s_waitcnt lgkmcnt(3)
v_mfma_f32_16x16x32_bf16 v[100:103], v[204:207], v[184:187], v[100:103]
v_mfma_f32_16x16x32_bf16 v[104:107], v[208:211], v[184:187], v[104:107]
buffer_load_dwordx4 v[196:199], v255, s[12:15], s37 offen offset:1024 sc1
v_mfma_f32_16x16x32_bf16 v[108:111], v[212:215], v[184:187], v[108:111]
ds_read_b128 v[184:187], v252 offset:46784
v_mfma_f32_16x16x32_bf16 v[112:115], v[204:207], v[188:191], v[112:115]
buffer_load_dwordx4 v[200:203], v255, s[12:15], s37 offen offset:2048 sc1
v_mfma_f32_16x16x32_bf16 v[116:119], v[208:211], v[188:191], v[116:119]
v_mfma_f32_16x16x32_bf16 v[120:123], v[212:215], v[188:191], v[120:123]
ds_read_b128 v[188:191], v253 offset:40640
s_waitcnt lgkmcnt(3)
v_mfma_f32_16x16x32_bf16 v[124:127], v[204:207], v[172:175], v[124:127]
v_mfma_f32_16x16x32_bf16 v[128:131], v[208:211], v[172:175], v[128:131]
v_mfma_f32_16x16x32_bf16 v[132:135], v[212:215], v[172:175], v[132:135]
ds_read_b128 v[172:175], v253 offset:41664
v_mfma_f32_16x16x32_bf16 v[136:139], v[204:207], v[176:179], v[136:139]
v_mfma_f32_16x16x32_bf16 v[140:143], v[208:211], v[176:179], v[140:143]
v_mfma_f32_16x16x32_bf16 v[144:147], v[212:215], v[176:179], v[144:147]
ds_read_b128 v[176:179], v253 offset:42688
s_waitcnt lgkmcnt(3)
v_mfma_f32_16x16x32_bf16 v[148:151], v[204:207], v[180:183], v[148:151]
v_mfma_f32_16x16x32_bf16 v[152:155], v[208:211], v[180:183], v[152:155]
v_mfma_f32_16x16x32_bf16 v[156:159], v[212:215], v[180:183], v[156:159]
ds_read_b128 v[180:183], v253 offset:43712
v_mfma_f32_16x16x32_bf16 v[160:163], v[204:207], v[184:187], v[160:163]
v_mfma_f32_16x16x32_bf16 v[164:167], v[208:211], v[184:187], v[164:167]
v_mfma_f32_16x16x32_bf16 v[168:171], v[212:215], v[184:187], v[168:171]
ds_read_b128 v[184:187], v253 offset:44736
s_waitcnt vmcnt(9)
s_waitcnt lgkmcnt(3)
v_mfma_f32_16x16x32_bf16 v[88:91], v[216:219], v[188:191], v[88:91]
s_mov_b32 s34, 688128
v_mfma_f32_16x16x32_bf16 v[92:95], v[220:223], v[188:191], v[92:95]
buffer_load_dwordx4 v[204:207], v255, s[12:15], s34 offen offset:0 sc1
v_mfma_f32_16x16x32_bf16 v[96:99], v[224:227], v[188:191], v[96:99]
ds_read_b128 v[188:191], v253 offset:45760
v_mfma_f32_16x16x32_bf16 v[100:103], v[216:219], v[172:175], v[100:103]
v_mfma_f32_16x16x32_bf16 v[104:107], v[220:223], v[172:175], v[104:107]
buffer_load_dwordx4 v[208:211], v255, s[12:15], s34 offen offset:1024 sc1
v_mfma_f32_16x16x32_bf16 v[108:111], v[224:227], v[172:175], v[108:111]
ds_read_b128 v[172:175], v253 offset:46784
s_waitcnt lgkmcnt(3)
v_mfma_f32_16x16x32_bf16 v[112:115], v[216:219], v[176:179], v[112:115]
buffer_load_dwordx4 v[212:215], v255, s[12:15], s34 offen offset:2048 sc1
v_mfma_f32_16x16x32_bf16 v[116:119], v[220:223], v[176:179], v[116:119]
v_mfma_f32_16x16x32_bf16 v[120:123], v[224:227], v[176:179], v[120:123]
ds_read_b128 v[176:179], v254 offset:40640
v_mfma_f32_16x16x32_bf16 v[124:127], v[216:219], v[180:183], v[124:127]
v_mfma_f32_16x16x32_bf16 v[128:131], v[220:223], v[180:183], v[128:131]
v_mfma_f32_16x16x32_bf16 v[132:135], v[224:227], v[180:183], v[132:135]
ds_read_b128 v[180:183], v254 offset:41664
s_waitcnt lgkmcnt(3)
v_mfma_f32_16x16x32_bf16 v[136:139], v[216:219], v[184:187], v[136:139]
v_mfma_f32_16x16x32_bf16 v[140:143], v[220:223], v[184:187], v[140:143]
v_mfma_f32_16x16x32_bf16 v[144:147], v[224:227], v[184:187], v[144:147]
ds_read_b128 v[184:187], v254 offset:42688
v_mfma_f32_16x16x32_bf16 v[148:151], v[216:219], v[188:191], v[148:151]
v_mfma_f32_16x16x32_bf16 v[152:155], v[220:223], v[188:191], v[152:155]
v_mfma_f32_16x16x32_bf16 v[156:159], v[224:227], v[188:191], v[156:159]
ds_read_b128 v[188:191], v254 offset:43712
s_waitcnt lgkmcnt(3)
v_mfma_f32_16x16x32_bf16 v[160:163], v[216:219], v[172:175], v[160:163]
v_mfma_f32_16x16x32_bf16 v[164:167], v[220:223], v[172:175], v[164:167]
v_mfma_f32_16x16x32_bf16 v[168:171], v[224:227], v[172:175], v[168:171]
ds_read_b128 v[172:175], v254 offset:44736
s_barrier
s_waitcnt vmcnt(9)
v_mfma_f32_16x16x32_bf16 v[88:91], v[228:231], v[176:179], v[88:91]
s_mov_b32 s37, 700416
v_mfma_f32_16x16x32_bf16 v[92:95], v[232:235], v[176:179], v[92:95]
buffer_load_dwordx4 v[216:219], v255, s[12:15], s37 offen offset:0 sc1
v_mfma_f32_16x16x32_bf16 v[96:99], v[236:239], v[176:179], v[96:99]
ds_read_b128 v[176:179], v254 offset:45760
s_waitcnt lgkmcnt(3)
v_mfma_f32_16x16x32_bf16 v[100:103], v[228:231], v[180:183], v[100:103]
v_mfma_f32_16x16x32_bf16 v[104:107], v[232:235], v[180:183], v[104:107]
buffer_load_dwordx4 v[220:223], v255, s[12:15], s37 offen offset:1024 sc1
v_mfma_f32_16x16x32_bf16 v[108:111], v[236:239], v[180:183], v[108:111]
ds_read_b128 v[180:183], v254 offset:46784
v_mfma_f32_16x16x32_bf16 v[112:115], v[228:231], v[184:187], v[112:115]
buffer_load_dwordx4 v[224:227], v255, s[12:15], s37 offen offset:2048 sc1
v_mfma_f32_16x16x32_bf16 v[116:119], v[232:235], v[184:187], v[116:119]
v_add_u32 v252, 48768, v252
v_mfma_f32_16x16x32_bf16 v[120:123], v[236:239], v[184:187], v[120:123]
ds_read_b128 v[184:187], v252 offset:0
s_waitcnt lgkmcnt(3)
v_mfma_f32_16x16x32_bf16 v[124:127], v[228:231], v[188:191], v[124:127]
v_sub_f32 v4, v4, v88
v_mfma_f32_16x16x32_bf16 v[128:131], v[232:235], v[188:191], v[128:131]
v_add_u32 v253, 48768, v253
v_mfma_f32_16x16x32_bf16 v[132:135], v[236:239], v[188:191], v[132:135]
ds_read_b128 v[188:191], v253 offset:0
v_sub_f32 v16, v16, v100
v_mfma_f32_16x16x32_bf16 v[136:139], v[228:231], v[172:175], v[136:139]
v_sub_f32 v5, v5, v89
v_sub_f32 v17, v17, v101
v_mfma_f32_16x16x32_bf16 v[140:143], v[232:235], v[172:175], v[140:143]
v_sub_f32 v6, v6, v90
v_sub_f32 v18, v18, v102
v_mfma_f32_16x16x32_bf16 v[144:147], v[236:239], v[172:175], v[144:147]
ds_read_b128 v[172:175], v252 offset:1024
v_sub_f32 v19, v19, v103
s_waitcnt lgkmcnt(3)
v_mfma_f32_16x16x32_bf16 v[148:151], v[228:231], v[176:179], v[148:151]
v_sub_f32 v7, v7, v91
v_sub_f32 v28, v28, v112
v_mfma_f32_16x16x32_bf16 v[152:155], v[232:235], v[176:179], v[152:155]
v_sub_f32 v8, v8, v92
v_sub_f32 v20, v20, v104
v_mfma_f32_16x16x32_bf16 v[156:159], v[236:239], v[176:179], v[156:159]
ds_read_b128 v[176:179], v253 offset:1024
v_sub_f32 v29, v29, v113
v_sub_f32 v40, v40, v124
v_mfma_f32_16x16x32_bf16 v[160:163], v[228:231], v[180:183], v[160:163]
v_sub_f32 v9, v9, v93
v_sub_f32 v30, v30, v114
v_sub_f32 v41, v41, v125
v_mfma_f32_16x16x32_bf16 v[164:167], v[232:235], v[180:183], v[164:167]
v_sub_f32 v10, v10, v94
v_sub_f32 v11, v11, v95
v_mfma_f32_16x16x32_bf16 v[168:171], v[236:239], v[180:183], v[168:171]
ds_read_b128 v[180:183], v252 offset:2048
v_sub_f32 v12, v12, v96
v_sub_f32 v13, v13, v97
v_sub_f32 v14, v14, v98
v_sub_f32 v15, v15, v99
s_waitcnt vmcnt(9)
s_waitcnt lgkmcnt(3)
v_mfma_f32_16x16x32_bf16 v[88:91], v[240:243], v[184:187], v[88:91]
s_mov_b32 s34, 712704
v_sub_f32 v31, v31, v115
v_sub_f32 v52, v52, v136
v_mfma_f32_16x16x32_bf16 v[92:95], v[244:247], v[184:187], v[92:95]
buffer_load_dwordx4 v[228:231], v255, s[12:15], s34 offen offset:0 sc1
v_sub_f32 v42, v42, v126
v_sub_f32 v53, v53, v137
v_mfma_f32_16x16x32_bf16 v[96:99], v[248:251], v[184:187], v[96:99]
ds_read_b128 v[184:187], v253 offset:2048
v_sub_f32 v43, v43, v127
v_sub_f32 v64, v64, v148
s_waitcnt vmcnt(7)
v_mfma_f32_16x16x32_bf16 v[88:91], v[192:195], v[188:191], v[88:91]
v_sub_f32 v21, v21, v105
v_sub_f32 v22, v22, v106
v_sub_f32 v54, v54, v138
v_mfma_f32_16x16x32_bf16 v[92:95], v[196:199], v[188:191], v[92:95]
buffer_load_dwordx4 v[232:235], v255, s[12:15], s34 offen offset:1024 sc1
v_sub_f32 v23, v23, v107
v_sub_f32 v65, v65, v149
v_mfma_f32_16x16x32_bf16 v[96:99], v[200:203], v[188:191], v[96:99]
ds_read_b128 v[188:191], v252 offset:3072
v_sub_f32 v24, v24, v108
v_sub_f32 v25, v25, v109
v_sub_f32 v26, v26, v110
v_sub_f32 v27, v27, v111
s_waitcnt lgkmcnt(3)
v_mfma_f32_16x16x32_bf16 v[100:103], v[240:243], v[172:175], v[100:103]
buffer_load_dwordx4 v[236:239], v255, s[12:15], s34 offen offset:2048 sc1
v_sub_f32 v44, v44, v128
v_sub_f32 v66, v66, v150
v_mfma_f32_16x16x32_bf16 v[104:107], v[244:247], v[172:175], v[104:107]
v_sub_f32 v32, v32, v116
v_sub_f32 v55, v55, v139
v_sub_f32 v76, v76, v160
v_mfma_f32_16x16x32_bf16 v[108:111], v[248:251], v[172:175], v[108:111]
ds_read_b128 v[172:175], v253 offset:3072
v_sub_f32 v56, v56, v140
v_sub_f32 v67, v67, v151
v_mfma_f32_16x16x32_bf16 v[100:103], v[192:195], v[176:179], v[100:103]
v_sub_f32 v33, v33, v117
v_sub_f32 v57, v57, v141
v_sub_f32 v77, v77, v161
v_mfma_f32_16x16x32_bf16 v[104:107], v[196:199], v[176:179], v[104:107]
v_sub_f32 v34, v34, v118
v_sub_f32 v35, v35, v119
v_sub_f32 v78, v78, v162
v_mfma_f32_16x16x32_bf16 v[108:111], v[200:203], v[176:179], v[108:111]
ds_read_b128 v[176:179], v252 offset:4096
v_sub_f32 v36, v36, v120
v_sub_f32 v37, v37, v121
v_sub_f32 v38, v38, v122
v_sub_f32 v39, v39, v123
s_waitcnt lgkmcnt(3)
v_mfma_f32_16x16x32_bf16 v[112:115], v[240:243], v[180:183], v[112:115]
v_sub_f32 v45, v45, v129
v_sub_f32 v58, v58, v142
v_sub_f32 v79, v79, v163
v_mfma_f32_16x16x32_bf16 v[116:119], v[244:247], v[180:183], v[116:119]
v_sub_f32 v46, v46, v130
v_sub_f32 v68, v68, v152
v_mfma_f32_16x16x32_bf16 v[120:123], v[248:251], v[180:183], v[120:123]
ds_read_b128 v[180:183], v253 offset:4096
v_sub_f32 v69, v69, v153
v_mfma_f32_16x16x32_bf16 v[112:115], v[192:195], v[184:187], v[112:115]
v_sub_f32 v47, v47, v131
v_sub_f32 v70, v70, v154
v_sub_f32 v80, v80, v164
v_mfma_f32_16x16x32_bf16 v[116:119], v[196:199], v[184:187], v[116:119]
v_sub_f32 v48, v48, v132
v_sub_f32 v49, v49, v133
v_mfma_f32_16x16x32_bf16 v[120:123], v[200:203], v[184:187], v[120:123]
ds_read_b128 v[184:187], v252 offset:5120
v_sub_f32 v50, v50, v134
v_sub_f32 v51, v51, v135
s_waitcnt lgkmcnt(3)
v_mfma_f32_16x16x32_bf16 v[124:127], v[240:243], v[188:191], v[124:127]
v_sub_f32 v59, v59, v143
v_sub_f32 v71, v71, v155
v_mfma_f32_16x16x32_bf16 v[128:131], v[244:247], v[188:191], v[128:131]
v_sub_f32 v60, v60, v144
v_sub_f32 v81, v81, v165
v_mfma_f32_16x16x32_bf16 v[132:135], v[248:251], v[188:191], v[132:135]
ds_read_b128 v[188:191], v253 offset:5120
v_sub_f32 v82, v82, v166
v_mfma_f32_16x16x32_bf16 v[124:127], v[192:195], v[172:175], v[124:127]
v_sub_f32 v61, v61, v145
v_sub_f32 v83, v83, v167
v_mfma_f32_16x16x32_bf16 v[128:131], v[196:199], v[172:175], v[128:131]
v_sub_f32 v62, v62, v146
v_sub_f32 v63, v63, v147
v_mfma_f32_16x16x32_bf16 v[132:135], v[200:203], v[172:175], v[132:135]
ds_read_b128 v[172:175], v252 offset:6144
v_cvt_pk_bf16_f32 v4, v4, v5
s_waitcnt lgkmcnt(3)
v_mfma_f32_16x16x32_bf16 v[136:139], v[240:243], v[176:179], v[136:139]
v_sub_f32 v72, v72, v156
v_cvt_pk_bf16_f32 v5, v6, v7
v_mfma_f32_16x16x32_bf16 v[140:143], v[244:247], v[176:179], v[140:143]
v_sub_f32 v73, v73, v157
v_sub_f32 v84, v84, v168
v_mfma_f32_16x16x32_bf16 v[144:147], v[248:251], v[176:179], v[144:147]
ds_read_b128 v[176:179], v253 offset:6144
v_cvt_pk_bf16_f32 v8, v8, v9
v_mfma_f32_16x16x32_bf16 v[136:139], v[192:195], v[180:183], v[136:139]
v_sub_f32 v74, v74, v158
v_sub_f32 v75, v75, v159
v_mfma_f32_16x16x32_bf16 v[140:143], v[196:199], v[180:183], v[140:143]
v_add_u32 v254, 48768, v254
v_cvt_pk_bf16_f32 v9, v10, v11
v_mfma_f32_16x16x32_bf16 v[144:147], v[200:203], v[180:183], v[144:147]
ds_read_b128 v[180:183], v254 offset:0
s_waitcnt lgkmcnt(3)
v_mfma_f32_16x16x32_bf16 v[148:151], v[240:243], v[184:187], v[148:151]
v_sub_f32 v85, v85, v169
v_cvt_pk_bf16_f32 v12, v12, v13
v_mfma_f32_16x16x32_bf16 v[152:155], v[244:247], v[184:187], v[152:155]
v_sub_f32 v86, v86, v170
v_mfma_f32_16x16x32_bf16 v[156:159], v[248:251], v[184:187], v[156:159]
ds_read_b128 v[184:187], v254 offset:1024
v_mfma_f32_16x16x32_bf16 v[148:151], v[192:195], v[188:191], v[148:151]
v_sub_f32 v87, v87, v171
v_mfma_f32_16x16x32_bf16 v[152:155], v[196:199], v[188:191], v[152:155]
v_cvt_pk_bf16_f32 v13, v14, v15
v_mfma_f32_16x16x32_bf16 v[156:159], v[200:203], v[188:191], v[156:159]
ds_read_b128 v[188:191], v254 offset:2048
s_waitcnt lgkmcnt(3)
v_mfma_f32_16x16x32_bf16 v[160:163], v[240:243], v[172:175], v[160:163]
ds_write_b64 v1, v[4:5] offset:0
v_mfma_f32_16x16x32_bf16 v[164:167], v[244:247], v[172:175], v[164:167]
ds_write_b64 v1, v[8:9] offset:32
v_mfma_f32_16x16x32_bf16 v[168:171], v[248:251], v[172:175], v[168:171]
ds_read_b128 v[172:175], v254 offset:3072
ds_write_b64 v1, v[12:13] offset:64
v_mfma_f32_16x16x32_bf16 v[160:163], v[192:195], v[176:179], v[160:163]
s_mov_b32 s37, 724992
v_mfma_f32_16x16x32_bf16 v[164:167], v[196:199], v[176:179], v[164:167]
buffer_load_dwordx4 v[240:243], v255, s[12:15], s37 offen offset:0 sc1
v_mfma_f32_16x16x32_bf16 v[168:171], v[200:203], v[176:179], v[168:171]
ds_read_b128 v[176:179], v254 offset:4096
s_waitcnt vmcnt(7)
s_waitcnt lgkmcnt(6)
v_mfma_f32_16x16x32_bf16 v[88:91], v[204:207], v[180:183], v[88:91]
v_mfma_f32_16x16x32_bf16 v[92:95], v[208:211], v[180:183], v[92:95]
buffer_load_dwordx4 v[244:247], v255, s[12:15], s37 offen offset:1024 sc1
v_mfma_f32_16x16x32_bf16 v[96:99], v[212:215], v[180:183], v[96:99]
ds_read_b128 v[180:183], v254 offset:5120
v_mfma_f32_16x16x32_bf16 v[100:103], v[204:207], v[184:187], v[100:103]
buffer_load_dwordx4 v[248:251], v255, s[12:15], s37 offen offset:2048 sc1
v_mfma_f32_16x16x32_bf16 v[104:107], v[208:211], v[184:187], v[104:107]
v_cvt_pk_bf16_f32 v16, v16, v17
v_mfma_f32_16x16x32_bf16 v[108:111], v[212:215], v[184:187], v[108:111]
ds_read_b128 v[184:187], v254 offset:6144
s_waitcnt lgkmcnt(4)
v_mfma_f32_16x16x32_bf16 v[112:115], v[204:207], v[188:191], v[112:115]
v_cvt_pk_bf16_f32 v17, v18, v19
v_cvt_pk_bf16_f32 v20, v20, v21
v_mfma_f32_16x16x32_bf16 v[116:119], v[208:211], v[188:191], v[116:119]
s_mov_b32 s34, 737280
v_cvt_pk_bf16_f32 v21, v22, v23
v_mfma_f32_16x16x32_bf16 v[120:123], v[212:215], v[188:191], v[120:123]
ds_read_b128 v[188:191], v252 offset:8128
v_mfma_f32_16x16x32_bf16 v[124:127], v[204:207], v[172:175], v[124:127]
buffer_load_dwordx4 v[192:195], v255, s[12:15], s34 offen offset:0 sc1
v_mfma_f32_16x16x32_bf16 v[128:131], v[208:211], v[172:175], v[128:131]
buffer_load_dwordx4 v[196:199], v255, s[12:15], s34 offen offset:1024 sc1
v_mfma_f32_16x16x32_bf16 v[132:135], v[212:215], v[172:175], v[132:135]
ds_read_b128 v[172:175], v252 offset:9152
s_waitcnt lgkmcnt(3)
v_mfma_f32_16x16x32_bf16 v[136:139], v[204:207], v[176:179], v[136:139]
v_cvt_pk_bf16_f32 v24, v24, v25
v_mfma_f32_16x16x32_bf16 v[140:143], v[208:211], v[176:179], v[140:143]
buffer_load_dwordx4 v[200:203], v255, s[12:15], s34 offen offset:2048 sc1
v_mfma_f32_16x16x32_bf16 v[144:147], v[212:215], v[176:179], v[144:147]
ds_read_b128 v[176:179], v252 offset:10176
v_mfma_f32_16x16x32_bf16 v[148:151], v[204:207], v[180:183], v[148:151]
s_mov_b32 s35, 860160
v_mfma_f32_16x16x32_bf16 v[152:155], v[208:211], v[180:183], v[152:155]
buffer_load_dwordx4 v[4:7], v255, s[12:15], s35 offen offset:0 sc1
v_mfma_f32_16x16x32_bf16 v[156:159], v[212:215], v[180:183], v[156:159]
ds_read_b128 v[180:183], v252 offset:11200
s_waitcnt lgkmcnt(3)
v_mfma_f32_16x16x32_bf16 v[160:163], v[204:207], v[184:187], v[160:163]
v_cvt_pk_bf16_f32 v25, v26, v27
v_mfma_f32_16x16x32_bf16 v[164:167], v[208:211], v[184:187], v[164:167]
ds_write_b64 v1, v[16:17] offset:6400
ds_write_b64 v1, v[20:21] offset:6432
v_mfma_f32_16x16x32_bf16 v[168:171], v[212:215], v[184:187], v[168:171]
ds_read_b128 v[184:187], v252 offset:12224
ds_write_b64 v1, v[24:25] offset:6464
s_waitcnt vmcnt(10)
v_mfma_f32_16x16x32_bf16 v[88:91], v[216:219], v[188:191], v[88:91]
s_mov_b32 s37, 749568
v_mfma_f32_16x16x32_bf16 v[92:95], v[220:223], v[188:191], v[92:95]
buffer_load_dwordx4 v[204:207], v255, s[12:15], s37 offen offset:0 sc1
v_mfma_f32_16x16x32_bf16 v[96:99], v[224:227], v[188:191], v[96:99]
ds_read_b128 v[188:191], v252 offset:13248
s_waitcnt lgkmcnt(6)
v_mfma_f32_16x16x32_bf16 v[100:103], v[216:219], v[172:175], v[100:103]
v_cvt_pk_bf16_f32 v28, v28, v29
v_cvt_pk_bf16_f32 v29, v30, v31
v_mfma_f32_16x16x32_bf16 v[104:107], v[220:223], v[172:175], v[104:107]
buffer_load_dwordx4 v[208:211], v255, s[12:15], s37 offen offset:1024 sc1
v_mfma_f32_16x16x32_bf16 v[108:111], v[224:227], v[172:175], v[108:111]
ds_read_b128 v[172:175], v252 offset:14272
v_mfma_f32_16x16x32_bf16 v[112:115], v[216:219], v[176:179], v[112:115]
buffer_load_dwordx4 v[212:215], v255, s[12:15], s37 offen offset:2048 sc1
v_mfma_f32_16x16x32_bf16 v[116:119], v[220:223], v[176:179], v[116:119]
v_cvt_pk_bf16_f32 v32, v32, v33
v_mfma_f32_16x16x32_bf16 v[120:123], v[224:227], v[176:179], v[120:123]
ds_read_b128 v[176:179], v253 offset:8128
s_waitcnt lgkmcnt(4)
v_mfma_f32_16x16x32_bf16 v[124:127], v[216:219], v[180:183], v[124:127]
v_cvt_pk_bf16_f32 v33, v34, v35
v_mfma_f32_16x16x32_bf16 v[128:131], v[220:223], v[180:183], v[128:131]
v_cvt_pk_bf16_f32 v36, v36, v37
v_mfma_f32_16x16x32_bf16 v[132:135], v[224:227], v[180:183], v[132:135]
ds_read_b128 v[180:183], v253 offset:9152
v_mfma_f32_16x16x32_bf16 v[136:139], v[216:219], v[184:187], v[136:139]
s_mov_b32 s35, 860160
v_mfma_f32_16x16x32_bf16 v[140:143], v[220:223], v[184:187], v[140:143]
buffer_load_dwordx4 v[8:11], v255, s[12:15], s35 offen offset:1024 sc1
v_mfma_f32_16x16x32_bf16 v[144:147], v[224:227], v[184:187], v[144:147]
ds_read_b128 v[184:187], v253 offset:10176
s_waitcnt lgkmcnt(3)
v_mfma_f32_16x16x32_bf16 v[148:151], v[216:219], v[188:191], v[148:151]
v_cvt_pk_bf16_f32 v37, v38, v39
v_mfma_f32_16x16x32_bf16 v[152:155], v[220:223], v[188:191], v[152:155]
ds_write_b64 v1, v[28:29] offset:12800
v_mfma_f32_16x16x32_bf16 v[156:159], v[224:227], v[188:191], v[156:159]
ds_read_b128 v[188:191], v253 offset:11200
v_mfma_f32_16x16x32_bf16 v[160:163], v[216:219], v[172:175], v[160:163]
ds_write_b64 v1, v[32:33] offset:12832
v_mfma_f32_16x16x32_bf16 v[164:167], v[220:223], v[172:175], v[164:167]
ds_write_b64 v1, v[36:37] offset:12864
v_mfma_f32_16x16x32_bf16 v[168:171], v[224:227], v[172:175], v[168:171]
ds_read_b128 v[172:175], v253 offset:12224
s_barrier
s_waitcnt vmcnt(11)
s_waitcnt lgkmcnt(6)
v_mfma_f32_16x16x32_bf16 v[88:91], v[228:231], v[176:179], v[88:91]
s_mov_b32 s34, 761856
v_mfma_f32_16x16x32_bf16 v[92:95], v[232:235], v[176:179], v[92:95]
buffer_load_dwordx4 v[216:219], v255, s[12:15], s34 offen offset:0 sc1
v_mfma_f32_16x16x32_bf16 v[96:99], v[236:239], v[176:179], v[96:99]
ds_read_b128 v[176:179], v253 offset:13248
v_mfma_f32_16x16x32_bf16 v[100:103], v[228:231], v[180:183], v[100:103]
v_cvt_pk_bf16_f32 v40, v40, v41
v_cvt_pk_bf16_f32 v41, v42, v43
v_mfma_f32_16x16x32_bf16 v[104:107], v[232:235], v[180:183], v[104:107]
buffer_load_dwordx4 v[220:223], v255, s[12:15], s34 offen offset:1024 sc1
v_mfma_f32_16x16x32_bf16 v[108:111], v[236:239], v[180:183], v[108:111]
ds_read_b128 v[180:183], v253 offset:14272
s_waitcnt lgkmcnt(5)
v_mfma_f32_16x16x32_bf16 v[112:115], v[228:231], v[184:187], v[112:115]
buffer_load_dwordx4 v[224:227], v255, s[12:15], s34 offen offset:2048 sc1
v_mfma_f32_16x16x32_bf16 v[116:119], v[232:235], v[184:187], v[116:119]
v_cvt_pk_bf16_f32 v44, v44, v45
v_mfma_f32_16x16x32_bf16 v[120:123], v[236:239], v[184:187], v[120:123]
ds_read_b128 v[184:187], v254 offset:8128
v_mfma_f32_16x16x32_bf16 v[124:127], v[228:231], v[188:191], v[124:127]
v_cvt_pk_bf16_f32 v45, v46, v47
v_mfma_f32_16x16x32_bf16 v[128:131], v[232:235], v[188:191], v[128:131]
v_cvt_pk_bf16_f32 v48, v48, v49
v_mfma_f32_16x16x32_bf16 v[132:135], v[236:239], v[188:191], v[132:135]
ds_read_b128 v[188:191], v254 offset:9152
s_waitcnt lgkmcnt(3)
v_mfma_f32_16x16x32_bf16 v[136:139], v[228:231], v[172:175], v[136:139]
s_mov_b32 s35, 860160
v_mfma_f32_16x16x32_bf16 v[140:143], v[232:235], v[172:175], v[140:143]
buffer_load_dwordx4 v[12:15], v255, s[12:15], s35 offen offset:2048 sc1
v_mfma_f32_16x16x32_bf16 v[144:147], v[236:239], v[172:175], v[144:147]
ds_read_b128 v[172:175], v254 offset:10176
v_mfma_f32_16x16x32_bf16 v[148:151], v[228:231], v[176:179], v[148:151]
v_cvt_pk_bf16_f32 v49, v50, v51
v_mfma_f32_16x16x32_bf16 v[152:155], v[232:235], v[176:179], v[152:155]
ds_write_b64 v1, v[40:41] offset:19200
v_mfma_f32_16x16x32_bf16 v[156:159], v[236:239], v[176:179], v[156:159]
ds_read_b128 v[176:179], v254 offset:11200
s_waitcnt lgkmcnt(4)
v_mfma_f32_16x16x32_bf16 v[160:163], v[228:231], v[180:183], v[160:163]
ds_write_b64 v1, v[44:45] offset:19232
v_mfma_f32_16x16x32_bf16 v[164:167], v[232:235], v[180:183], v[164:167]
ds_write_b64 v1, v[48:49] offset:19264
v_mfma_f32_16x16x32_bf16 v[168:171], v[236:239], v[180:183], v[168:171]
ds_read_b128 v[180:183], v254 offset:12224
s_waitcnt vmcnt(12)
v_mfma_f32_16x16x32_bf16 v[88:91], v[240:243], v[184:187], v[88:91]
s_mov_b32 s37, 774144
v_mfma_f32_16x16x32_bf16 v[92:95], v[244:247], v[184:187], v[92:95]
buffer_load_dwordx4 v[228:231], v255, s[12:15], s37 offen offset:0 sc1
v_mfma_f32_16x16x32_bf16 v[96:99], v[248:251], v[184:187], v[96:99]
ds_read_b128 v[184:187], v254 offset:13248
s_waitcnt lgkmcnt(6)
v_mfma_f32_16x16x32_bf16 v[100:103], v[240:243], v[188:191], v[100:103]
v_cvt_pk_bf16_f32 v52, v52, v53
v_cvt_pk_bf16_f32 v53, v54, v55
v_mfma_f32_16x16x32_bf16 v[104:107], v[244:247], v[188:191], v[104:107]
buffer_load_dwordx4 v[232:235], v255, s[12:15], s37 offen offset:1024 sc1
v_mfma_f32_16x16x32_bf16 v[108:111], v[248:251], v[188:191], v[108:111]
ds_read_b128 v[188:191], v254 offset:14272
v_mfma_f32_16x16x32_bf16 v[112:115], v[240:243], v[172:175], v[112:115]
buffer_load_dwordx4 v[236:239], v255, s[12:15], s37 offen offset:2048 sc1
v_mfma_f32_16x16x32_bf16 v[116:119], v[244:247], v[172:175], v[116:119]
v_cvt_pk_bf16_f32 v56, v56, v57
v_mfma_f32_16x16x32_bf16 v[120:123], v[248:251], v[172:175], v[120:123]
ds_read_b128 v[172:175], v252 offset:16256
s_waitcnt lgkmcnt(3)
v_mfma_f32_16x16x32_bf16 v[124:127], v[240:243], v[176:179], v[124:127]
v_cvt_pk_bf16_f32 v57, v58, v59
v_mfma_f32_16x16x32_bf16 v[128:131], v[244:247], v[176:179], v[128:131]
v_cvt_pk_bf16_f32 v60, v60, v61
v_mfma_f32_16x16x32_bf16 v[132:135], v[248:251], v[176:179], v[132:135]
ds_read_b128 v[176:179], v252 offset:17280
v_mfma_f32_16x16x32_bf16 v[136:139], v[240:243], v[180:183], v[136:139]
s_mov_b32 s35, 872448
v_mfma_f32_16x16x32_bf16 v[140:143], v[244:247], v[180:183], v[140:143]
buffer_load_dwordx4 v[16:19], v255, s[12:15], s35 offen offset:0 sc1
v_mfma_f32_16x16x32_bf16 v[144:147], v[248:251], v[180:183], v[144:147]
ds_read_b128 v[180:183], v252 offset:18304
s_waitcnt lgkmcnt(3)
v_mfma_f32_16x16x32_bf16 v[148:151], v[240:243], v[184:187], v[148:151]
v_cvt_pk_bf16_f32 v61, v62, v63
v_mfma_f32_16x16x32_bf16 v[152:155], v[244:247], v[184:187], v[152:155]
ds_write_b64 v1, v[52:53] offset:25600
v_mfma_f32_16x16x32_bf16 v[156:159], v[248:251], v[184:187], v[156:159]
ds_read_b128 v[184:187], v252 offset:19328
v_mfma_f32_16x16x32_bf16 v[160:163], v[240:243], v[188:191], v[160:163]
ds_write_b64 v1, v[56:57] offset:25632
v_mfma_f32_16x16x32_bf16 v[164:167], v[244:247], v[188:191], v[164:167]
ds_write_b64 v1, v[60:61] offset:25664
v_mfma_f32_16x16x32_bf16 v[168:171], v[248:251], v[188:191], v[168:171]
ds_read_b128 v[188:191], v252 offset:20352
s_barrier
s_waitcnt vmcnt(13)
s_waitcnt lgkmcnt(6)
v_mfma_f32_16x16x32_bf16 v[88:91], v[192:195], v[172:175], v[88:91]
s_mov_b32 s34, 786432
v_mfma_f32_16x16x32_bf16 v[92:95], v[196:199], v[172:175], v[92:95]
buffer_load_dwordx4 v[240:243], v255, s[12:15], s34 offen offset:0 sc1
v_mfma_f32_16x16x32_bf16 v[96:99], v[200:203], v[172:175], v[96:99]
ds_read_b128 v[172:175], v252 offset:21376
v_mfma_f32_16x16x32_bf16 v[100:103], v[192:195], v[176:179], v[100:103]
v_cvt_pk_bf16_f32 v64, v64, v65
v_cvt_pk_bf16_f32 v65, v66, v67
v_mfma_f32_16x16x32_bf16 v[104:107], v[196:199], v[176:179], v[104:107]
buffer_load_dwordx4 v[244:247], v255, s[12:15], s34 offen offset:1024 sc1
v_mfma_f32_16x16x32_bf16 v[108:111], v[200:203], v[176:179], v[108:111]
ds_read_b128 v[176:179], v252 offset:22400
s_waitcnt lgkmcnt(5)
v_mfma_f32_16x16x32_bf16 v[112:115], v[192:195], v[180:183], v[112:115]
buffer_load_dwordx4 v[248:251], v255, s[12:15], s34 offen offset:2048 sc1
v_mfma_f32_16x16x32_bf16 v[116:119], v[196:199], v[180:183], v[116:119]
v_cvt_pk_bf16_f32 v68, v68, v69
v_mfma_f32_16x16x32_bf16 v[120:123], v[200:203], v[180:183], v[120:123]
ds_read_b128 v[180:183], v253 offset:16256
v_mfma_f32_16x16x32_bf16 v[124:127], v[192:195], v[184:187], v[124:127]
v_cvt_pk_bf16_f32 v69, v70, v71
v_mfma_f32_16x16x32_bf16 v[128:131], v[196:199], v[184:187], v[128:131]
v_cvt_pk_bf16_f32 v72, v72, v73
v_mfma_f32_16x16x32_bf16 v[132:135], v[200:203], v[184:187], v[132:135]
ds_read_b128 v[184:187], v253 offset:17280
s_waitcnt lgkmcnt(3)
v_mfma_f32_16x16x32_bf16 v[136:139], v[192:195], v[188:191], v[136:139]
s_mov_b32 s35, 872448
v_mfma_f32_16x16x32_bf16 v[140:143], v[196:199], v[188:191], v[140:143]
buffer_load_dwordx4 v[20:23], v255, s[12:15], s35 offen offset:1024 sc1
v_mfma_f32_16x16x32_bf16 v[144:147], v[200:203], v[188:191], v[144:147]
ds_read_b128 v[188:191], v253 offset:18304
v_mfma_f32_16x16x32_bf16 v[148:151], v[192:195], v[172:175], v[148:151]
v_cvt_pk_bf16_f32 v73, v74, v75
v_mfma_f32_16x16x32_bf16 v[152:155], v[196:199], v[172:175], v[152:155]
ds_write_b64 v1, v[64:65] offset:32000
v_mfma_f32_16x16x32_bf16 v[156:159], v[200:203], v[172:175], v[156:159]
ds_read_b128 v[172:175], v253 offset:19328
s_waitcnt lgkmcnt(4)
v_mfma_f32_16x16x32_bf16 v[160:163], v[192:195], v[176:179], v[160:163]
ds_write_b64 v1, v[68:69] offset:32032
v_mfma_f32_16x16x32_bf16 v[164:167], v[196:199], v[176:179], v[164:167]
ds_write_b64 v1, v[72:73] offset:32064
v_mfma_f32_16x16x32_bf16 v[168:171], v[200:203], v[176:179], v[168:171]
ds_read_b128 v[176:179], v253 offset:20352
s_waitcnt vmcnt(13)
v_mfma_f32_16x16x32_bf16 v[88:91], v[204:207], v[180:183], v[88:91]
s_mov_b32 s37, 798720
v_mfma_f32_16x16x32_bf16 v[92:95], v[208:211], v[180:183], v[92:95]
buffer_load_dwordx4 v[192:195], v255, s[12:15], s37 offen offset:0 sc1
v_mfma_f32_16x16x32_bf16 v[96:99], v[212:215], v[180:183], v[96:99]
ds_read_b128 v[180:183], v253 offset:21376
s_waitcnt lgkmcnt(6)
v_mfma_f32_16x16x32_bf16 v[100:103], v[204:207], v[184:187], v[100:103]
v_cvt_pk_bf16_f32 v76, v76, v77
v_cvt_pk_bf16_f32 v77, v78, v79
v_mfma_f32_16x16x32_bf16 v[104:107], v[208:211], v[184:187], v[104:107]
buffer_load_dwordx4 v[196:199], v255, s[12:15], s37 offen offset:1024 sc1
v_mfma_f32_16x16x32_bf16 v[108:111], v[212:215], v[184:187], v[108:111]
ds_read_b128 v[184:187], v253 offset:22400
v_mfma_f32_16x16x32_bf16 v[112:115], v[204:207], v[188:191], v[112:115]
buffer_load_dwordx4 v[200:203], v255, s[12:15], s37 offen offset:2048 sc1
v_mfma_f32_16x16x32_bf16 v[116:119], v[208:211], v[188:191], v[116:119]
v_cvt_pk_bf16_f32 v80, v80, v81
v_mfma_f32_16x16x32_bf16 v[120:123], v[212:215], v[188:191], v[120:123]
ds_read_b128 v[188:191], v254 offset:16256
s_waitcnt lgkmcnt(3)
v_mfma_f32_16x16x32_bf16 v[124:127], v[204:207], v[172:175], v[124:127]
v_cvt_pk_bf16_f32 v81, v82, v83
v_mfma_f32_16x16x32_bf16 v[128:131], v[208:211], v[172:175], v[128:131]
v_cvt_pk_bf16_f32 v84, v84, v85
v_mfma_f32_16x16x32_bf16 v[132:135], v[212:215], v[172:175], v[132:135]
ds_read_b128 v[172:175], v254 offset:17280
v_mfma_f32_16x16x32_bf16 v[136:139], v[204:207], v[176:179], v[136:139]
s_mov_b32 s35, 872448
v_mfma_f32_16x16x32_bf16 v[140:143], v[208:211], v[176:179], v[140:143]
buffer_load_dwordx4 v[24:27], v255, s[12:15], s35 offen offset:2048 sc1
v_mfma_f32_16x16x32_bf16 v[144:147], v[212:215], v[176:179], v[144:147]
ds_read_b128 v[176:179], v254 offset:18304
s_waitcnt lgkmcnt(3)
v_mfma_f32_16x16x32_bf16 v[148:151], v[204:207], v[180:183], v[148:151]
v_cvt_pk_bf16_f32 v85, v86, v87
v_mfma_f32_16x16x32_bf16 v[152:155], v[208:211], v[180:183], v[152:155]
ds_write_b64 v1, v[76:77] offset:38400
v_mfma_f32_16x16x32_bf16 v[156:159], v[212:215], v[180:183], v[156:159]
ds_read_b128 v[180:183], v254 offset:19328
v_mfma_f32_16x16x32_bf16 v[160:163], v[204:207], v[184:187], v[160:163]
ds_write_b64 v1, v[80:81] offset:38432
v_mfma_f32_16x16x32_bf16 v[164:167], v[208:211], v[184:187], v[164:167]
ds_write_b64 v1, v[84:85] offset:38464
v_mfma_f32_16x16x32_bf16 v[168:171], v[212:215], v[184:187], v[168:171]
ds_read_b128 v[184:187], v254 offset:20352
s_barrier
s_waitcnt vmcnt(13)
s_waitcnt lgkmcnt(6)
v_mfma_f32_16x16x32_bf16 v[88:91], v[216:219], v[188:191], v[88:91]
s_mov_b32 s34, 811008
v_mfma_f32_16x16x32_bf16 v[92:95], v[220:223], v[188:191], v[92:95]
buffer_load_dwordx4 v[204:207], v255, s[12:15], s34 offen offset:0 sc1
v_mfma_f32_16x16x32_bf16 v[96:99], v[224:227], v[188:191], v[96:99]
ds_read_b128 v[188:191], v254 offset:21376
v_mfma_f32_16x16x32_bf16 v[100:103], v[216:219], v[172:175], v[100:103]
v_mfma_f32_16x16x32_bf16 v[104:107], v[220:223], v[172:175], v[104:107]
buffer_load_dwordx4 v[208:211], v255, s[12:15], s34 offen offset:1024 sc1
v_mfma_f32_16x16x32_bf16 v[108:111], v[224:227], v[172:175], v[108:111]
ds_read_b128 v[172:175], v254 offset:22400
s_waitcnt lgkmcnt(5)
v_mfma_f32_16x16x32_bf16 v[112:115], v[216:219], v[176:179], v[112:115]
buffer_load_dwordx4 v[212:215], v255, s[12:15], s34 offen offset:2048 sc1
v_mfma_f32_16x16x32_bf16 v[116:119], v[220:223], v[176:179], v[116:119]
v_mfma_f32_16x16x32_bf16 v[120:123], v[224:227], v[176:179], v[120:123]
ds_read_b128 v[176:179], v252 offset:24384
v_mfma_f32_16x16x32_bf16 v[124:127], v[216:219], v[180:183], v[124:127]
v_mfma_f32_16x16x32_bf16 v[128:131], v[220:223], v[180:183], v[128:131]
v_mfma_f32_16x16x32_bf16 v[132:135], v[224:227], v[180:183], v[132:135]
ds_read_b128 v[180:183], v252 offset:25408
s_waitcnt lgkmcnt(3)
v_mfma_f32_16x16x32_bf16 v[136:139], v[216:219], v[184:187], v[136:139]
v_mfma_f32_16x16x32_bf16 v[140:143], v[220:223], v[184:187], v[140:143]
v_mfma_f32_16x16x32_bf16 v[144:147], v[224:227], v[184:187], v[144:147]
ds_read_b128 v[184:187], v252 offset:26432
v_mfma_f32_16x16x32_bf16 v[148:151], v[216:219], v[188:191], v[148:151]
v_mfma_f32_16x16x32_bf16 v[152:155], v[220:223], v[188:191], v[152:155]
v_mfma_f32_16x16x32_bf16 v[156:159], v[224:227], v[188:191], v[156:159]
ds_read_b128 v[188:191], v252 offset:27456
s_waitcnt lgkmcnt(3)
v_mfma_f32_16x16x32_bf16 v[160:163], v[216:219], v[172:175], v[160:163]
v_mfma_f32_16x16x32_bf16 v[164:167], v[220:223], v[172:175], v[164:167]
v_mfma_f32_16x16x32_bf16 v[168:171], v[224:227], v[172:175], v[168:171]
ds_read_b128 v[172:175], v252 offset:28480
s_barrier
s_waitcnt vmcnt(12)
v_mfma_f32_16x16x32_bf16 v[88:91], v[228:231], v[176:179], v[88:91]
s_mov_b32 s37, 823296
v_mfma_f32_16x16x32_bf16 v[92:95], v[232:235], v[176:179], v[92:95]
buffer_load_dwordx4 v[216:219], v255, s[12:15], s37 offen offset:0 sc1
v_mfma_f32_16x16x32_bf16 v[96:99], v[236:239], v[176:179], v[96:99]
ds_read_b128 v[176:179], v252 offset:29504
s_waitcnt lgkmcnt(3)
v_mfma_f32_16x16x32_bf16 v[100:103], v[228:231], v[180:183], v[100:103]
v_mfma_f32_16x16x32_bf16 v[104:107], v[232:235], v[180:183], v[104:107]
buffer_load_dwordx4 v[220:223], v255, s[12:15], s37 offen offset:1024 sc1
v_mfma_f32_16x16x32_bf16 v[108:111], v[236:239], v[180:183], v[108:111]
ds_read_b128 v[180:183], v252 offset:30528
v_mfma_f32_16x16x32_bf16 v[112:115], v[228:231], v[184:187], v[112:115]
buffer_load_dwordx4 v[224:227], v255, s[12:15], s37 offen offset:2048 sc1
v_mfma_f32_16x16x32_bf16 v[116:119], v[232:235], v[184:187], v[116:119]
v_mfma_f32_16x16x32_bf16 v[120:123], v[236:239], v[184:187], v[120:123]
ds_read_b128 v[184:187], v253 offset:24384
s_waitcnt lgkmcnt(3)
v_mfma_f32_16x16x32_bf16 v[124:127], v[228:231], v[188:191], v[124:127]
v_mfma_f32_16x16x32_bf16 v[128:131], v[232:235], v[188:191], v[128:131]
v_mfma_f32_16x16x32_bf16 v[132:135], v[236:239], v[188:191], v[132:135]
ds_read_b128 v[188:191], v253 offset:25408
v_mfma_f32_16x16x32_bf16 v[136:139], v[228:231], v[172:175], v[136:139]
v_mfma_f32_16x16x32_bf16 v[140:143], v[232:235], v[172:175], v[140:143]
v_mfma_f32_16x16x32_bf16 v[144:147], v[236:239], v[172:175], v[144:147]
ds_read_b128 v[172:175], v253 offset:26432
s_waitcnt lgkmcnt(3)
v_mfma_f32_16x16x32_bf16 v[148:151], v[228:231], v[176:179], v[148:151]
v_mfma_f32_16x16x32_bf16 v[152:155], v[232:235], v[176:179], v[152:155]
v_mfma_f32_16x16x32_bf16 v[156:159], v[236:239], v[176:179], v[156:159]
ds_read_b128 v[176:179], v253 offset:27456
v_mfma_f32_16x16x32_bf16 v[160:163], v[228:231], v[180:183], v[160:163]
v_mfma_f32_16x16x32_bf16 v[164:167], v[232:235], v[180:183], v[164:167]
v_mfma_f32_16x16x32_bf16 v[168:171], v[236:239], v[180:183], v[168:171]
ds_read_b128 v[180:183], v253 offset:28480
s_waitcnt vmcnt(11)
s_waitcnt lgkmcnt(3)
v_mfma_f32_16x16x32_bf16 v[88:91], v[240:243], v[184:187], v[88:91]
s_mov_b32 s34, 835584
v_mfma_f32_16x16x32_bf16 v[92:95], v[244:247], v[184:187], v[92:95]
buffer_load_dwordx4 v[228:231], v255, s[12:15], s34 offen offset:0 sc1
v_mfma_f32_16x16x32_bf16 v[96:99], v[248:251], v[184:187], v[96:99]
ds_read_b128 v[184:187], v253 offset:29504
v_mfma_f32_16x16x32_bf16 v[100:103], v[240:243], v[188:191], v[100:103]
v_mfma_f32_16x16x32_bf16 v[104:107], v[244:247], v[188:191], v[104:107]
buffer_load_dwordx4 v[232:235], v255, s[12:15], s34 offen offset:1024 sc1
v_mfma_f32_16x16x32_bf16 v[108:111], v[248:251], v[188:191], v[108:111]
ds_read_b128 v[188:191], v253 offset:30528
s_waitcnt lgkmcnt(3)
v_mfma_f32_16x16x32_bf16 v[112:115], v[240:243], v[172:175], v[112:115]
buffer_load_dwordx4 v[236:239], v255, s[12:15], s34 offen offset:2048 sc1
v_mfma_f32_16x16x32_bf16 v[116:119], v[244:247], v[172:175], v[116:119]
v_mfma_f32_16x16x32_bf16 v[120:123], v[248:251], v[172:175], v[120:123]
ds_read_b128 v[172:175], v254 offset:24384
v_mfma_f32_16x16x32_bf16 v[124:127], v[240:243], v[176:179], v[124:127]
v_mfma_f32_16x16x32_bf16 v[128:131], v[244:247], v[176:179], v[128:131]
v_mfma_f32_16x16x32_bf16 v[132:135], v[248:251], v[176:179], v[132:135]
ds_read_b128 v[176:179], v254 offset:25408
s_waitcnt lgkmcnt(3)
v_mfma_f32_16x16x32_bf16 v[136:139], v[240:243], v[180:183], v[136:139]
v_mfma_f32_16x16x32_bf16 v[140:143], v[244:247], v[180:183], v[140:143]
v_mfma_f32_16x16x32_bf16 v[144:147], v[248:251], v[180:183], v[144:147]
ds_read_b128 v[180:183], v254 offset:26432
v_mfma_f32_16x16x32_bf16 v[148:151], v[240:243], v[184:187], v[148:151]
v_mfma_f32_16x16x32_bf16 v[152:155], v[244:247], v[184:187], v[152:155]
v_mfma_f32_16x16x32_bf16 v[156:159], v[248:251], v[184:187], v[156:159]
ds_read_b128 v[184:187], v254 offset:27456
s_waitcnt lgkmcnt(3)
v_mfma_f32_16x16x32_bf16 v[160:163], v[240:243], v[188:191], v[160:163]
v_mfma_f32_16x16x32_bf16 v[164:167], v[244:247], v[188:191], v[164:167]
v_mfma_f32_16x16x32_bf16 v[168:171], v[248:251], v[188:191], v[168:171]
ds_read_b128 v[188:191], v254 offset:28480
s_waitcnt vmcnt(10)
v_mfma_f32_16x16x32_bf16 v[88:91], v[192:195], v[172:175], v[88:91]
s_mov_b32 s37, 847872
v_mfma_f32_16x16x32_bf16 v[92:95], v[196:199], v[172:175], v[92:95]
buffer_load_dwordx4 v[240:243], v255, s[12:15], s37 offen offset:0 sc1
v_mfma_f32_16x16x32_bf16 v[96:99], v[200:203], v[172:175], v[96:99]
ds_read_b128 v[172:175], v254 offset:29504
s_waitcnt lgkmcnt(3)
v_mfma_f32_16x16x32_bf16 v[100:103], v[192:195], v[176:179], v[100:103]
v_mfma_f32_16x16x32_bf16 v[104:107], v[196:199], v[176:179], v[104:107]
buffer_load_dwordx4 v[244:247], v255, s[12:15], s37 offen offset:1024 sc1
v_mfma_f32_16x16x32_bf16 v[108:111], v[200:203], v[176:179], v[108:111]
ds_read_b128 v[176:179], v254 offset:30528
v_mfma_f32_16x16x32_bf16 v[112:115], v[192:195], v[180:183], v[112:115]
buffer_load_dwordx4 v[248:251], v255, s[12:15], s37 offen offset:2048 sc1
v_mfma_f32_16x16x32_bf16 v[116:119], v[196:199], v[180:183], v[116:119]
v_mfma_f32_16x16x32_bf16 v[120:123], v[200:203], v[180:183], v[120:123]
ds_read_b128 v[180:183], v252 offset:32512
s_waitcnt lgkmcnt(3)
v_mfma_f32_16x16x32_bf16 v[124:127], v[192:195], v[184:187], v[124:127]
v_mfma_f32_16x16x32_bf16 v[128:131], v[196:199], v[184:187], v[128:131]
v_mfma_f32_16x16x32_bf16 v[132:135], v[200:203], v[184:187], v[132:135]
ds_read_b128 v[184:187], v253 offset:32512
v_mfma_f32_16x16x32_bf16 v[136:139], v[192:195], v[188:191], v[136:139]
v_mfma_f32_16x16x32_bf16 v[140:143], v[196:199], v[188:191], v[140:143]
v_mfma_f32_16x16x32_bf16 v[144:147], v[200:203], v[188:191], v[144:147]
ds_read_b128 v[188:191], v254 offset:32512
s_waitcnt lgkmcnt(3)
v_mfma_f32_16x16x32_bf16 v[148:151], v[192:195], v[172:175], v[148:151]
v_mfma_f32_16x16x32_bf16 v[152:155], v[196:199], v[172:175], v[152:155]
v_mfma_f32_16x16x32_bf16 v[156:159], v[200:203], v[172:175], v[156:159]
ds_read_b128 v[172:175], v252 offset:40640
v_mfma_f32_16x16x32_bf16 v[160:163], v[192:195], v[176:179], v[160:163]
v_mfma_f32_16x16x32_bf16 v[164:167], v[196:199], v[176:179], v[164:167]
v_mfma_f32_16x16x32_bf16 v[168:171], v[200:203], v[176:179], v[168:171]
ds_read_b128 v[176:179], v253 offset:40640
s_waitcnt vmcnt(9)
s_waitcnt lgkmcnt(3)
v_add_u32 v1, 97536, v1
v_mfma_f32_16x16x32_bf16 v[88:91], v[204:207], v[180:183], v[88:91]
v_mfma_f32_16x16x32_bf16 v[92:95], v[208:211], v[180:183], v[92:95]
v_mfma_f32_16x16x32_bf16 v[96:99], v[212:215], v[180:183], v[96:99]
ds_read_b128 v[180:183], v254 offset:40640
s_waitcnt vmcnt(6)
v_mfma_f32_16x16x32_bf16 v[88:91], v[216:219], v[184:187], v[88:91]
v_mfma_f32_16x16x32_bf16 v[92:95], v[220:223], v[184:187], v[92:95]
v_mfma_f32_16x16x32_bf16 v[96:99], v[224:227], v[184:187], v[96:99]
ds_read_b128 v[184:187], v252 offset:33536
s_waitcnt vmcnt(3)
s_waitcnt lgkmcnt(3)
v_mfma_f32_16x16x32_bf16 v[88:91], v[228:231], v[188:191], v[88:91]
v_mfma_f32_16x16x32_bf16 v[92:95], v[232:235], v[188:191], v[92:95]
v_mfma_f32_16x16x32_bf16 v[96:99], v[236:239], v[188:191], v[96:99]
ds_read_b128 v[188:191], v253 offset:33536
s_waitcnt vmcnt(0)
v_mfma_f32_16x16x32_bf16 v[88:91], v[240:243], v[172:175], v[88:91]
v_mfma_f32_16x16x32_bf16 v[92:95], v[244:247], v[172:175], v[92:95]
v_mfma_f32_16x16x32_bf16 v[96:99], v[248:251], v[172:175], v[96:99]
ds_read_b128 v[172:175], v254 offset:33536
s_waitcnt lgkmcnt(3)
v_mfma_f32_16x16x32_bf16 v[88:91], v[4:7], v[176:179], v[88:91]
v_mfma_f32_16x16x32_bf16 v[92:95], v[8:11], v[176:179], v[92:95]
v_mfma_f32_16x16x32_bf16 v[96:99], v[12:15], v[176:179], v[96:99]
ds_read_b128 v[176:179], v252 offset:41664
v_mfma_f32_16x16x32_bf16 v[88:91], v[16:19], v[180:183], v[88:91]
v_mfma_f32_16x16x32_bf16 v[92:95], v[20:23], v[180:183], v[92:95]
v_mfma_f32_16x16x32_bf16 v[96:99], v[24:27], v[180:183], v[96:99]
ds_read_b128 v[180:183], v253 offset:41664
s_waitcnt lgkmcnt(3)
v_mfma_f32_16x16x32_bf16 v[100:103], v[204:207], v[184:187], v[100:103]
v_mfma_f32_16x16x32_bf16 v[104:107], v[208:211], v[184:187], v[104:107]
v_mfma_f32_16x16x32_bf16 v[108:111], v[212:215], v[184:187], v[108:111]
ds_read_b128 v[184:187], v254 offset:41664
v_mfma_f32_16x16x32_bf16 v[100:103], v[216:219], v[188:191], v[100:103]
v_mfma_f32_16x16x32_bf16 v[104:107], v[220:223], v[188:191], v[104:107]
v_mfma_f32_16x16x32_bf16 v[108:111], v[224:227], v[188:191], v[108:111]
ds_read_b128 v[188:191], v252 offset:34560
s_waitcnt lgkmcnt(3)
v_mfma_f32_16x16x32_bf16 v[100:103], v[228:231], v[172:175], v[100:103]
v_cvt_pk_bf16_f32 v88, v88, v89
v_mfma_f32_16x16x32_bf16 v[104:107], v[232:235], v[172:175], v[104:107]
v_cvt_pk_bf16_f32 v89, v90, v91
v_mfma_f32_16x16x32_bf16 v[108:111], v[236:239], v[172:175], v[108:111]
ds_read_b128 v[172:175], v253 offset:34560
v_mfma_f32_16x16x32_bf16 v[100:103], v[240:243], v[176:179], v[100:103]
v_cvt_pk_bf16_f32 v92, v92, v93
v_mfma_f32_16x16x32_bf16 v[104:107], v[244:247], v[176:179], v[104:107]
v_cvt_pk_bf16_f32 v93, v94, v95
v_mfma_f32_16x16x32_bf16 v[108:111], v[248:251], v[176:179], v[108:111]
ds_read_b128 v[176:179], v254 offset:34560
s_waitcnt lgkmcnt(3)
v_mfma_f32_16x16x32_bf16 v[100:103], v[4:7], v[180:183], v[100:103]
v_cvt_pk_bf16_f32 v96, v96, v97
v_mfma_f32_16x16x32_bf16 v[104:107], v[8:11], v[180:183], v[104:107]
v_cvt_pk_bf16_f32 v97, v98, v99
ds_write_b64 v1, v[88:89] offset:0
v_mfma_f32_16x16x32_bf16 v[108:111], v[12:15], v[180:183], v[108:111]
ds_read_b128 v[180:183], v252 offset:42688
ds_write_b64 v1, v[92:93] offset:32
ds_write_b64 v1, v[96:97] offset:64
v_mfma_f32_16x16x32_bf16 v[100:103], v[16:19], v[184:187], v[100:103]
v_mfma_f32_16x16x32_bf16 v[104:107], v[20:23], v[184:187], v[104:107]
v_mfma_f32_16x16x32_bf16 v[108:111], v[24:27], v[184:187], v[108:111]
ds_read_b128 v[184:187], v253 offset:42688
s_waitcnt lgkmcnt(6)
v_mfma_f32_16x16x32_bf16 v[112:115], v[204:207], v[188:191], v[112:115]
v_mfma_f32_16x16x32_bf16 v[116:119], v[208:211], v[188:191], v[116:119]
v_mfma_f32_16x16x32_bf16 v[120:123], v[212:215], v[188:191], v[120:123]
ds_read_b128 v[188:191], v254 offset:42688
v_mfma_f32_16x16x32_bf16 v[112:115], v[216:219], v[172:175], v[112:115]
v_mfma_f32_16x16x32_bf16 v[116:119], v[220:223], v[172:175], v[116:119]
v_mfma_f32_16x16x32_bf16 v[120:123], v[224:227], v[172:175], v[120:123]
ds_read_b128 v[172:175], v252 offset:35584
s_waitcnt lgkmcnt(5)
v_mfma_f32_16x16x32_bf16 v[112:115], v[228:231], v[176:179], v[112:115]
v_cvt_pk_bf16_f32 v100, v100, v101
v_mfma_f32_16x16x32_bf16 v[116:119], v[232:235], v[176:179], v[116:119]
v_cvt_pk_bf16_f32 v101, v102, v103
v_mfma_f32_16x16x32_bf16 v[120:123], v[236:239], v[176:179], v[120:123]
ds_read_b128 v[176:179], v253 offset:35584
v_mfma_f32_16x16x32_bf16 v[112:115], v[240:243], v[180:183], v[112:115]
v_cvt_pk_bf16_f32 v104, v104, v105
v_mfma_f32_16x16x32_bf16 v[116:119], v[244:247], v[180:183], v[116:119]
v_cvt_pk_bf16_f32 v105, v106, v107
v_mfma_f32_16x16x32_bf16 v[120:123], v[248:251], v[180:183], v[120:123]
ds_read_b128 v[180:183], v254 offset:35584
s_waitcnt lgkmcnt(3)
v_mfma_f32_16x16x32_bf16 v[112:115], v[4:7], v[184:187], v[112:115]
v_cvt_pk_bf16_f32 v108, v108, v109
v_mfma_f32_16x16x32_bf16 v[116:119], v[8:11], v[184:187], v[116:119]
v_cvt_pk_bf16_f32 v109, v110, v111
ds_write_b64 v1, v[100:101] offset:6400
v_mfma_f32_16x16x32_bf16 v[120:123], v[12:15], v[184:187], v[120:123]
ds_read_b128 v[184:187], v252 offset:43712
ds_write_b64 v1, v[104:105] offset:6432
ds_write_b64 v1, v[108:109] offset:6464
v_mfma_f32_16x16x32_bf16 v[112:115], v[16:19], v[188:191], v[112:115]
v_mfma_f32_16x16x32_bf16 v[116:119], v[20:23], v[188:191], v[116:119]
v_mfma_f32_16x16x32_bf16 v[120:123], v[24:27], v[188:191], v[120:123]
ds_read_b128 v[188:191], v253 offset:43712
s_waitcnt lgkmcnt(1)
s_barrier
v_mfma_f32_16x16x32_bf16 v[124:127], v[204:207], v[172:175], v[124:127]
v_mfma_f32_16x16x32_bf16 v[128:131], v[208:211], v[172:175], v[128:131]
v_mfma_f32_16x16x32_bf16 v[132:135], v[212:215], v[172:175], v[132:135]
ds_read_b128 v[172:175], v254 offset:43712
v_mfma_f32_16x16x32_bf16 v[124:127], v[216:219], v[176:179], v[124:127]
v_mfma_f32_16x16x32_bf16 v[128:131], v[220:223], v[176:179], v[128:131]
v_mfma_f32_16x16x32_bf16 v[132:135], v[224:227], v[176:179], v[132:135]
ds_read_b128 v[176:179], v252 offset:36608
v_mfma_f32_16x16x32_bf16 v[124:127], v[228:231], v[180:183], v[124:127]
v_cvt_pk_bf16_f32 v112, v112, v113
v_mfma_f32_16x16x32_bf16 v[128:131], v[232:235], v[180:183], v[128:131]
v_cvt_pk_bf16_f32 v113, v114, v115
v_mfma_f32_16x16x32_bf16 v[132:135], v[236:239], v[180:183], v[132:135]
ds_read_b128 v[180:183], v253 offset:36608
v_mfma_f32_16x16x32_bf16 v[124:127], v[240:243], v[184:187], v[124:127]
v_cvt_pk_bf16_f32 v116, v116, v117
v_mfma_f32_16x16x32_bf16 v[128:131], v[244:247], v[184:187], v[128:131]
v_cvt_pk_bf16_f32 v117, v118, v119
v_mfma_f32_16x16x32_bf16 v[132:135], v[248:251], v[184:187], v[132:135]
ds_read_b128 v[184:187], v254 offset:36608
s_waitcnt lgkmcnt(3)
v_mfma_f32_16x16x32_bf16 v[124:127], v[4:7], v[188:191], v[124:127]
v_cvt_pk_bf16_f32 v120, v120, v121
v_mfma_f32_16x16x32_bf16 v[128:131], v[8:11], v[188:191], v[128:131]
v_cvt_pk_bf16_f32 v121, v122, v123
ds_write_b64 v1, v[112:113] offset:12800
v_mfma_f32_16x16x32_bf16 v[132:135], v[12:15], v[188:191], v[132:135]
ds_read_b128 v[188:191], v252 offset:44736
ds_write_b64 v1, v[116:117] offset:12832
ds_write_b64 v1, v[120:121] offset:12864
v_mfma_f32_16x16x32_bf16 v[124:127], v[16:19], v[172:175], v[124:127]
v_mfma_f32_16x16x32_bf16 v[128:131], v[20:23], v[172:175], v[128:131]
v_mfma_f32_16x16x32_bf16 v[132:135], v[24:27], v[172:175], v[132:135]
ds_read_b128 v[172:175], v253 offset:44736
s_waitcnt lgkmcnt(6)
v_mfma_f32_16x16x32_bf16 v[136:139], v[204:207], v[176:179], v[136:139]
v_mfma_f32_16x16x32_bf16 v[140:143], v[208:211], v[176:179], v[140:143]
v_mfma_f32_16x16x32_bf16 v[144:147], v[212:215], v[176:179], v[144:147]
ds_read_b128 v[176:179], v254 offset:44736
v_mfma_f32_16x16x32_bf16 v[136:139], v[216:219], v[180:183], v[136:139]
v_mfma_f32_16x16x32_bf16 v[140:143], v[220:223], v[180:183], v[140:143]
v_mfma_f32_16x16x32_bf16 v[144:147], v[224:227], v[180:183], v[144:147]
ds_read_b128 v[180:183], v252 offset:37632
s_waitcnt lgkmcnt(5)
v_mfma_f32_16x16x32_bf16 v[136:139], v[228:231], v[184:187], v[136:139]
v_cvt_pk_bf16_f32 v124, v124, v125
v_mfma_f32_16x16x32_bf16 v[140:143], v[232:235], v[184:187], v[140:143]
v_cvt_pk_bf16_f32 v125, v126, v127
v_mfma_f32_16x16x32_bf16 v[144:147], v[236:239], v[184:187], v[144:147]
ds_read_b128 v[184:187], v253 offset:37632
v_mfma_f32_16x16x32_bf16 v[136:139], v[240:243], v[188:191], v[136:139]
v_cvt_pk_bf16_f32 v128, v128, v129
v_mfma_f32_16x16x32_bf16 v[140:143], v[244:247], v[188:191], v[140:143]
v_cvt_pk_bf16_f32 v129, v130, v131
v_mfma_f32_16x16x32_bf16 v[144:147], v[248:251], v[188:191], v[144:147]
ds_read_b128 v[188:191], v254 offset:37632
s_waitcnt lgkmcnt(3)
v_mfma_f32_16x16x32_bf16 v[136:139], v[4:7], v[172:175], v[136:139]
v_cvt_pk_bf16_f32 v132, v132, v133
v_mfma_f32_16x16x32_bf16 v[140:143], v[8:11], v[172:175], v[140:143]
v_cvt_pk_bf16_f32 v133, v134, v135
ds_write_b64 v1, v[124:125] offset:19200
v_mfma_f32_16x16x32_bf16 v[144:147], v[12:15], v[172:175], v[144:147]
ds_read_b128 v[172:175], v252 offset:45760
ds_write_b64 v1, v[128:129] offset:19232
ds_write_b64 v1, v[132:133] offset:19264
v_mfma_f32_16x16x32_bf16 v[136:139], v[16:19], v[176:179], v[136:139]
v_mfma_f32_16x16x32_bf16 v[140:143], v[20:23], v[176:179], v[140:143]
v_mfma_f32_16x16x32_bf16 v[144:147], v[24:27], v[176:179], v[144:147]
ds_read_b128 v[176:179], v253 offset:45760
s_waitcnt lgkmcnt(1)
s_barrier
v_mfma_f32_16x16x32_bf16 v[148:151], v[204:207], v[180:183], v[148:151]
v_mfma_f32_16x16x32_bf16 v[152:155], v[208:211], v[180:183], v[152:155]
v_mfma_f32_16x16x32_bf16 v[156:159], v[212:215], v[180:183], v[156:159]
ds_read_b128 v[180:183], v254 offset:45760
v_mfma_f32_16x16x32_bf16 v[148:151], v[216:219], v[184:187], v[148:151]
v_mfma_f32_16x16x32_bf16 v[152:155], v[220:223], v[184:187], v[152:155]
v_mfma_f32_16x16x32_bf16 v[156:159], v[224:227], v[184:187], v[156:159]
ds_read_b128 v[184:187], v252 offset:38656
v_mfma_f32_16x16x32_bf16 v[148:151], v[228:231], v[188:191], v[148:151]
v_cvt_pk_bf16_f32 v136, v136, v137
v_mfma_f32_16x16x32_bf16 v[152:155], v[232:235], v[188:191], v[152:155]
v_cvt_pk_bf16_f32 v137, v138, v139
v_mfma_f32_16x16x32_bf16 v[156:159], v[236:239], v[188:191], v[156:159]
ds_read_b128 v[188:191], v253 offset:38656
v_mfma_f32_16x16x32_bf16 v[148:151], v[240:243], v[172:175], v[148:151]
v_cvt_pk_bf16_f32 v140, v140, v141
v_mfma_f32_16x16x32_bf16 v[152:155], v[244:247], v[172:175], v[152:155]
v_cvt_pk_bf16_f32 v141, v142, v143
v_mfma_f32_16x16x32_bf16 v[156:159], v[248:251], v[172:175], v[156:159]
ds_read_b128 v[172:175], v254 offset:38656
s_waitcnt lgkmcnt(3)
v_mfma_f32_16x16x32_bf16 v[148:151], v[4:7], v[176:179], v[148:151]
v_cvt_pk_bf16_f32 v144, v144, v145
v_mfma_f32_16x16x32_bf16 v[152:155], v[8:11], v[176:179], v[152:155]
v_cvt_pk_bf16_f32 v145, v146, v147
ds_write_b64 v1, v[136:137] offset:25600
v_mfma_f32_16x16x32_bf16 v[156:159], v[12:15], v[176:179], v[156:159]
ds_read_b128 v[176:179], v252 offset:46784
ds_write_b64 v1, v[140:141] offset:25632
ds_write_b64 v1, v[144:145] offset:25664
v_mfma_f32_16x16x32_bf16 v[148:151], v[16:19], v[180:183], v[148:151]
v_mfma_f32_16x16x32_bf16 v[152:155], v[20:23], v[180:183], v[152:155]
v_mfma_f32_16x16x32_bf16 v[156:159], v[24:27], v[180:183], v[156:159]
ds_read_b128 v[180:183], v253 offset:46784
s_waitcnt lgkmcnt(6)
v_mfma_f32_16x16x32_bf16 v[160:163], v[204:207], v[184:187], v[160:163]
v_mfma_f32_16x16x32_bf16 v[164:167], v[208:211], v[184:187], v[164:167]
v_mfma_f32_16x16x32_bf16 v[168:171], v[212:215], v[184:187], v[168:171]
ds_read_b128 v[184:187], v254 offset:46784
v_mfma_f32_16x16x32_bf16 v[160:163], v[216:219], v[188:191], v[160:163]
v_mfma_f32_16x16x32_bf16 v[164:167], v[220:223], v[188:191], v[164:167]
v_mfma_f32_16x16x32_bf16 v[168:171], v[224:227], v[188:191], v[168:171]
v_cvt_pk_bf16_f32 v148, v148, v149
s_waitcnt lgkmcnt(4)
v_mfma_f32_16x16x32_bf16 v[160:163], v[228:231], v[172:175], v[160:163]
v_cvt_pk_bf16_f32 v149, v150, v151
v_mfma_f32_16x16x32_bf16 v[164:167], v[232:235], v[172:175], v[164:167]
v_cvt_pk_bf16_f32 v152, v152, v153
v_mfma_f32_16x16x32_bf16 v[168:171], v[236:239], v[172:175], v[168:171]
v_cvt_pk_bf16_f32 v153, v154, v155
v_mfma_f32_16x16x32_bf16 v[160:163], v[240:243], v[176:179], v[160:163]
v_cvt_pk_bf16_f32 v156, v156, v157
v_mfma_f32_16x16x32_bf16 v[164:167], v[244:247], v[176:179], v[164:167]
v_cvt_pk_bf16_f32 v157, v158, v159
v_mfma_f32_16x16x32_bf16 v[168:171], v[248:251], v[176:179], v[168:171]
ds_write_b64 v1, v[148:149] offset:32000
s_waitcnt lgkmcnt(1)
v_mfma_f32_16x16x32_bf16 v[160:163], v[4:7], v[180:183], v[160:163]
ds_write_b64 v1, v[152:153] offset:32032
v_mfma_f32_16x16x32_bf16 v[164:167], v[8:11], v[180:183], v[164:167]
ds_write_b64 v1, v[156:157] offset:32064
v_mfma_f32_16x16x32_bf16 v[168:171], v[12:15], v[180:183], v[168:171]
v_mfma_f32_16x16x32_bf16 v[160:163], v[16:19], v[184:187], v[160:163]
v_mfma_f32_16x16x32_bf16 v[164:167], v[20:23], v[184:187], v[164:167]
v_mfma_f32_16x16x32_bf16 v[168:171], v[24:27], v[184:187], v[168:171]
s_waitcnt lgkmcnt(0)
s_barrier
s_nop 7
v_cvt_pk_bf16_f32 v160, v160, v161
v_cvt_pk_bf16_f32 v161, v162, v163
v_cvt_pk_bf16_f32 v164, v164, v165
v_cvt_pk_bf16_f32 v165, v166, v167
v_cvt_pk_bf16_f32 v168, v168, v169
v_cvt_pk_bf16_f32 v169, v170, v171
ds_write_b64 v1, v[160:161] offset:38400
ds_write_b64 v1, v[164:165] offset:38432
ds_write_b64 v1, v[168:169] offset:38464
s_waitcnt lgkmcnt(0)
s_barrier
s_endpgm
L_producer:
s_sub_u32 s31, s3, 4
s_and_b32 s33, s31, 1
s_cmp_eq_u32 s33, 1
s_cbranch_scc1 L_prod_h1
s_setprio 3
s_mov_b32 s35, s30
v_lshrrev_b32 v228, 3, v0
v_and_b32 v229, 7, v0
s_lshr_b32 s32, s31, 1
s_lshl_b32 s33, s32, 3
v_add_u32 v230, s33, v228
s_sub_u32 s33, s29, 1
v_add_u32 v231, s33, v230
s_add_i32 s33, s30, 0
s_lshl_b32 s33, s33, 1
s_add_u32 s33, s33, s26
v_lshl_add_u32 v232, v231, 1, s25
v_mul_u32_u24 v232, 224, v232
v_add_u32 v232, s33, v232
v_mul_u32_u24 v232, 384, v232
v_lshl_add_u32 v232, v229, 4, v232
v_mov_b32 v234, 0x7ff00000
v_cmp_gt_u32 vcc, 112, v231
s_nop 1
v_cndmask_b32 v148, v234, v232, vcc
v_add_u32 v149, 3840, v148
s_cmp_eq_u32 s30, 0
s_cselect_b32 s33, 1, 0
v_mov_b32 v233, s33
v_subrev_u32 v150, 768, v148
v_cmp_eq_u32 vcc, 0, v233
s_nop 1
v_cndmask_b32 v150, v234, v150, vcc
s_waitcnt lgkmcnt(0)
s_mov_b32 s8, s4
s_mov_b32 s9, s5
s_mov_b32 s10, 19267584
s_mov_b32 s11, 0x20000
s_mov_b32 s72, s6
s_mov_b32 s73, s7
s_mov_b32 s74, 663552
s_mov_b32 s75, 0x20000
s_mov_b32 s12, s20
s_mov_b32 s13, s21
s_mov_b32 s14, 884736
s_mov_b32 s15, 0x20000
s_mov_b32 s16, s68
s_mov_b32 s17, s69
s_mov_b32 s18, 19267584
s_mov_b32 s19, 0x20000
s_mov_b32 s76, s70
s_mov_b32 s77, s71
s_mov_b32 s78, 256
s_mov_b32 s79, 0x20000
buffer_load_dwordx4 v[4:7], v150, s[8:11], 0 offen offset:0 nt
buffer_load_dwordx4 v[12:15], v148, s[8:11], 0 offen offset:768 nt
buffer_load_dwordx4 v[20:23], v148, s[8:11], 0 offen offset:2304 nt
buffer_load_dwordx4 v[28:31], v149, s[8:11], 0 offen offset:0 nt
buffer_load_dwordx4 v[36:39], v149, s[8:11], 0 offen offset:1536 nt
s_mov_b32 s30, 0xffff0000
v_mul_u32_u24 v235, 7, v230
v_add_u32 v235, 0, v235
v_bfe_u32 v233, v235, 2, 1
v_lshlrev_b32 v233, 1, v233
v_and_b32 v232, 3, v229
v_xor_b32 v233, v233, v232
v_lshlrev_b32 v233, 4, v233
v_lshl_add_u32 v233, v235, 6, v233
v_lshrrev_b32 v232, 2, v229
v_mul_u32_u24 v232, 8128, v232
v_add_u32 v152, v233, v232
v_add_u32 v156, 48768, v152
v_mul_u32_u24 v235, 7, v230
v_add_u32 v235, 1, v235
v_bfe_u32 v233, v235, 2, 1
v_lshlrev_b32 v233, 1, v233
v_and_b32 v232, 3, v229
v_xor_b32 v233, v233, v232
v_lshlrev_b32 v233, 4, v233
v_lshl_add_u32 v233, v235, 6, v233
v_lshrrev_b32 v232, 2, v229
v_mul_u32_u24 v232, 8128, v232
v_add_u32 v153, v233, v232
v_add_u32 v157, 48768, v153
v_mul_u32_u24 v235, 7, v230
v_add_u32 v235, 2, v235
v_bfe_u32 v233, v235, 2, 1
v_lshlrev_b32 v233, 1, v233
v_and_b32 v232, 3, v229
v_xor_b32 v233, v233, v232
v_lshlrev_b32 v233, 4, v233
v_lshl_add_u32 v233, v235, 6, v233
v_lshrrev_b32 v232, 2, v229
v_mul_u32_u24 v232, 8128, v232
v_add_u32 v154, v233, v232
v_add_u32 v158, 48768, v154
v_mul_u32_u24 v235, 7, v230
v_add_u32 v235, 3, v235
v_bfe_u32 v233, v235, 2, 1
v_lshlrev_b32 v233, 1, v233
v_and_b32 v232, 3, v229
v_xor_b32 v233, v233, v232
v_lshlrev_b32 v233, 4, v233
v_lshl_add_u32 v233, v235, 6, v233
v_lshrrev_b32 v232, 2, v229
v_mul_u32_u24 v232, 8128, v232
v_add_u32 v155, v233, v232
v_add_u32 v159, 48768, v155
s_waitcnt vmcnt(3)
v_lshlrev_b32 v124, 16, v4
v_and_b32 v125, s30, v4
v_lshlrev_b32 v126, 16, v5
v_and_b32 v127, s30, v5
v_lshlrev_b32 v128, 16, v6
v_and_b32 v129, s30, v6
v_lshlrev_b32 v130, 16, v7
v_and_b32 v131, s30, v7
v_lshlrev_b32 v132, 16, v12
v_and_b32 v133, s30, v12
v_lshlrev_b32 v134, 16, v13
v_and_b32 v135, s30, v13
v_lshlrev_b32 v136, 16, v14
v_and_b32 v137, s30, v14
v_lshlrev_b32 v138, 16, v15
v_and_b32 v139, s30, v15
v_sub_f32 v233, v124, v132
v_sub_f32 v234, v125, v133
v_cvt_pk_bf16_f32 v140, v233, v234
v_sub_f32 v233, v126, v134
v_sub_f32 v234, v127, v135
v_cvt_pk_bf16_f32 v141, v233, v234
v_sub_f32 v233, v128, v136
v_sub_f32 v234, v129, v137
v_cvt_pk_bf16_f32 v142, v233, v234
v_sub_f32 v233, v130, v138
v_sub_f32 v234, v131, v139
v_cvt_pk_bf16_f32 v143, v233, v234
ds_write_b128 v152, v[140:143] offset:0
s_waitcnt vmcnt(2)
v_lshlrev_b32 v124, 16, v20
v_and_b32 v125, s30, v20
v_lshlrev_b32 v126, 16, v21
v_and_b32 v127, s30, v21
v_lshlrev_b32 v128, 16, v22
v_and_b32 v129, s30, v22
v_lshlrev_b32 v130, 16, v23
v_and_b32 v131, s30, v23
v_sub_f32 v233, v132, v124
v_sub_f32 v234, v133, v125
v_cvt_pk_bf16_f32 v144, v233, v234
v_sub_f32 v233, v134, v126
v_sub_f32 v234, v135, v127
v_cvt_pk_bf16_f32 v145, v233, v234
v_sub_f32 v233, v136, v128
v_sub_f32 v234, v137, v129
v_cvt_pk_bf16_f32 v146, v233, v234
v_sub_f32 v233, v138, v130
v_sub_f32 v234, v139, v131
v_cvt_pk_bf16_f32 v147, v233, v234
ds_write_b128 v153, v[144:147] offset:0
s_waitcnt vmcnt(1)
v_lshlrev_b32 v132, 16, v28
v_and_b32 v133, s30, v28
v_lshlrev_b32 v134, 16, v29
v_and_b32 v135, s30, v29
v_lshlrev_b32 v136, 16, v30
v_and_b32 v137, s30, v30
v_lshlrev_b32 v138, 16, v31
v_and_b32 v139, s30, v31
v_sub_f32 v233, v124, v132
v_sub_f32 v234, v125, v133
v_cvt_pk_bf16_f32 v140, v233, v234
v_sub_f32 v233, v126, v134
v_sub_f32 v234, v127, v135
v_cvt_pk_bf16_f32 v141, v233, v234
v_sub_f32 v233, v128, v136
v_sub_f32 v234, v129, v137
v_cvt_pk_bf16_f32 v142, v233, v234
v_sub_f32 v233, v130, v138
v_sub_f32 v234, v131, v139
v_cvt_pk_bf16_f32 v143, v233, v234
ds_write_b128 v154, v[140:143] offset:0
s_waitcnt vmcnt(0)
v_lshlrev_b32 v124, 16, v36
v_and_b32 v125, s30, v36
v_lshlrev_b32 v126, 16, v37
v_and_b32 v127, s30, v37
v_lshlrev_b32 v128, 16, v38
v_and_b32 v129, s30, v38
v_lshlrev_b32 v130, 16, v39
v_and_b32 v131, s30, v39
v_sub_f32 v233, v132, v124
v_sub_f32 v234, v133, v125
v_cvt_pk_bf16_f32 v144, v233, v234
v_sub_f32 v233, v134, v126
v_sub_f32 v234, v135, v127
v_cvt_pk_bf16_f32 v145, v233, v234
v_sub_f32 v233, v136, v128
v_sub_f32 v234, v137, v129
v_cvt_pk_bf16_f32 v146, v233, v234
v_sub_f32 v233, v138, v130
v_sub_f32 v234, v139, v131
v_cvt_pk_bf16_f32 v147, v233, v234
ds_write_b128 v155, v[144:147] offset:0
buffer_load_dwordx4 v[44:47], v150, s[8:11], 0 offen offset:128 nt
buffer_load_dwordx4 v[52:55], v148, s[8:11], 0 offen offset:896 nt
buffer_load_dwordx4 v[60:63], v148, s[8:11], 0 offen offset:2432 nt
buffer_load_dwordx4 v[68:71], v149, s[8:11], 0 offen offset:128 nt
buffer_load_dwordx4 v[76:79], v149, s[8:11], 0 offen offset:1664 nt
s_waitcnt lgkmcnt(0)
s_barrier
s_setprio 0
s_mov_b32 s94, 0
s_cmp_lt_u32 s97, 216
s_cbranch_scc0 L_noU1
s_cmp_eq_u32 s31, 0
s_cbranch_scc0 L_noU1
s_mov_b32 s94, 1
s_mul_i32 s80, s97, 171
s_lshr_b32 s80, s80, 11
s_mul_i32 s81, s80, 12
s_sub_u32 s81, s97, s81
s_mul_i32 s82, s80, 86
s_lshr_b32 s82, s82, 8
s_mul_i32 s83, s82, 3
s_sub_u32 s83, s80, s83
v_lshrrev_b32 v223, 1, v0
v_and_b32 v224, 0x13, v223
v_and_b32 v225, 4, v223
v_lshl_or_b32 v224, v225, 1, v224
v_bfe_u32 v225, v223, 3, 1
v_lshl_or_b32 v224, v225, 2, v224
v_mul_u32_u24 v224, 384, v224
v_and_b32 v223, 1, v0
v_lshl_add_u32 v224, v223, 4, v224
s_lshl_b32 s84, s81, 5
v_add_u32 v220, s84, v224
s_mul_i32 s85, s83, 576
s_lshl_b32 s86, s82, 5
s_add_u32 s85, s85, s86
s_mul_i32 s85, s85, 384
s_mov_b32 m0, 81280
s_add_u32 s86, s85, 0
buffer_load_dwordx4 v220, s[72:75], s86 offen lds
s_mov_b32 m0, 82304
s_add_u32 s86, s85, 73728
buffer_load_dwordx4 v220, s[72:75], s86 offen lds
s_mov_b32 m0, 83328
s_add_u32 s86, s85, 147456
buffer_load_dwordx4 v220, s[72:75], s86 offen lds
v_lshrrev_b32 v223, 5, v0
v_lshlrev_b32 v223, 9, v223
v_bfe_u32 v224, v0, 4, 1
v_lshl_add_u32 v223, v224, 7, v223
v_bfe_u32 v224, v0, 2, 2
v_lshl_add_u32 v223, v224, 5, v223
v_and_b32 v224, 3, v0
v_lshl_add_u32 v223, v224, 3, v223
v_add_u32 v221, 81280, v223
s_mul_i32 s87, s80, 12288
s_lshl_b32 s84, s81, 10
s_add_u32 s87, s87, s84
v_lshlrev_b32 v222, 4, v0
v_add_u32 v222, s87, v222
L_noU1:
buffer_load_dwordx4 v[84:87], v150, s[8:11], 0 offen offset:256 nt
buffer_load_dwordx4 v[92:95], v148, s[8:11], 0 offen offset:1024 nt
s_waitcnt vmcnt(5)
v_lshlrev_b32 v124, 16, v44
v_and_b32 v125, s30, v44
v_lshlrev_b32 v126, 16, v45
v_and_b32 v127, s30, v45
v_lshlrev_b32 v128, 16, v46
v_and_b32 v129, s30, v46
v_lshlrev_b32 v130, 16, v47
v_and_b32 v131, s30, v47
v_lshlrev_b32 v132, 16, v52
v_and_b32 v133, s30, v52
v_lshlrev_b32 v134, 16, v53
v_and_b32 v135, s30, v53
v_lshlrev_b32 v136, 16, v54
v_and_b32 v137, s30, v54
v_lshlrev_b32 v138, 16, v55
v_and_b32 v139, s30, v55
v_sub_f32 v233, v124, v132
v_sub_f32 v234, v125, v133
v_cvt_pk_bf16_f32 v140, v233, v234
v_sub_f32 v233, v126, v134
v_sub_f32 v234, v127, v135
v_cvt_pk_bf16_f32 v141, v233, v234
v_sub_f32 v233, v128, v136
v_sub_f32 v234, v129, v137
v_cvt_pk_bf16_f32 v142, v233, v234
v_sub_f32 v233, v130, v138
v_sub_f32 v234, v131, v139
v_cvt_pk_bf16_f32 v143, v233, v234
ds_write_b128 v152, v[140:143] offset:16256
buffer_load_dwordx4 v[100:103], v148, s[8:11], 0 offen offset:2560 nt
s_waitcnt vmcnt(5)
v_lshlrev_b32 v124, 16, v60
v_and_b32 v125, s30, v60
v_lshlrev_b32 v126, 16, v61
v_and_b32 v127, s30, v61
v_lshlrev_b32 v128, 16, v62
v_and_b32 v129, s30, v62
v_lshlrev_b32 v130, 16, v63
v_and_b32 v131, s30, v63
v_sub_f32 v233, v132, v124
v_sub_f32 v234, v133, v125
v_cvt_pk_bf16_f32 v144, v233, v234
v_sub_f32 v233, v134, v126
v_sub_f32 v234, v135, v127
v_cvt_pk_bf16_f32 v145, v233, v234
v_sub_f32 v233, v136, v128
v_sub_f32 v234, v137, v129
v_cvt_pk_bf16_f32 v146, v233, v234
v_sub_f32 v233, v138, v130
v_sub_f32 v234, v139, v131
v_cvt_pk_bf16_f32 v147, v233, v234
ds_write_b128 v153, v[144:147] offset:16256
buffer_load_dwordx4 v[108:111], v149, s[8:11], 0 offen offset:256 nt
s_waitcnt vmcnt(5)
v_lshlrev_b32 v132, 16, v68
v_and_b32 v133, s30, v68
v_lshlrev_b32 v134, 16, v69
v_and_b32 v135, s30, v69
v_lshlrev_b32 v136, 16, v70
v_and_b32 v137, s30, v70
v_lshlrev_b32 v138, 16, v71
v_and_b32 v139, s30, v71
v_sub_f32 v233, v124, v132
v_sub_f32 v234, v125, v133
v_cvt_pk_bf16_f32 v140, v233, v234
v_sub_f32 v233, v126, v134
v_sub_f32 v234, v127, v135
v_cvt_pk_bf16_f32 v141, v233, v234
v_sub_f32 v233, v128, v136
v_sub_f32 v234, v129, v137
v_cvt_pk_bf16_f32 v142, v233, v234
v_sub_f32 v233, v130, v138
v_sub_f32 v234, v131, v139
v_cvt_pk_bf16_f32 v143, v233, v234
ds_write_b128 v154, v[140:143] offset:16256
buffer_load_dwordx4 v[116:119], v149, s[8:11], 0 offen offset:1792 nt
s_waitcnt vmcnt(5)
v_lshlrev_b32 v124, 16, v76
v_and_b32 v125, s30, v76
v_lshlrev_b32 v126, 16, v77
v_and_b32 v127, s30, v77
v_lshlrev_b32 v128, 16, v78
v_and_b32 v129, s30, v78
v_lshlrev_b32 v130, 16, v79
v_and_b32 v131, s30, v79
v_sub_f32 v233, v132, v124
v_sub_f32 v234, v133, v125
v_cvt_pk_bf16_f32 v144, v233, v234
v_sub_f32 v233, v134, v126
v_sub_f32 v234, v135, v127
v_cvt_pk_bf16_f32 v145, v233, v234
v_sub_f32 v233, v136, v128
v_sub_f32 v234, v137, v129
v_cvt_pk_bf16_f32 v146, v233, v234
v_sub_f32 v233, v138, v130
v_sub_f32 v234, v139, v131
v_cvt_pk_bf16_f32 v147, v233, v234
ds_write_b128 v155, v[144:147] offset:16256
s_cmp_eq_u32 s94, 0
s_cbranch_scc1 L_noU2
s_waitcnt vmcnt(5)
ds_read_b64_tr_b16 v[184:185], v221 offset:0
ds_read_b64_tr_b16 v[186:187], v221 offset:256
ds_read_b64_tr_b16 v[188:189], v221 offset:1024
ds_read_b64_tr_b16 v[190:191], v221 offset:1280
ds_read_b64_tr_b16 v[192:193], v221 offset:2048
ds_read_b64_tr_b16 v[194:195], v221 offset:2304
s_mov_b32 s85, 0x80008000
s_waitcnt lgkmcnt(0)
v_lshlrev_b32 v208, 16, v184
v_and_b32 v211, s30, v184
v_lshlrev_b32 v209, 16, v188
v_and_b32 v212, s30, v188
v_lshlrev_b32 v210, 16, v192
v_and_b32 v213, s30, v192
v_add_f32 v214, v208, v210
v_add_f32 v215, v211, v213
v_add_f32 v216, v214, v209
v_add_f32 v217, v215, v212
v_mul_f32 v216, 0.5, v216
v_mul_f32 v217, 0.5, v217
v_cvt_pk_bf16_f32 v196, v216, v217
v_sub_f32 v216, v209, v214
v_sub_f32 v217, v212, v215
v_mul_f32 v216, 0.5, v216
v_mul_f32 v217, 0.5, v217
v_cvt_pk_bf16_f32 v200, v216, v217
v_xor_b32 v204, s85, v192
v_lshlrev_b32 v208, 16, v185
v_and_b32 v211, s30, v185
v_lshlrev_b32 v209, 16, v189
v_and_b32 v212, s30, v189
v_lshlrev_b32 v210, 16, v193
v_and_b32 v213, s30, v193
v_add_f32 v214, v208, v210
v_add_f32 v215, v211, v213
v_add_f32 v216, v214, v209
v_add_f32 v217, v215, v212
v_mul_f32 v216, 0.5, v216
v_mul_f32 v217, 0.5, v217
v_cvt_pk_bf16_f32 v197, v216, v217
v_sub_f32 v216, v209, v214
v_sub_f32 v217, v212, v215
v_mul_f32 v216, 0.5, v216
v_mul_f32 v217, 0.5, v217
v_cvt_pk_bf16_f32 v201, v216, v217
v_xor_b32 v205, s85, v193
v_lshlrev_b32 v208, 16, v186
v_and_b32 v211, s30, v186
v_lshlrev_b32 v209, 16, v190
v_and_b32 v212, s30, v190
v_lshlrev_b32 v210, 16, v194
v_and_b32 v213, s30, v194
v_add_f32 v214, v208, v210
v_add_f32 v215, v211, v213
v_add_f32 v216, v214, v209
v_add_f32 v217, v215, v212
v_mul_f32 v216, 0.5, v216
v_mul_f32 v217, 0.5, v217
v_cvt_pk_bf16_f32 v198, v216, v217
v_sub_f32 v216, v209, v214
v_sub_f32 v217, v212, v215
v_mul_f32 v216, 0.5, v216
v_mul_f32 v217, 0.5, v217
v_cvt_pk_bf16_f32 v202, v216, v217
v_xor_b32 v206, s85, v194
v_lshlrev_b32 v208, 16, v187
v_and_b32 v211, s30, v187
v_lshlrev_b32 v209, 16, v191
v_and_b32 v212, s30, v191
v_lshlrev_b32 v210, 16, v195
v_and_b32 v213, s30, v195
v_add_f32 v214, v208, v210
v_add_f32 v215, v211, v213
v_add_f32 v216, v214, v209
v_add_f32 v217, v215, v212
v_mul_f32 v216, 0.5, v216
v_mul_f32 v217, 0.5, v217
v_cvt_pk_bf16_f32 v199, v216, v217
v_sub_f32 v216, v209, v214
v_sub_f32 v217, v212, v215
v_mul_f32 v216, 0.5, v216
v_mul_f32 v217, 0.5, v217
v_cvt_pk_bf16_f32 v203, v216, v217
v_xor_b32 v207, s85, v195
s_mov_b32 s84, 221184
buffer_store_dwordx4 v[196:199], v222, s[12:15], s84 offen sc1
s_mov_b32 s84, 442368
buffer_store_dwordx4 v[200:203], v222, s[12:15], s84 offen sc1
s_mov_b32 s84, 663552
buffer_store_dwordx4 v[204:207], v222, s[12:15], s84 offen sc1
L_noU2:
s_waitcnt lgkmcnt(0)
s_barrier
buffer_load_dwordx4 v[8:11], v148, s[8:11], 0 offen offset:0 nt
buffer_load_dwordx4 v[16:19], v148, s[8:11], 0 offen offset:1536 nt
buffer_load_dwordx4 v[24:27], v148, s[8:11], 0 offen offset:3072 nt
s_cmp_eq_u32 s94, 0
s_cbranch_scc1 L_noU3
s_waitcnt vmcnt(3)
s_and_b32 s84, s97, 3
s_lshl_b32 s84, s84, 6
v_mov_b32 v223, 1
s_mov_b64 exec, 1
buffer_atomic_add v223, off, s[76:79], s84 sc1
s_mov_b64 exec, -1
L_noU3:
buffer_load_dwordx4 v[32:35], v149, s[8:11], 0 offen offset:768 nt
s_waitcnt vmcnt(7)
v_lshlrev_b32 v124, 16, v84
v_and_b32 v125, s30, v84
v_lshlrev_b32 v126, 16, v85
v_and_b32 v127, s30, v85
v_lshlrev_b32 v128, 16, v86
v_and_b32 v129, s30, v86
v_lshlrev_b32 v130, 16, v87
v_and_b32 v131, s30, v87
v_lshlrev_b32 v132, 16, v92
v_and_b32 v133, s30, v92
v_lshlrev_b32 v134, 16, v93
v_and_b32 v135, s30, v93
v_lshlrev_b32 v136, 16, v94
v_and_b32 v137, s30, v94
v_lshlrev_b32 v138, 16, v95
v_and_b32 v139, s30, v95
v_sub_f32 v233, v124, v132
v_sub_f32 v234, v125, v133
v_cvt_pk_bf16_f32 v140, v233, v234
v_sub_f32 v233, v126, v134
v_sub_f32 v234, v127, v135
v_cvt_pk_bf16_f32 v141, v233, v234
v_sub_f32 v233, v128, v136
v_sub_f32 v234, v129, v137
v_cvt_pk_bf16_f32 v142, v233, v234
v_sub_f32 v233, v130, v138
v_sub_f32 v234, v131, v139
v_cvt_pk_bf16_f32 v143, v233, v234
ds_write_b128 v152, v[140:143] offset:32512
s_waitcnt vmcnt(6)
v_lshlrev_b32 v124, 16, v100
v_and_b32 v125, s30, v100
v_lshlrev_b32 v126, 16, v101
v_and_b32 v127, s30, v101
v_lshlrev_b32 v128, 16, v102
v_and_b32 v129, s30, v102
v_lshlrev_b32 v130, 16, v103
v_and_b32 v131, s30, v103
v_sub_f32 v233, v132, v124
v_sub_f32 v234, v133, v125
v_cvt_pk_bf16_f32 v144, v233, v234
v_sub_f32 v233, v134, v126
v_sub_f32 v234, v135, v127
v_cvt_pk_bf16_f32 v145, v233, v234
v_sub_f32 v233, v136, v128
v_sub_f32 v234, v137, v129
v_cvt_pk_bf16_f32 v146, v233, v234
v_sub_f32 v233, v138, v130
v_sub_f32 v234, v139, v131
v_cvt_pk_bf16_f32 v147, v233, v234
ds_write_b128 v153, v[144:147] offset:32512
s_waitcnt vmcnt(5)
v_lshlrev_b32 v132, 16, v108
v_and_b32 v133, s30, v108
v_lshlrev_b32 v134, 16, v109
v_and_b32 v135, s30, v109
v_lshlrev_b32 v136, 16, v110
v_and_b32 v137, s30, v110
v_lshlrev_b32 v138, 16, v111
v_and_b32 v139, s30, v111
v_sub_f32 v233, v124, v132
v_sub_f32 v234, v125, v133
v_cvt_pk_bf16_f32 v140, v233, v234
v_sub_f32 v233, v126, v134
v_sub_f32 v234, v127, v135
v_cvt_pk_bf16_f32 v141, v233, v234
v_sub_f32 v233, v128, v136
v_sub_f32 v234, v129, v137
v_cvt_pk_bf16_f32 v142, v233, v234
v_sub_f32 v233, v130, v138
v_sub_f32 v234, v131, v139
v_cvt_pk_bf16_f32 v143, v233, v234
ds_write_b128 v154, v[140:143] offset:32512
s_waitcnt vmcnt(4)
v_lshlrev_b32 v124, 16, v116
v_and_b32 v125, s30, v116
v_lshlrev_b32 v126, 16, v117
v_and_b32 v127, s30, v117
v_lshlrev_b32 v128, 16, v118
v_and_b32 v129, s30, v118
v_lshlrev_b32 v130, 16, v119
v_and_b32 v131, s30, v119
v_sub_f32 v233, v132, v124
v_sub_f32 v234, v133, v125
v_cvt_pk_bf16_f32 v144, v233, v234
v_sub_f32 v233, v134, v126
v_sub_f32 v234, v135, v127
v_cvt_pk_bf16_f32 v145, v233, v234
v_sub_f32 v233, v136, v128
v_sub_f32 v234, v137, v129
v_cvt_pk_bf16_f32 v146, v233, v234
v_sub_f32 v233, v138, v130
v_sub_f32 v234, v139, v131
v_cvt_pk_bf16_f32 v147, v233, v234
ds_write_b128 v155, v[144:147] offset:32512
s_waitcnt lgkmcnt(0)
s_barrier
buffer_load_dwordx4 v[48:51], v148, s[8:11], 0 offen offset:128 nt
buffer_load_dwordx4 v[56:59], v148, s[8:11], 0 offen offset:1664 nt
buffer_load_dwordx4 v[64:67], v148, s[8:11], 0 offen offset:3200 nt
buffer_load_dwordx4 v[72:75], v149, s[8:11], 0 offen offset:896 nt
s_waitcnt vmcnt(7)
v_lshlrev_b32 v124, 16, v8
v_and_b32 v125, s30, v8
v_lshlrev_b32 v126, 16, v9
v_and_b32 v127, s30, v9
v_lshlrev_b32 v128, 16, v10
v_and_b32 v129, s30, v10
v_lshlrev_b32 v130, 16, v11
v_and_b32 v131, s30, v11
v_lshlrev_b32 v132, 16, v12
v_and_b32 v133, s30, v12
v_lshlrev_b32 v134, 16, v13
v_and_b32 v135, s30, v13
v_lshlrev_b32 v136, 16, v14
v_and_b32 v137, s30, v14
v_lshlrev_b32 v138, 16, v15
v_and_b32 v139, s30, v15
v_add_f32 v233, v124, v132
v_add_f32 v234, v125, v133
v_cvt_pk_bf16_f32 v140, v233, v234
v_add_f32 v233, v126, v134
v_add_f32 v234, v127, v135
v_cvt_pk_bf16_f32 v141, v233, v234
v_add_f32 v233, v128, v136
v_add_f32 v234, v129, v137
v_cvt_pk_bf16_f32 v142, v233, v234
v_add_f32 v233, v130, v138
v_add_f32 v234, v131, v139
v_cvt_pk_bf16_f32 v143, v233, v234
ds_write_b128 v156, v[140:143] offset:0
s_waitcnt vmcnt(6)
v_lshlrev_b32 v124, 16, v16
v_and_b32 v125, s30, v16
v_lshlrev_b32 v126, 16, v17
v_and_b32 v127, s30, v17
v_lshlrev_b32 v128, 16, v18
v_and_b32 v129, s30, v18
v_lshlrev_b32 v130, 16, v19
v_and_b32 v131, s30, v19
v_lshlrev_b32 v132, 16, v20
v_and_b32 v133, s30, v20
v_lshlrev_b32 v134, 16, v21
v_and_b32 v135, s30, v21
v_lshlrev_b32 v136, 16, v22
v_and_b32 v137, s30, v22
v_lshlrev_b32 v138, 16, v23
v_and_b32 v139, s30, v23
v_add_f32 v233, v124, v132
v_add_f32 v234, v125, v133
v_cvt_pk_bf16_f32 v144, v233, v234
v_add_f32 v233, v126, v134
v_add_f32 v234, v127, v135
v_cvt_pk_bf16_f32 v145, v233, v234
v_add_f32 v233, v128, v136
v_add_f32 v234, v129, v137
v_cvt_pk_bf16_f32 v146, v233, v234
v_add_f32 v233, v130, v138
v_add_f32 v234, v131, v139
v_cvt_pk_bf16_f32 v147, v233, v234
ds_write_b128 v157, v[144:147] offset:0
s_waitcnt lgkmcnt(0)
s_barrier
buffer_load_dwordx4 v[88:91], v148, s[8:11], 0 offen offset:256 nt
buffer_load_dwordx4 v[96:99], v148, s[8:11], 0 offen offset:1792 nt
s_waitcnt vmcnt(7)
v_lshlrev_b32 v124, 16, v24
v_and_b32 v125, s30, v24
v_lshlrev_b32 v126, 16, v25
v_and_b32 v127, s30, v25
v_lshlrev_b32 v128, 16, v26
v_and_b32 v129, s30, v26
v_lshlrev_b32 v130, 16, v27
v_and_b32 v131, s30, v27
v_lshlrev_b32 v132, 16, v28
v_and_b32 v133, s30, v28
v_lshlrev_b32 v134, 16, v29
v_and_b32 v135, s30, v29
v_lshlrev_b32 v136, 16, v30
v_and_b32 v137, s30, v30
v_lshlrev_b32 v138, 16, v31
v_and_b32 v139, s30, v31
v_add_f32 v233, v124, v132
v_add_f32 v234, v125, v133
v_cvt_pk_bf16_f32 v140, v233, v234
v_add_f32 v233, v126, v134
v_add_f32 v234, v127, v135
v_cvt_pk_bf16_f32 v141, v233, v234
v_add_f32 v233, v128, v136
v_add_f32 v234, v129, v137
v_cvt_pk_bf16_f32 v142, v233, v234
v_add_f32 v233, v130, v138
v_add_f32 v234, v131, v139
v_cvt_pk_bf16_f32 v143, v233, v234
ds_write_b128 v158, v[140:143] offset:0
s_waitcnt vmcnt(6)
v_lshlrev_b32 v124, 16, v32
v_and_b32 v125, s30, v32
v_lshlrev_b32 v126, 16, v33
v_and_b32 v127, s30, v33
v_lshlrev_b32 v128, 16, v34
v_and_b32 v129, s30, v34
v_lshlrev_b32 v130, 16, v35
v_and_b32 v131, s30, v35
v_lshlrev_b32 v132, 16, v36
v_and_b32 v133, s30, v36
v_lshlrev_b32 v134, 16, v37
v_and_b32 v135, s30, v37
v_lshlrev_b32 v136, 16, v38
v_and_b32 v137, s30, v38
v_lshlrev_b32 v138, 16, v39
v_and_b32 v139, s30, v39
v_add_f32 v233, v124, v132
v_add_f32 v234, v125, v133
v_cvt_pk_bf16_f32 v144, v233, v234
v_add_f32 v233, v126, v134
v_add_f32 v234, v127, v135
v_cvt_pk_bf16_f32 v145, v233, v234
v_add_f32 v233, v128, v136
v_add_f32 v234, v129, v137
v_cvt_pk_bf16_f32 v146, v233, v234
v_add_f32 v233, v130, v138
v_add_f32 v234, v131, v139
v_cvt_pk_bf16_f32 v147, v233, v234
ds_write_b128 v159, v[144:147] offset:0
s_waitcnt lgkmcnt(0)
s_barrier
buffer_load_dwordx4 v[104:107], v148, s[8:11], 0 offen offset:3328 nt
buffer_load_dwordx4 v[112:115], v149, s[8:11], 0 offen offset:1024 nt
buffer_load_dwordx4 v[40:43], v149, s[8:11], 0 offen offset:2304 nt
buffer_load_dwordx4 v[80:83], v149, s[8:11], 0 offen offset:2432 nt
buffer_load_dwordx4 v[120:123], v149, s[8:11], 0 offen offset:2560 nt
s_waitcnt vmcnt(10)
v_lshlrev_b32 v124, 16, v48
v_and_b32 v125, s30, v48
v_lshlrev_b32 v126, 16, v49
v_and_b32 v127, s30, v49
v_lshlrev_b32 v128, 16, v50
v_and_b32 v129, s30, v50
v_lshlrev_b32 v130, 16, v51
v_and_b32 v131, s30, v51
v_lshlrev_b32 v132, 16, v52
v_and_b32 v133, s30, v52
v_lshlrev_b32 v134, 16, v53
v_and_b32 v135, s30, v53
v_lshlrev_b32 v136, 16, v54
v_and_b32 v137, s30, v54
v_lshlrev_b32 v138, 16, v55
v_and_b32 v139, s30, v55
v_add_f32 v233, v124, v132
v_add_f32 v234, v125, v133
v_cvt_pk_bf16_f32 v140, v233, v234
v_add_f32 v233, v126, v134
v_add_f32 v234, v127, v135
v_cvt_pk_bf16_f32 v141, v233, v234
v_add_f32 v233, v128, v136
v_add_f32 v234, v129, v137
v_cvt_pk_bf16_f32 v142, v233, v234
v_add_f32 v233, v130, v138
v_add_f32 v234, v131, v139
v_cvt_pk_bf16_f32 v143, v233, v234
ds_write_b128 v156, v[140:143] offset:16256
s_waitcnt vmcnt(9)
v_lshlrev_b32 v124, 16, v56
v_and_b32 v125, s30, v56
v_lshlrev_b32 v126, 16, v57
v_and_b32 v127, s30, v57
v_lshlrev_b32 v128, 16, v58
v_and_b32 v129, s30, v58
v_lshlrev_b32 v130, 16, v59
v_and_b32 v131, s30, v59
v_lshlrev_b32 v132, 16, v60
v_and_b32 v133, s30, v60
v_lshlrev_b32 v134, 16, v61
v_and_b32 v135, s30, v61
v_lshlrev_b32 v136, 16, v62
v_and_b32 v137, s30, v62
v_lshlrev_b32 v138, 16, v63
v_and_b32 v139, s30, v63
v_add_f32 v233, v124, v132
v_add_f32 v234, v125, v133
v_cvt_pk_bf16_f32 v144, v233, v234
v_add_f32 v233, v126, v134
v_add_f32 v234, v127, v135
v_cvt_pk_bf16_f32 v145, v233, v234
v_add_f32 v233, v128, v136
v_add_f32 v234, v129, v137
v_cvt_pk_bf16_f32 v146, v233, v234
v_add_f32 v233, v130, v138
v_add_f32 v234, v131, v139
v_cvt_pk_bf16_f32 v147, v233, v234
ds_write_b128 v157, v[144:147] offset:16256
s_waitcnt vmcnt(8)
v_lshlrev_b32 v124, 16, v64
v_and_b32 v125, s30, v64
v_lshlrev_b32 v126, 16, v65
v_and_b32 v127, s30, v65
v_lshlrev_b32 v128, 16, v66
v_and_b32 v129, s30, v66
v_lshlrev_b32 v130, 16, v67
v_and_b32 v131, s30, v67
v_lshlrev_b32 v132, 16, v68
v_and_b32 v133, s30, v68
v_lshlrev_b32 v134, 16, v69
v_and_b32 v135, s30, v69
v_lshlrev_b32 v136, 16, v70
v_and_b32 v137, s30, v70
v_lshlrev_b32 v138, 16, v71
v_and_b32 v139, s30, v71
v_add_f32 v233, v124, v132
v_add_f32 v234, v125, v133
v_cvt_pk_bf16_f32 v140, v233, v234
v_add_f32 v233, v126, v134
v_add_f32 v234, v127, v135
v_cvt_pk_bf16_f32 v141, v233, v234
v_add_f32 v233, v128, v136
v_add_f32 v234, v129, v137
v_cvt_pk_bf16_f32 v142, v233, v234
v_add_f32 v233, v130, v138
v_add_f32 v234, v131, v139
v_cvt_pk_bf16_f32 v143, v233, v234
ds_write_b128 v158, v[140:143] offset:16256
s_waitcnt vmcnt(7)
v_lshlrev_b32 v124, 16, v72
v_and_b32 v125, s30, v72
v_lshlrev_b32 v126, 16, v73
v_and_b32 v127, s30, v73
v_lshlrev_b32 v128, 16, v74
v_and_b32 v129, s30, v74
v_lshlrev_b32 v130, 16, v75
v_and_b32 v131, s30, v75
v_lshlrev_b32 v132, 16, v76
v_and_b32 v133, s30, v76
v_lshlrev_b32 v134, 16, v77
v_and_b32 v135, s30, v77
v_lshlrev_b32 v136, 16, v78
v_and_b32 v137, s30, v78
v_lshlrev_b32 v138, 16, v79
v_and_b32 v139, s30, v79
v_add_f32 v233, v124, v132
v_add_f32 v234, v125, v133
v_cvt_pk_bf16_f32 v144, v233, v234
v_add_f32 v233, v126, v134
v_add_f32 v234, v127, v135
v_cvt_pk_bf16_f32 v145, v233, v234
v_add_f32 v233, v128, v136
v_add_f32 v234, v129, v137
v_cvt_pk_bf16_f32 v146, v233, v234
v_add_f32 v233, v130, v138
v_add_f32 v234, v131, v139
v_cvt_pk_bf16_f32 v147, v233, v234
ds_write_b128 v159, v[144:147] offset:16256
s_waitcnt lgkmcnt(0)
s_barrier
s_waitcnt vmcnt(6)
v_lshlrev_b32 v124, 16, v88
v_and_b32 v125, s30, v88
v_lshlrev_b32 v126, 16, v89
v_and_b32 v127, s30, v89
v_lshlrev_b32 v128, 16, v90
v_and_b32 v129, s30, v90
v_lshlrev_b32 v130, 16, v91
v_and_b32 v131, s30, v91
v_lshlrev_b32 v132, 16, v92
v_and_b32 v133, s30, v92
v_lshlrev_b32 v134, 16, v93
v_and_b32 v135, s30, v93
v_lshlrev_b32 v136, 16, v94
v_and_b32 v137, s30, v94
v_lshlrev_b32 v138, 16, v95
v_and_b32 v139, s30, v95
v_add_f32 v233, v124, v132
v_add_f32 v234, v125, v133
v_cvt_pk_bf16_f32 v140, v233, v234
v_add_f32 v233, v126, v134
v_add_f32 v234, v127, v135
v_cvt_pk_bf16_f32 v141, v233, v234
v_add_f32 v233, v128, v136
v_add_f32 v234, v129, v137
v_cvt_pk_bf16_f32 v142, v233, v234
v_add_f32 v233, v130, v138
v_add_f32 v234, v131, v139
v_cvt_pk_bf16_f32 v143, v233, v234
ds_write_b128 v156, v[140:143] offset:32512
s_waitcnt vmcnt(5)
v_lshlrev_b32 v124, 16, v96
v_and_b32 v125, s30, v96
v_lshlrev_b32 v126, 16, v97
v_and_b32 v127, s30, v97
v_lshlrev_b32 v128, 16, v98
v_and_b32 v129, s30, v98
v_lshlrev_b32 v130, 16, v99
v_and_b32 v131, s30, v99
v_lshlrev_b32 v132, 16, v100
v_and_b32 v133, s30, v100
v_lshlrev_b32 v134, 16, v101
v_and_b32 v135, s30, v101
v_lshlrev_b32 v136, 16, v102
v_and_b32 v137, s30, v102
v_lshlrev_b32 v138, 16, v103
v_and_b32 v139, s30, v103
v_add_f32 v233, v124, v132
v_add_f32 v234, v125, v133
v_cvt_pk_bf16_f32 v144, v233, v234
v_add_f32 v233, v126, v134
v_add_f32 v234, v127, v135
v_cvt_pk_bf16_f32 v145, v233, v234
v_add_f32 v233, v128, v136
v_add_f32 v234, v129, v137
v_cvt_pk_bf16_f32 v146, v233, v234
v_add_f32 v233, v130, v138
v_add_f32 v234, v131, v139
v_cvt_pk_bf16_f32 v147, v233, v234
ds_write_b128 v157, v[144:147] offset:32512
s_waitcnt vmcnt(4)
v_lshlrev_b32 v124, 16, v104
v_and_b32 v125, s30, v104
v_lshlrev_b32 v126, 16, v105
v_and_b32 v127, s30, v105
v_lshlrev_b32 v128, 16, v106
v_and_b32 v129, s30, v106
v_lshlrev_b32 v130, 16, v107
v_and_b32 v131, s30, v107
v_lshlrev_b32 v132, 16, v108
v_and_b32 v133, s30, v108
v_lshlrev_b32 v134, 16, v109
v_and_b32 v135, s30, v109
v_lshlrev_b32 v136, 16, v110
v_and_b32 v137, s30, v110
v_lshlrev_b32 v138, 16, v111
v_and_b32 v139, s30, v111
v_add_f32 v233, v124, v132
v_add_f32 v234, v125, v133
v_cvt_pk_bf16_f32 v140, v233, v234
v_add_f32 v233, v126, v134
v_add_f32 v234, v127, v135
v_cvt_pk_bf16_f32 v141, v233, v234
v_add_f32 v233, v128, v136
v_add_f32 v234, v129, v137
v_cvt_pk_bf16_f32 v142, v233, v234
v_add_f32 v233, v130, v138
v_add_f32 v234, v131, v139
v_cvt_pk_bf16_f32 v143, v233, v234
ds_write_b128 v158, v[140:143] offset:32512
s_waitcnt vmcnt(3)
v_lshlrev_b32 v124, 16, v112
v_and_b32 v125, s30, v112
v_lshlrev_b32 v126, 16, v113
v_and_b32 v127, s30, v113
v_lshlrev_b32 v128, 16, v114
v_and_b32 v129, s30, v114
v_lshlrev_b32 v130, 16, v115
v_and_b32 v131, s30, v115
v_lshlrev_b32 v132, 16, v116
v_and_b32 v133, s30, v116
v_lshlrev_b32 v134, 16, v117
v_and_b32 v135, s30, v117
v_lshlrev_b32 v136, 16, v118
v_and_b32 v137, s30, v118
v_lshlrev_b32 v138, 16, v119
v_and_b32 v139, s30, v119
v_add_f32 v233, v124, v132
v_add_f32 v234, v125, v133
v_cvt_pk_bf16_f32 v144, v233, v234
v_add_f32 v233, v126, v134
v_add_f32 v234, v127, v135
v_cvt_pk_bf16_f32 v145, v233, v234
v_add_f32 v233, v128, v136
v_add_f32 v234, v129, v137
v_cvt_pk_bf16_f32 v146, v233, v234
v_add_f32 v233, v130, v138
v_add_f32 v234, v131, v139
v_cvt_pk_bf16_f32 v147, v233, v234
ds_write_b128 v159, v[144:147] offset:32512
v_lshlrev_b32 v124, 16, v8
v_and_b32 v125, s30, v8
v_lshlrev_b32 v126, 16, v9
v_and_b32 v127, s30, v9
v_lshlrev_b32 v128, 16, v10
v_and_b32 v129, s30, v10
v_lshlrev_b32 v130, 16, v11
v_and_b32 v131, s30, v11
v_lshlrev_b32 v132, 16, v12
v_and_b32 v133, s30, v12
v_lshlrev_b32 v134, 16, v13
v_and_b32 v135, s30, v13
v_lshlrev_b32 v136, 16, v14
v_and_b32 v137, s30, v14
v_lshlrev_b32 v138, 16, v15
v_and_b32 v139, s30, v15
v_sub_f32 v233, v132, v124
v_sub_f32 v234, v133, v125
v_cvt_pk_bf16_f32 v140, v233, v234
v_sub_f32 v233, v134, v126
v_sub_f32 v234, v135, v127
v_cvt_pk_bf16_f32 v141, v233, v234
v_sub_f32 v233, v136, v128
v_sub_f32 v234, v137, v129
v_cvt_pk_bf16_f32 v142, v233, v234
v_sub_f32 v233, v138, v130
v_sub_f32 v234, v139, v131
v_cvt_pk_bf16_f32 v143, v233, v234
ds_write_b128 v152, v[140:143] offset:0
v_lshlrev_b32 v124, 16, v16
v_and_b32 v125, s30, v16
v_lshlrev_b32 v126, 16, v17
v_and_b32 v127, s30, v17
v_lshlrev_b32 v128, 16, v18
v_and_b32 v129, s30, v18
v_lshlrev_b32 v130, 16, v19
v_and_b32 v131, s30, v19
v_lshlrev_b32 v132, 16, v20
v_and_b32 v133, s30, v20
v_lshlrev_b32 v134, 16, v21
v_and_b32 v135, s30, v21
v_lshlrev_b32 v136, 16, v22
v_and_b32 v137, s30, v22
v_lshlrev_b32 v138, 16, v23
v_and_b32 v139, s30, v23
v_sub_f32 v233, v132, v124
v_sub_f32 v234, v133, v125
v_cvt_pk_bf16_f32 v144, v233, v234
v_sub_f32 v233, v134, v126
v_sub_f32 v234, v135, v127
v_cvt_pk_bf16_f32 v145, v233, v234
v_sub_f32 v233, v136, v128
v_sub_f32 v234, v137, v129
v_cvt_pk_bf16_f32 v146, v233, v234
v_sub_f32 v233, v138, v130
v_sub_f32 v234, v139, v131
v_cvt_pk_bf16_f32 v147, v233, v234
ds_write_b128 v153, v[144:147] offset:0
v_lshlrev_b32 v124, 16, v24
v_and_b32 v125, s30, v24
v_lshlrev_b32 v126, 16, v25
v_and_b32 v127, s30, v25
v_lshlrev_b32 v128, 16, v26
v_and_b32 v129, s30, v26
v_lshlrev_b32 v130, 16, v27
v_and_b32 v131, s30, v27
v_lshlrev_b32 v132, 16, v28
v_and_b32 v133, s30, v28
v_lshlrev_b32 v134, 16, v29
v_and_b32 v135, s30, v29
v_lshlrev_b32 v136, 16, v30
v_and_b32 v137, s30, v30
v_lshlrev_b32 v138, 16, v31
v_and_b32 v139, s30, v31
v_sub_f32 v233, v132, v124
v_sub_f32 v234, v133, v125
v_cvt_pk_bf16_f32 v140, v233, v234
v_sub_f32 v233, v134, v126
v_sub_f32 v234, v135, v127
v_cvt_pk_bf16_f32 v141, v233, v234
v_sub_f32 v233, v136, v128
v_sub_f32 v234, v137, v129
v_cvt_pk_bf16_f32 v142, v233, v234
v_sub_f32 v233, v138, v130
v_sub_f32 v234, v139, v131
v_cvt_pk_bf16_f32 v143, v233, v234
ds_write_b128 v154, v[140:143] offset:0
v_lshlrev_b32 v124, 16, v32
v_and_b32 v125, s30, v32
v_lshlrev_b32 v126, 16, v33
v_and_b32 v127, s30, v33
v_lshlrev_b32 v128, 16, v34
v_and_b32 v129, s30, v34
v_lshlrev_b32 v130, 16, v35
v_and_b32 v131, s30, v35
v_lshlrev_b32 v132, 16, v36
v_and_b32 v133, s30, v36
v_lshlrev_b32 v134, 16, v37
v_and_b32 v135, s30, v37
v_lshlrev_b32 v136, 16, v38
v_and_b32 v137, s30, v38
v_lshlrev_b32 v138, 16, v39
v_and_b32 v139, s30, v39
v_sub_f32 v233, v132, v124
v_sub_f32 v234, v133, v125
v_cvt_pk_bf16_f32 v144, v233, v234
v_sub_f32 v233, v134, v126
v_sub_f32 v234, v135, v127
v_cvt_pk_bf16_f32 v145, v233, v234
v_sub_f32 v233, v136, v128
v_sub_f32 v234, v137, v129
v_cvt_pk_bf16_f32 v146, v233, v234
v_sub_f32 v233, v138, v130
v_sub_f32 v234, v139, v131
v_cvt_pk_bf16_f32 v147, v233, v234
ds_write_b128 v155, v[144:147] offset:0
s_waitcnt lgkmcnt(0)
s_barrier
v_lshlrev_b32 v124, 16, v48
v_and_b32 v125, s30, v48
v_lshlrev_b32 v126, 16, v49
v_and_b32 v127, s30, v49
v_lshlrev_b32 v128, 16, v50
v_and_b32 v129, s30, v50
v_lshlrev_b32 v130, 16, v51
v_and_b32 v131, s30, v51
v_lshlrev_b32 v132, 16, v52
v_and_b32 v133, s30, v52
v_lshlrev_b32 v134, 16, v53
v_and_b32 v135, s30, v53
v_lshlrev_b32 v136, 16, v54
v_and_b32 v137, s30, v54
v_lshlrev_b32 v138, 16, v55
v_and_b32 v139, s30, v55
v_sub_f32 v233, v132, v124
v_sub_f32 v234, v133, v125
v_cvt_pk_bf16_f32 v140, v233, v234
v_sub_f32 v233, v134, v126
v_sub_f32 v234, v135, v127
v_cvt_pk_bf16_f32 v141, v233, v234
v_sub_f32 v233, v136, v128
v_sub_f32 v234, v137, v129
v_cvt_pk_bf16_f32 v142, v233, v234
v_sub_f32 v233, v138, v130
v_sub_f32 v234, v139, v131
v_cvt_pk_bf16_f32 v143, v233, v234
ds_write_b128 v152, v[140:143] offset:16256
v_lshlrev_b32 v124, 16, v56
v_and_b32 v125, s30, v56
v_lshlrev_b32 v126, 16, v57
v_and_b32 v127, s30, v57
v_lshlrev_b32 v128, 16, v58
v_and_b32 v129, s30, v58
v_lshlrev_b32 v130, 16, v59
v_and_b32 v131, s30, v59
v_lshlrev_b32 v132, 16, v60
v_and_b32 v133, s30, v60
v_lshlrev_b32 v134, 16, v61
v_and_b32 v135, s30, v61
v_lshlrev_b32 v136, 16, v62
v_and_b32 v137, s30, v62
v_lshlrev_b32 v138, 16, v63
v_and_b32 v139, s30, v63
v_sub_f32 v233, v132, v124
v_sub_f32 v234, v133, v125
v_cvt_pk_bf16_f32 v144, v233, v234
v_sub_f32 v233, v134, v126
v_sub_f32 v234, v135, v127
v_cvt_pk_bf16_f32 v145, v233, v234
v_sub_f32 v233, v136, v128
v_sub_f32 v234, v137, v129
v_cvt_pk_bf16_f32 v146, v233, v234
v_sub_f32 v233, v138, v130
v_sub_f32 v234, v139, v131
v_cvt_pk_bf16_f32 v147, v233, v234
ds_write_b128 v153, v[144:147] offset:16256
v_lshlrev_b32 v124, 16, v64
v_and_b32 v125, s30, v64
v_lshlrev_b32 v126, 16, v65
v_and_b32 v127, s30, v65
v_lshlrev_b32 v128, 16, v66
v_and_b32 v129, s30, v66
v_lshlrev_b32 v130, 16, v67
v_and_b32 v131, s30, v67
v_lshlrev_b32 v132, 16, v68
v_and_b32 v133, s30, v68
v_lshlrev_b32 v134, 16, v69
v_and_b32 v135, s30, v69
v_lshlrev_b32 v136, 16, v70
v_and_b32 v137, s30, v70
v_lshlrev_b32 v138, 16, v71
v_and_b32 v139, s30, v71
v_sub_f32 v233, v132, v124
v_sub_f32 v234, v133, v125
v_cvt_pk_bf16_f32 v140, v233, v234
v_sub_f32 v233, v134, v126
v_sub_f32 v234, v135, v127
v_cvt_pk_bf16_f32 v141, v233, v234
v_sub_f32 v233, v136, v128
v_sub_f32 v234, v137, v129
v_cvt_pk_bf16_f32 v142, v233, v234
v_sub_f32 v233, v138, v130
v_sub_f32 v234, v139, v131
v_cvt_pk_bf16_f32 v143, v233, v234
ds_write_b128 v154, v[140:143] offset:16256
v_lshlrev_b32 v124, 16, v72
v_and_b32 v125, s30, v72
v_lshlrev_b32 v126, 16, v73
v_and_b32 v127, s30, v73
v_lshlrev_b32 v128, 16, v74
v_and_b32 v129, s30, v74
v_lshlrev_b32 v130, 16, v75
v_and_b32 v131, s30, v75
v_lshlrev_b32 v132, 16, v76
v_and_b32 v133, s30, v76
v_lshlrev_b32 v134, 16, v77
v_and_b32 v135, s30, v77
v_lshlrev_b32 v136, 16, v78
v_and_b32 v137, s30, v78
v_lshlrev_b32 v138, 16, v79
v_and_b32 v139, s30, v79
v_sub_f32 v233, v132, v124
v_sub_f32 v234, v133, v125
v_cvt_pk_bf16_f32 v144, v233, v234
v_sub_f32 v233, v134, v126
v_sub_f32 v234, v135, v127
v_cvt_pk_bf16_f32 v145, v233, v234
v_sub_f32 v233, v136, v128
v_sub_f32 v234, v137, v129
v_cvt_pk_bf16_f32 v146, v233, v234
v_sub_f32 v233, v138, v130
v_sub_f32 v234, v139, v131
v_cvt_pk_bf16_f32 v147, v233, v234
ds_write_b128 v155, v[144:147] offset:16256
v_lshlrev_b32 v124, 16, v88
v_and_b32 v125, s30, v88
v_lshlrev_b32 v126, 16, v89
v_and_b32 v127, s30, v89
v_lshlrev_b32 v128, 16, v90
v_and_b32 v129, s30, v90
v_lshlrev_b32 v130, 16, v91
v_and_b32 v131, s30, v91
v_lshlrev_b32 v132, 16, v92
v_and_b32 v133, s30, v92
v_lshlrev_b32 v134, 16, v93
v_and_b32 v135, s30, v93
v_lshlrev_b32 v136, 16, v94
v_and_b32 v137, s30, v94
v_lshlrev_b32 v138, 16, v95
v_and_b32 v139, s30, v95
v_sub_f32 v233, v132, v124
v_sub_f32 v234, v133, v125
v_cvt_pk_bf16_f32 v140, v233, v234
v_sub_f32 v233, v134, v126
v_sub_f32 v234, v135, v127
v_cvt_pk_bf16_f32 v141, v233, v234
v_sub_f32 v233, v136, v128
v_sub_f32 v234, v137, v129
v_cvt_pk_bf16_f32 v142, v233, v234
v_sub_f32 v233, v138, v130
v_sub_f32 v234, v139, v131
v_cvt_pk_bf16_f32 v143, v233, v234
ds_write_b128 v152, v[140:143] offset:32512
v_lshlrev_b32 v124, 16, v96
v_and_b32 v125, s30, v96
v_lshlrev_b32 v126, 16, v97
v_and_b32 v127, s30, v97
v_lshlrev_b32 v128, 16, v98
v_and_b32 v129, s30, v98
v_lshlrev_b32 v130, 16, v99
v_and_b32 v131, s30, v99
v_lshlrev_b32 v132, 16, v100
v_and_b32 v133, s30, v100
v_lshlrev_b32 v134, 16, v101
v_and_b32 v135, s30, v101
v_lshlrev_b32 v136, 16, v102
v_and_b32 v137, s30, v102
v_lshlrev_b32 v138, 16, v103
v_and_b32 v139, s30, v103
v_sub_f32 v233, v132, v124
v_sub_f32 v234, v133, v125
v_cvt_pk_bf16_f32 v144, v233, v234
v_sub_f32 v233, v134, v126
v_sub_f32 v234, v135, v127
v_cvt_pk_bf16_f32 v145, v233, v234
v_sub_f32 v233, v136, v128
v_sub_f32 v234, v137, v129
v_cvt_pk_bf16_f32 v146, v233, v234
v_sub_f32 v233, v138, v130
v_sub_f32 v234, v139, v131
v_cvt_pk_bf16_f32 v147, v233, v234
ds_write_b128 v153, v[144:147] offset:32512
v_lshlrev_b32 v124, 16, v104
v_and_b32 v125, s30, v104
v_lshlrev_b32 v126, 16, v105
v_and_b32 v127, s30, v105
v_lshlrev_b32 v128, 16, v106
v_and_b32 v129, s30, v106
v_lshlrev_b32 v130, 16, v107
v_and_b32 v131, s30, v107
v_lshlrev_b32 v132, 16, v108
v_and_b32 v133, s30, v108
v_lshlrev_b32 v134, 16, v109
v_and_b32 v135, s30, v109
v_lshlrev_b32 v136, 16, v110
v_and_b32 v137, s30, v110
v_lshlrev_b32 v138, 16, v111
v_and_b32 v139, s30, v111
v_sub_f32 v233, v132, v124
v_sub_f32 v234, v133, v125
v_cvt_pk_bf16_f32 v140, v233, v234
v_sub_f32 v233, v134, v126
v_sub_f32 v234, v135, v127
v_cvt_pk_bf16_f32 v141, v233, v234
v_sub_f32 v233, v136, v128
v_sub_f32 v234, v137, v129
v_cvt_pk_bf16_f32 v142, v233, v234
v_sub_f32 v233, v138, v130
v_sub_f32 v234, v139, v131
v_cvt_pk_bf16_f32 v143, v233, v234
ds_write_b128 v154, v[140:143] offset:32512
v_lshlrev_b32 v124, 16, v112
v_and_b32 v125, s30, v112
v_lshlrev_b32 v126, 16, v113
v_and_b32 v127, s30, v113
v_lshlrev_b32 v128, 16, v114
v_and_b32 v129, s30, v114
v_lshlrev_b32 v130, 16, v115
v_and_b32 v131, s30, v115
v_lshlrev_b32 v132, 16, v116
v_and_b32 v133, s30, v116
v_lshlrev_b32 v134, 16, v117
v_and_b32 v135, s30, v117
v_lshlrev_b32 v136, 16, v118
v_and_b32 v137, s30, v118
v_lshlrev_b32 v138, 16, v119
v_and_b32 v139, s30, v119
v_sub_f32 v233, v132, v124
v_sub_f32 v234, v133, v125
v_cvt_pk_bf16_f32 v144, v233, v234
v_sub_f32 v233, v134, v126
v_sub_f32 v234, v135, v127
v_cvt_pk_bf16_f32 v145, v233, v234
v_sub_f32 v233, v136, v128
v_sub_f32 v234, v137, v129
v_cvt_pk_bf16_f32 v146, v233, v234
v_sub_f32 v233, v138, v130
v_sub_f32 v234, v139, v131
v_cvt_pk_bf16_f32 v147, v233, v234
ds_write_b128 v155, v[144:147] offset:32512
s_waitcnt lgkmcnt(0)
s_barrier
v_lshlrev_b32 v124, 16, v8
v_and_b32 v125, s30, v8
v_lshlrev_b32 v126, 16, v9
v_and_b32 v127, s30, v9
v_lshlrev_b32 v128, 16, v10
v_and_b32 v129, s30, v10
v_lshlrev_b32 v130, 16, v11
v_and_b32 v131, s30, v11
v_lshlrev_b32 v132, 16, v16
v_and_b32 v133, s30, v16
v_lshlrev_b32 v134, 16, v17
v_and_b32 v135, s30, v17
v_lshlrev_b32 v136, 16, v18
v_and_b32 v137, s30, v18
v_lshlrev_b32 v138, 16, v19
v_and_b32 v139, s30, v19
v_sub_f32 v233, v124, v132
v_sub_f32 v234, v125, v133
v_cvt_pk_bf16_f32 v140, v233, v234
v_sub_f32 v233, v126, v134
v_sub_f32 v234, v127, v135
v_cvt_pk_bf16_f32 v141, v233, v234
v_sub_f32 v233, v128, v136
v_sub_f32 v234, v129, v137
v_cvt_pk_bf16_f32 v142, v233, v234
v_sub_f32 v233, v130, v138
v_sub_f32 v234, v131, v139
v_cvt_pk_bf16_f32 v143, v233, v234
ds_write_b128 v156, v[140:143] offset:0
v_lshlrev_b32 v124, 16, v24
v_and_b32 v125, s30, v24
v_lshlrev_b32 v126, 16, v25
v_and_b32 v127, s30, v25
v_lshlrev_b32 v128, 16, v26
v_and_b32 v129, s30, v26
v_lshlrev_b32 v130, 16, v27
v_and_b32 v131, s30, v27
v_sub_f32 v233, v132, v124
v_sub_f32 v234, v133, v125
v_cvt_pk_bf16_f32 v144, v233, v234
v_sub_f32 v233, v134, v126
v_sub_f32 v234, v135, v127
v_cvt_pk_bf16_f32 v145, v233, v234
v_sub_f32 v233, v136, v128
v_sub_f32 v234, v137, v129
v_cvt_pk_bf16_f32 v146, v233, v234
v_sub_f32 v233, v138, v130
v_sub_f32 v234, v139, v131
v_cvt_pk_bf16_f32 v147, v233, v234
ds_write_b128 v157, v[144:147] offset:0
v_lshlrev_b32 v132, 16, v32
v_and_b32 v133, s30, v32
v_lshlrev_b32 v134, 16, v33
v_and_b32 v135, s30, v33
v_lshlrev_b32 v136, 16, v34
v_and_b32 v137, s30, v34
v_lshlrev_b32 v138, 16, v35
v_and_b32 v139, s30, v35
v_sub_f32 v233, v124, v132
v_sub_f32 v234, v125, v133
v_cvt_pk_bf16_f32 v140, v233, v234
v_sub_f32 v233, v126, v134
v_sub_f32 v234, v127, v135
v_cvt_pk_bf16_f32 v141, v233, v234
v_sub_f32 v233, v128, v136
v_sub_f32 v234, v129, v137
v_cvt_pk_bf16_f32 v142, v233, v234
v_sub_f32 v233, v130, v138
v_sub_f32 v234, v131, v139
v_cvt_pk_bf16_f32 v143, v233, v234
ds_write_b128 v158, v[140:143] offset:0
s_waitcnt vmcnt(2)
v_lshlrev_b32 v124, 16, v40
v_and_b32 v125, s30, v40
v_lshlrev_b32 v126, 16, v41
v_and_b32 v127, s30, v41
v_lshlrev_b32 v128, 16, v42
v_and_b32 v129, s30, v42
v_lshlrev_b32 v130, 16, v43
v_and_b32 v131, s30, v43
v_sub_f32 v233, v132, v124
v_sub_f32 v234, v133, v125
v_cvt_pk_bf16_f32 v144, v233, v234
v_sub_f32 v233, v134, v126
v_sub_f32 v234, v135, v127
v_cvt_pk_bf16_f32 v145, v233, v234
v_sub_f32 v233, v136, v128
v_sub_f32 v234, v137, v129
v_cvt_pk_bf16_f32 v146, v233, v234
v_sub_f32 v233, v138, v130
v_sub_f32 v234, v139, v131
v_cvt_pk_bf16_f32 v147, v233, v234
ds_write_b128 v159, v[144:147] offset:0
v_lshlrev_b32 v124, 16, v48
v_and_b32 v125, s30, v48
v_lshlrev_b32 v126, 16, v49
v_and_b32 v127, s30, v49
v_lshlrev_b32 v128, 16, v50
v_and_b32 v129, s30, v50
v_lshlrev_b32 v130, 16, v51
v_and_b32 v131, s30, v51
v_lshlrev_b32 v132, 16, v56
v_and_b32 v133, s30, v56
v_lshlrev_b32 v134, 16, v57
v_and_b32 v135, s30, v57
v_lshlrev_b32 v136, 16, v58
v_and_b32 v137, s30, v58
v_lshlrev_b32 v138, 16, v59
v_and_b32 v139, s30, v59
v_sub_f32 v233, v124, v132
v_sub_f32 v234, v125, v133
v_cvt_pk_bf16_f32 v140, v233, v234
v_sub_f32 v233, v126, v134
v_sub_f32 v234, v127, v135
v_cvt_pk_bf16_f32 v141, v233, v234
v_sub_f32 v233, v128, v136
v_sub_f32 v234, v129, v137
v_cvt_pk_bf16_f32 v142, v233, v234
v_sub_f32 v233, v130, v138
v_sub_f32 v234, v131, v139
v_cvt_pk_bf16_f32 v143, v233, v234
ds_write_b128 v156, v[140:143] offset:16256
v_lshlrev_b32 v124, 16, v64
v_and_b32 v125, s30, v64
v_lshlrev_b32 v126, 16, v65
v_and_b32 v127, s30, v65
v_lshlrev_b32 v128, 16, v66
v_and_b32 v129, s30, v66
v_lshlrev_b32 v130, 16, v67
v_and_b32 v131, s30, v67
v_sub_f32 v233, v132, v124
v_sub_f32 v234, v133, v125
v_cvt_pk_bf16_f32 v144, v233, v234
v_sub_f32 v233, v134, v126
v_sub_f32 v234, v135, v127
v_cvt_pk_bf16_f32 v145, v233, v234
v_sub_f32 v233, v136, v128
v_sub_f32 v234, v137, v129
v_cvt_pk_bf16_f32 v146, v233, v234
v_sub_f32 v233, v138, v130
v_sub_f32 v234, v139, v131
v_cvt_pk_bf16_f32 v147, v233, v234
ds_write_b128 v157, v[144:147] offset:16256
v_lshlrev_b32 v132, 16, v72
v_and_b32 v133, s30, v72
v_lshlrev_b32 v134, 16, v73
v_and_b32 v135, s30, v73
v_lshlrev_b32 v136, 16, v74
v_and_b32 v137, s30, v74
v_lshlrev_b32 v138, 16, v75
v_and_b32 v139, s30, v75
v_sub_f32 v233, v124, v132
v_sub_f32 v234, v125, v133
v_cvt_pk_bf16_f32 v140, v233, v234
v_sub_f32 v233, v126, v134
v_sub_f32 v234, v127, v135
v_cvt_pk_bf16_f32 v141, v233, v234
v_sub_f32 v233, v128, v136
v_sub_f32 v234, v129, v137
v_cvt_pk_bf16_f32 v142, v233, v234
v_sub_f32 v233, v130, v138
v_sub_f32 v234, v131, v139
v_cvt_pk_bf16_f32 v143, v233, v234
ds_write_b128 v158, v[140:143] offset:16256
s_waitcnt vmcnt(1)
v_lshlrev_b32 v124, 16, v80
v_and_b32 v125, s30, v80
v_lshlrev_b32 v126, 16, v81
v_and_b32 v127, s30, v81
v_lshlrev_b32 v128, 16, v82
v_and_b32 v129, s30, v82
v_lshlrev_b32 v130, 16, v83
v_and_b32 v131, s30, v83
v_sub_f32 v233, v132, v124
v_sub_f32 v234, v133, v125
v_cvt_pk_bf16_f32 v144, v233, v234
v_sub_f32 v233, v134, v126
v_sub_f32 v234, v135, v127
v_cvt_pk_bf16_f32 v145, v233, v234
v_sub_f32 v233, v136, v128
v_sub_f32 v234, v137, v129
v_cvt_pk_bf16_f32 v146, v233, v234
v_sub_f32 v233, v138, v130
v_sub_f32 v234, v139, v131
v_cvt_pk_bf16_f32 v147, v233, v234
ds_write_b128 v159, v[144:147] offset:16256
v_lshlrev_b32 v124, 16, v88
v_and_b32 v125, s30, v88
v_lshlrev_b32 v126, 16, v89
v_and_b32 v127, s30, v89
v_lshlrev_b32 v128, 16, v90
v_and_b32 v129, s30, v90
v_lshlrev_b32 v130, 16, v91
v_and_b32 v131, s30, v91
v_lshlrev_b32 v132, 16, v96
v_and_b32 v133, s30, v96
v_lshlrev_b32 v134, 16, v97
v_and_b32 v135, s30, v97
v_lshlrev_b32 v136, 16, v98
v_and_b32 v137, s30, v98
v_lshlrev_b32 v138, 16, v99
v_and_b32 v139, s30, v99
v_sub_f32 v233, v124, v132
v_sub_f32 v234, v125, v133
v_cvt_pk_bf16_f32 v140, v233, v234
v_sub_f32 v233, v126, v134
v_sub_f32 v234, v127, v135
v_cvt_pk_bf16_f32 v141, v233, v234
v_sub_f32 v233, v128, v136
v_sub_f32 v234, v129, v137
v_cvt_pk_bf16_f32 v142, v233, v234
v_sub_f32 v233, v130, v138
v_sub_f32 v234, v131, v139
v_cvt_pk_bf16_f32 v143, v233, v234
ds_write_b128 v156, v[140:143] offset:32512
v_lshlrev_b32 v124, 16, v104
v_and_b32 v125, s30, v104
v_lshlrev_b32 v126, 16, v105
v_and_b32 v127, s30, v105
v_lshlrev_b32 v128, 16, v106
v_and_b32 v129, s30, v106
v_lshlrev_b32 v130, 16, v107
v_and_b32 v131, s30, v107
v_sub_f32 v233, v132, v124
v_sub_f32 v234, v133, v125
v_cvt_pk_bf16_f32 v144, v233, v234
v_sub_f32 v233, v134, v126
v_sub_f32 v234, v135, v127
v_cvt_pk_bf16_f32 v145, v233, v234
v_sub_f32 v233, v136, v128
v_sub_f32 v234, v137, v129
v_cvt_pk_bf16_f32 v146, v233, v234
v_sub_f32 v233, v138, v130
v_sub_f32 v234, v139, v131
v_cvt_pk_bf16_f32 v147, v233, v234
ds_write_b128 v157, v[144:147] offset:32512
v_lshlrev_b32 v132, 16, v112
v_and_b32 v133, s30, v112
v_lshlrev_b32 v134, 16, v113
v_and_b32 v135, s30, v113
v_lshlrev_b32 v136, 16, v114
v_and_b32 v137, s30, v114
v_lshlrev_b32 v138, 16, v115
v_and_b32 v139, s30, v115
v_sub_f32 v233, v124, v132
v_sub_f32 v234, v125, v133
v_cvt_pk_bf16_f32 v140, v233, v234
v_sub_f32 v233, v126, v134
v_sub_f32 v234, v127, v135
v_cvt_pk_bf16_f32 v141, v233, v234
v_sub_f32 v233, v128, v136
v_sub_f32 v234, v129, v137
v_cvt_pk_bf16_f32 v142, v233, v234
v_sub_f32 v233, v130, v138
v_sub_f32 v234, v131, v139
v_cvt_pk_bf16_f32 v143, v233, v234
ds_write_b128 v158, v[140:143] offset:32512
s_waitcnt vmcnt(0)
v_lshlrev_b32 v124, 16, v120
v_and_b32 v125, s30, v120
v_lshlrev_b32 v126, 16, v121
v_and_b32 v127, s30, v121
v_lshlrev_b32 v128, 16, v122
v_and_b32 v129, s30, v122
v_lshlrev_b32 v130, 16, v123
v_and_b32 v131, s30, v123
v_sub_f32 v233, v132, v124
v_sub_f32 v234, v133, v125
v_cvt_pk_bf16_f32 v144, v233, v234
v_sub_f32 v233, v134, v126
v_sub_f32 v234, v135, v127
v_cvt_pk_bf16_f32 v145, v233, v234
v_sub_f32 v233, v136, v128
v_sub_f32 v234, v137, v129
v_cvt_pk_bf16_f32 v146, v233, v234
v_sub_f32 v233, v138, v130
v_sub_f32 v234, v139, v131
v_cvt_pk_bf16_f32 v147, v233, v234
ds_write_b128 v159, v[144:147] offset:32512
s_lshl_b32 s32, s29, 1
s_add_u32 s32, s32, s25
s_mul_i32 s32, s32, 224
s_lshl_b32 s33, s35, 1
s_add_u32 s33, s33, s26
s_add_u32 s32, s32, s33
s_mul_i32 s32, s32, 384
s_mov_b32 s33, 172032
s_lshl_b32 s36, s31, 6
s_add_u32 s36, s36, 0
v_add_u32 v236, s36, v0
v_mul_u32_u24 v237, 2731, v236
v_lshrrev_b32 v237, 16, v237
v_mul_u32_u24 v238, 24, v237
v_sub_u32 v238, v236, v238
v_mul_u32_u24 v160, 400, v237
v_lshl_add_u32 v160, v238, 4, v160
v_mul_u32_u24 v239, 147, v237
v_lshrrev_b32 v239, 10, v239
v_mul_u32_u24 v240, 7, v239
v_sub_u32 v240, v237, v240
v_mul_u32_u24 v240, 1536, v240
v_lshl_add_u32 v240, v238, 4, v240
v_mul_lo_u32 v239, v239, s33
v_add_u32 v240, v240, v239
v_add_u32 v240, s32, v240
v_mov_b32 v171, v240
s_lshl_b32 s36, s31, 6
s_add_u32 s36, s36, 256
v_add_u32 v236, s36, v0
v_mul_u32_u24 v237, 2731, v236
v_lshrrev_b32 v237, 16, v237
v_mul_u32_u24 v238, 24, v237
v_sub_u32 v238, v236, v238
v_mul_u32_u24 v161, 400, v237
v_lshl_add_u32 v161, v238, 4, v161
v_mul_u32_u24 v239, 147, v237
v_lshrrev_b32 v239, 10, v239
v_mul_u32_u24 v240, 7, v239
v_sub_u32 v240, v237, v240
v_mul_u32_u24 v240, 1536, v240
v_lshl_add_u32 v240, v238, 4, v240
v_mul_lo_u32 v239, v239, s33
v_add_u32 v240, v240, v239
v_add_u32 v240, s32, v240
v_mov_b32 v172, v240
s_lshl_b32 s36, s31, 6
s_add_u32 s36, s36, 512
v_add_u32 v236, s36, v0
v_mul_u32_u24 v237, 2731, v236
v_lshrrev_b32 v237, 16, v237
v_mul_u32_u24 v238, 24, v237
v_sub_u32 v238, v236, v238
v_mul_u32_u24 v162, 400, v237
v_lshl_add_u32 v162, v238, 4, v162
v_mul_u32_u24 v239, 147, v237
v_lshrrev_b32 v239, 10, v239
v_mul_u32_u24 v240, 7, v239
v_sub_u32 v240, v237, v240
v_mul_u32_u24 v240, 1536, v240
v_lshl_add_u32 v240, v238, 4, v240
v_mul_lo_u32 v239, v239, s33
v_add_u32 v240, v240, v239
v_add_u32 v240, s32, v240
v_mov_b32 v173, v240
s_lshl_b32 s36, s31, 6
s_add_u32 s36, s36, 768
v_add_u32 v236, s36, v0
v_mul_u32_u24 v237, 2731, v236
v_lshrrev_b32 v237, 16, v237
v_mul_u32_u24 v238, 24, v237
v_sub_u32 v238, v236, v238
v_mul_u32_u24 v163, 400, v237
v_lshl_add_u32 v163, v238, 4, v163
v_mul_u32_u24 v239, 147, v237
v_lshrrev_b32 v239, 10, v239
v_mul_u32_u24 v240, 7, v239
v_sub_u32 v240, v237, v240
v_mul_u32_u24 v240, 1536, v240
v_lshl_add_u32 v240, v238, 4, v240
v_mul_lo_u32 v239, v239, s33
v_add_u32 v240, v240, v239
v_add_u32 v240, s32, v240
v_mov_b32 v174, v240
s_lshl_b32 s36, s31, 6
s_add_u32 s36, s36, 1024
v_add_u32 v236, s36, v0
v_mul_u32_u24 v237, 2731, v236
v_lshrrev_b32 v237, 16, v237
v_mul_u32_u24 v238, 24, v237
v_sub_u32 v238, v236, v238
v_mul_u32_u24 v164, 400, v237
v_lshl_add_u32 v164, v238, 4, v164
v_mul_u32_u24 v239, 147, v237
v_lshrrev_b32 v239, 10, v239
v_mul_u32_u24 v240, 7, v239
v_sub_u32 v240, v237, v240
v_mul_u32_u24 v240, 1536, v240
v_lshl_add_u32 v240, v238, 4, v240
v_mul_lo_u32 v239, v239, s33
v_add_u32 v240, v240, v239
v_add_u32 v240, s32, v240
v_mov_b32 v175, v240
s_lshl_b32 s36, s31, 6
s_add_u32 s36, s36, 1280
v_add_u32 v236, s36, v0
v_mul_u32_u24 v237, 2731, v236
v_lshrrev_b32 v237, 16, v237
v_mul_u32_u24 v238, 24, v237
v_sub_u32 v238, v236, v238
v_mul_u32_u24 v165, 400, v237
v_lshl_add_u32 v165, v238, 4, v165
v_mul_u32_u24 v239, 147, v237
v_lshrrev_b32 v239, 10, v239
v_mul_u32_u24 v240, 7, v239
v_sub_u32 v240, v237, v240
v_mul_u32_u24 v240, 1536, v240
v_lshl_add_u32 v240, v238, 4, v240
v_mul_lo_u32 v239, v239, s33
v_add_u32 v240, v240, v239
v_add_u32 v240, s32, v240
v_mov_b32 v176, v240
s_lshl_b32 s36, s31, 6
s_add_u32 s36, s36, 1536
v_add_u32 v236, s36, v0
v_mul_u32_u24 v237, 2731, v236
v_lshrrev_b32 v237, 16, v237
v_mul_u32_u24 v238, 24, v237
v_sub_u32 v238, v236, v238
v_mul_u32_u24 v166, 400, v237
v_lshl_add_u32 v166, v238, 4, v166
v_mul_u32_u24 v239, 147, v237
v_lshrrev_b32 v239, 10, v239
v_mul_u32_u24 v240, 7, v239
v_sub_u32 v240, v237, v240
v_mul_u32_u24 v240, 1536, v240
v_lshl_add_u32 v240, v238, 4, v240
v_mul_lo_u32 v239, v239, s33
v_add_u32 v240, v240, v239
v_add_u32 v240, s32, v240
v_mov_b32 v177, v240
s_lshl_b32 s36, s31, 6
s_add_u32 s36, s36, 1792
v_add_u32 v236, s36, v0
v_mul_u32_u24 v237, 2731, v236
v_lshrrev_b32 v237, 16, v237
v_mul_u32_u24 v238, 24, v237
v_sub_u32 v238, v236, v238
v_mul_u32_u24 v167, 400, v237
v_lshl_add_u32 v167, v238, 4, v167
v_mul_u32_u24 v239, 147, v237
v_lshrrev_b32 v239, 10, v239
v_mul_u32_u24 v240, 7, v239
v_sub_u32 v240, v237, v240
v_mul_u32_u24 v240, 1536, v240
v_lshl_add_u32 v240, v238, 4, v240
v_mul_lo_u32 v239, v239, s33
v_add_u32 v240, v240, v239
v_add_u32 v240, s32, v240
v_mov_b32 v178, v240
s_lshl_b32 s36, s31, 6
s_add_u32 s36, s36, 2048
v_add_u32 v236, s36, v0
v_mul_u32_u24 v237, 2731, v236
v_lshrrev_b32 v237, 16, v237
v_mul_u32_u24 v238, 24, v237
v_sub_u32 v238, v236, v238
v_mul_u32_u24 v168, 400, v237
v_lshl_add_u32 v168, v238, 4, v168
v_mul_u32_u24 v239, 147, v237
v_lshrrev_b32 v239, 10, v239
v_mul_u32_u24 v240, 7, v239
v_sub_u32 v240, v237, v240
v_mul_u32_u24 v240, 1536, v240
v_lshl_add_u32 v240, v238, 4, v240
v_mul_lo_u32 v239, v239, s33
v_add_u32 v240, v240, v239
v_add_u32 v240, s32, v240
v_mov_b32 v179, v240
s_lshl_b32 s36, s31, 6
s_add_u32 s36, s36, 2304
v_add_u32 v236, s36, v0
v_mul_u32_u24 v237, 2731, v236
v_lshrrev_b32 v237, 16, v237
v_mul_u32_u24 v238, 24, v237
v_sub_u32 v238, v236, v238
v_mul_u32_u24 v169, 400, v237
v_lshl_add_u32 v169, v238, 4, v169
v_mul_u32_u24 v239, 147, v237
v_lshrrev_b32 v239, 10, v239
v_mul_u32_u24 v240, 7, v239
v_sub_u32 v240, v237, v240
v_mul_u32_u24 v240, 1536, v240
v_lshl_add_u32 v240, v238, 4, v240
v_mul_lo_u32 v239, v239, s33
v_add_u32 v240, v240, v239
v_add_u32 v240, s32, v240
v_mov_b32 v180, v240
s_lshl_b32 s36, s31, 6
s_add_u32 s36, s36, 2560
v_add_u32 v236, s36, v0
v_mul_u32_u24 v237, 2731, v236
v_lshrrev_b32 v237, 16, v237
v_mul_u32_u24 v238, 24, v237
v_sub_u32 v238, v236, v238
v_mul_u32_u24 v170, 400, v237
v_lshl_add_u32 v170, v238, 4, v170
v_mul_u32_u24 v239, 147, v237
v_lshrrev_b32 v239, 10, v239
v_mul_u32_u24 v240, 7, v239
v_sub_u32 v240, v237, v240
v_mul_u32_u24 v240, 1536, v240
v_lshl_add_u32 v240, v238, 4, v240
v_mul_lo_u32 v239, v239, s33
v_add_u32 v240, v240, v239
v_add_u32 v240, s32, v240
v_mov_b32 v239, 0x7ff00000
v_cmp_gt_u32 vcc, 112, v237
s_nop 1
v_cndmask_b32 v181, v239, v240, vcc
s_waitcnt lgkmcnt(0)
s_barrier
s_barrier
s_mov_b32 s36, 0
ds_read_b128 v[184:187], v160 offset:0
ds_read_b128 v[188:191], v161 offset:0
ds_read_b128 v[192:195], v162 offset:0
s_waitcnt lgkmcnt(2)
buffer_store_dwordx4 v[184:187], v171, s[16:19], s36 offen nt
s_waitcnt lgkmcnt(1)
buffer_store_dwordx4 v[188:191], v172, s[16:19], s36 offen nt
s_waitcnt lgkmcnt(0)
buffer_store_dwordx4 v[192:195], v173, s[16:19], s36 offen nt
s_barrier
s_mov_b32 s36, 0
ds_read_b128 v[196:199], v163 offset:0
ds_read_b128 v[200:203], v164 offset:0
ds_read_b128 v[204:207], v165 offset:0
s_waitcnt lgkmcnt(2)
buffer_store_dwordx4 v[196:199], v174, s[16:19], s36 offen nt
s_waitcnt lgkmcnt(1)
buffer_store_dwordx4 v[200:203], v175, s[16:19], s36 offen nt
s_waitcnt lgkmcnt(0)
buffer_store_dwordx4 v[204:207], v176, s[16:19], s36 offen nt
s_barrier
s_mov_b32 s36, 0
ds_read_b128 v[208:211], v166 offset:0
ds_read_b128 v[212:215], v167 offset:0
ds_read_b128 v[216:219], v168 offset:0
s_waitcnt lgkmcnt(2)
buffer_store_dwordx4 v[208:211], v177, s[16:19], s36 offen nt
s_waitcnt lgkmcnt(1)
buffer_store_dwordx4 v[212:215], v178, s[16:19], s36 offen nt
s_waitcnt lgkmcnt(0)
buffer_store_dwordx4 v[216:219], v179, s[16:19], s36 offen nt
s_barrier
s_mov_b32 s36, 0
ds_read_b128 v[220:223], v169 offset:0
ds_read_b128 v[224:227], v170 offset:0
s_waitcnt lgkmcnt(1)
buffer_store_dwordx4 v[220:223], v180, s[16:19], s36 offen nt
s_waitcnt lgkmcnt(0)
buffer_store_dwordx4 v[224:227], v181, s[16:19], s36 offen nt
v_add_u32 v160, 97536, v160
v_add_u32 v161, 97536, v161
v_add_u32 v162, 97536, v162
v_add_u32 v163, 97536, v163
v_add_u32 v164, 97536, v164
v_add_u32 v165, 97536, v165
v_add_u32 v166, 97536, v166
v_add_u32 v167, 97536, v167
v_add_u32 v168, 97536, v168
v_add_u32 v169, 97536, v169
v_add_u32 v170, 97536, v170
s_barrier
s_mov_b32 s36, 768
ds_read_b128 v[184:187], v160 offset:0
ds_read_b128 v[188:191], v161 offset:0
ds_read_b128 v[192:195], v162 offset:0
s_waitcnt lgkmcnt(2)
buffer_store_dwordx4 v[184:187], v171, s[16:19], s36 offen nt
s_waitcnt lgkmcnt(1)
buffer_store_dwordx4 v[188:191], v172, s[16:19], s36 offen nt
s_waitcnt lgkmcnt(0)
buffer_store_dwordx4 v[192:195], v173, s[16:19], s36 offen nt
s_barrier
s_mov_b32 s36, 768
ds_read_b128 v[196:199], v163 offset:0
ds_read_b128 v[200:203], v164 offset:0
ds_read_b128 v[204:207], v165 offset:0
s_waitcnt lgkmcnt(2)
buffer_store_dwordx4 v[196:199], v174, s[16:19], s36 offen nt
s_waitcnt lgkmcnt(1)
buffer_store_dwordx4 v[200:203], v175, s[16:19], s36 offen nt
s_waitcnt lgkmcnt(0)
buffer_store_dwordx4 v[204:207], v176, s[16:19], s36 offen nt
s_barrier
s_mov_b32 s36, 768
ds_read_b128 v[208:211], v166 offset:0
ds_read_b128 v[212:215], v167 offset:0
ds_read_b128 v[216:219], v168 offset:0
s_waitcnt lgkmcnt(2)
buffer_store_dwordx4 v[208:211], v177, s[16:19], s36 offen nt
s_waitcnt lgkmcnt(1)
buffer_store_dwordx4 v[212:215], v178, s[16:19], s36 offen nt
s_waitcnt lgkmcnt(0)
buffer_store_dwordx4 v[216:219], v179, s[16:19], s36 offen nt
s_barrier
s_mov_b32 s36, 768
ds_read_b128 v[220:223], v169 offset:0
ds_read_b128 v[224:227], v170 offset:0
s_waitcnt lgkmcnt(1)
buffer_store_dwordx4 v[220:223], v180, s[16:19], s36 offen nt
s_waitcnt lgkmcnt(0)
buffer_store_dwordx4 v[224:227], v181, s[16:19], s36 offen nt
s_endpgm
L_prod_h1:
s_setprio 3
s_mov_b32 s35, s30
v_lshrrev_b32 v228, 3, v0
v_and_b32 v229, 7, v0
s_lshr_b32 s32, s31, 1
s_lshl_b32 s33, s32, 3
v_add_u32 v230, s33, v228
s_sub_u32 s33, s29, 1
v_add_u32 v231, s33, v230
s_add_i32 s33, s30, 7
s_lshl_b32 s33, s33, 1
s_add_u32 s33, s33, s26
v_lshl_add_u32 v232, v231, 1, s25
v_mul_u32_u24 v232, 224, v232
v_add_u32 v232, s33, v232
v_mul_u32_u24 v232, 384, v232
v_lshl_add_u32 v232, v229, 4, v232
v_mov_b32 v234, 0x7ff00000
v_cmp_gt_u32 vcc, 112, v231
s_nop 1
v_cndmask_b32 v148, v234, v232, vcc
v_add_u32 v149, 3840, v148
s_cmp_eq_u32 s30, 98
s_cselect_b32 s33, 1, 0
v_mov_b32 v233, s33
v_add_u32 v150, 1536, v149
v_cmp_eq_u32 vcc, 0, v233
s_nop 1
v_cndmask_b32 v150, v234, v150, vcc
s_add_u32 s33, s29, 15
s_add_u32 s33, s33, s32
s_lshl_b32 s36, s33, 1
s_add_u32 s36, s36, s25
s_mul_i32 s36, s36, 224
v_lshl_add_u32 v235, v228, 1, s30
v_lshl_add_u32 v232, v235, 1, s26
v_add_u32 v232, s36, v232
v_mul_u32_u24 v232, 384, v232
v_lshl_add_u32 v232, v229, 4, v232
s_cmp_lt_u32 s33, 112
s_cselect_b32 s36, 7, 0
v_cmp_gt_u32 vcc, s36, v228
s_nop 1
v_cndmask_b32 v244, v234, v232, vcc
v_subrev_u32 v245, 768, v244
v_cmp_ne_u32 vcc, 0, v235
s_nop 1
v_cndmask_b32 v245, v234, v245, vcc
v_add_u32 v246, 1536, v244
v_cmp_gt_u32 vcc, 110, v235
s_nop 1
v_cndmask_b32 v246, v234, v246, vcc
s_waitcnt lgkmcnt(0)
s_mov_b32 s8, s4
s_mov_b32 s9, s5
s_mov_b32 s10, 19267584
s_mov_b32 s11, 0x20000
s_mov_b32 s72, s6
s_mov_b32 s73, s7
s_mov_b32 s74, 663552
s_mov_b32 s75, 0x20000
s_mov_b32 s12, s20
s_mov_b32 s13, s21
s_mov_b32 s14, 884736
s_mov_b32 s15, 0x20000
s_mov_b32 s16, s68
s_mov_b32 s17, s69
s_mov_b32 s18, 19267584
s_mov_b32 s19, 0x20000
s_mov_b32 s76, s70
s_mov_b32 s77, s71
s_mov_b32 s78, 256
s_mov_b32 s79, 0x20000
buffer_load_dwordx4 v[4:7], v148, s[8:11], 0 offen offset:0 nt
buffer_load_dwordx4 v[12:15], v148, s[8:11], 0 offen offset:1536 nt
buffer_load_dwordx4 v[20:23], v148, s[8:11], 0 offen offset:3072 nt
buffer_load_dwordx4 v[28:31], v149, s[8:11], 0 offen offset:768 nt
buffer_load_dwordx4 v[36:39], v245, s[8:11], 0 offen offset:0 nt
buffer_load_dwordx4 v[40:43], v244, s[8:11], 0 offen offset:768 nt
s_mov_b32 s30, 0xffff0000
v_mul_u32_u24 v235, 7, v230
v_add_u32 v235, 4, v235
v_bfe_u32 v233, v235, 2, 1
v_lshlrev_b32 v233, 1, v233
v_and_b32 v232, 3, v229
v_xor_b32 v233, v233, v232
v_lshlrev_b32 v233, 4, v233
v_lshl_add_u32 v233, v235, 6, v233
v_lshrrev_b32 v232, 2, v229
v_mul_u32_u24 v232, 8128, v232
v_add_u32 v152, v233, v232
v_add_u32 v156, 48768, v152
v_mul_u32_u24 v235, 7, v230
v_add_u32 v235, 5, v235
v_bfe_u32 v233, v235, 2, 1
v_lshlrev_b32 v233, 1, v233
v_and_b32 v232, 3, v229
v_xor_b32 v233, v233, v232
v_lshlrev_b32 v233, 4, v233
v_lshl_add_u32 v233, v235, 6, v233
v_lshrrev_b32 v232, 2, v229
v_mul_u32_u24 v232, 8128, v232
v_add_u32 v153, v233, v232
v_add_u32 v157, 48768, v153
v_mul_u32_u24 v235, 7, v230
v_add_u32 v235, 6, v235
v_bfe_u32 v233, v235, 2, 1
v_lshlrev_b32 v233, 1, v233
v_and_b32 v232, 3, v229
v_xor_b32 v233, v233, v232
v_lshlrev_b32 v233, 4, v233
v_lshl_add_u32 v233, v235, 6, v233
v_lshrrev_b32 v232, 2, v229
v_mul_u32_u24 v232, 8128, v232
v_add_u32 v154, v233, v232
v_add_u32 v158, 48768, v154
s_add_u32 s33, s32, 16
s_mul_i32 s33, s33, 7
v_add_u32 v235, s33, v228
v_bfe_u32 v233, v235, 2, 1
v_lshlrev_b32 v233, 1, v233
v_and_b32 v232, 3, v229
v_xor_b32 v233, v233, v232
v_lshlrev_b32 v233, 4, v233
v_lshl_add_u32 v233, v235, 6, v233
v_lshrrev_b32 v232, 2, v229
v_mul_u32_u24 v232, 8128, v232
v_add_u32 v247, v233, v232
v_add_u32 v233, 0x100000, v247
v_cmp_gt_u32 vcc, 7, v228
s_nop 1
v_cndmask_b32 v247, v233, v247, vcc
v_add_u32 v248, 48768, v247
s_waitcnt vmcnt(4)
v_lshlrev_b32 v124, 16, v4
v_and_b32 v125, s30, v4
v_lshlrev_b32 v126, 16, v5
v_and_b32 v127, s30, v5
v_lshlrev_b32 v128, 16, v6
v_and_b32 v129, s30, v6
v_lshlrev_b32 v130, 16, v7
v_and_b32 v131, s30, v7
v_lshlrev_b32 v132, 16, v12
v_and_b32 v133, s30, v12
v_lshlrev_b32 v134, 16, v13
v_and_b32 v135, s30, v13
v_lshlrev_b32 v136, 16, v14
v_and_b32 v137, s30, v14
v_lshlrev_b32 v138, 16, v15
v_and_b32 v139, s30, v15
v_sub_f32 v233, v124, v132
v_sub_f32 v234, v125, v133
v_cvt_pk_bf16_f32 v140, v233, v234
v_sub_f32 v233, v126, v134
v_sub_f32 v234, v127, v135
v_cvt_pk_bf16_f32 v141, v233, v234
v_sub_f32 v233, v128, v136
v_sub_f32 v234, v129, v137
v_cvt_pk_bf16_f32 v142, v233, v234
v_sub_f32 v233, v130, v138
v_sub_f32 v234, v131, v139
v_cvt_pk_bf16_f32 v143, v233, v234
ds_write_b128 v152, v[140:143] offset:0
s_waitcnt vmcnt(3)
v_lshlrev_b32 v124, 16, v20
v_and_b32 v125, s30, v20
v_lshlrev_b32 v126, 16, v21
v_and_b32 v127, s30, v21
v_lshlrev_b32 v128, 16, v22
v_and_b32 v129, s30, v22
v_lshlrev_b32 v130, 16, v23
v_and_b32 v131, s30, v23
v_sub_f32 v233, v132, v124
v_sub_f32 v234, v133, v125
v_cvt_pk_bf16_f32 v144, v233, v234
v_sub_f32 v233, v134, v126
v_sub_f32 v234, v135, v127
v_cvt_pk_bf16_f32 v145, v233, v234
v_sub_f32 v233, v136, v128
v_sub_f32 v234, v137, v129
v_cvt_pk_bf16_f32 v146, v233, v234
v_sub_f32 v233, v138, v130
v_sub_f32 v234, v139, v131
v_cvt_pk_bf16_f32 v147, v233, v234
ds_write_b128 v153, v[144:147] offset:0
s_waitcnt vmcnt(2)
v_lshlrev_b32 v132, 16, v28
v_and_b32 v133, s30, v28
v_lshlrev_b32 v134, 16, v29
v_and_b32 v135, s30, v29
v_lshlrev_b32 v136, 16, v30
v_and_b32 v137, s30, v30
v_lshlrev_b32 v138, 16, v31
v_and_b32 v139, s30, v31
v_sub_f32 v233, v124, v132
v_sub_f32 v234, v125, v133
v_cvt_pk_bf16_f32 v140, v233, v234
v_sub_f32 v233, v126, v134
v_sub_f32 v234, v127, v135
v_cvt_pk_bf16_f32 v141, v233, v234
v_sub_f32 v233, v128, v136
v_sub_f32 v234, v129, v137
v_cvt_pk_bf16_f32 v142, v233, v234
v_sub_f32 v233, v130, v138
v_sub_f32 v234, v131, v139
v_cvt_pk_bf16_f32 v143, v233, v234
ds_write_b128 v154, v[140:143] offset:0
s_waitcnt vmcnt(0)
v_lshlrev_b32 v124, 16, v36
v_and_b32 v125, s30, v36
v_lshlrev_b32 v126, 16, v37
v_and_b32 v127, s30, v37
v_lshlrev_b32 v128, 16, v38
v_and_b32 v129, s30, v38
v_lshlrev_b32 v130, 16, v39
v_and_b32 v131, s30, v39
v_lshlrev_b32 v132, 16, v40
v_and_b32 v133, s30, v40
v_lshlrev_b32 v134, 16, v41
v_and_b32 v135, s30, v41
v_lshlrev_b32 v136, 16, v42
v_and_b32 v137, s30, v42
v_lshlrev_b32 v138, 16, v43
v_and_b32 v139, s30, v43
v_sub_f32 v233, v124, v132
v_sub_f32 v234, v125, v133
v_cvt_pk_bf16_f32 v144, v233, v234
v_sub_f32 v233, v126, v134
v_sub_f32 v234, v127, v135
v_cvt_pk_bf16_f32 v145, v233, v234
v_sub_f32 v233, v128, v136
v_sub_f32 v234, v129, v137
v_cvt_pk_bf16_f32 v146, v233, v234
v_sub_f32 v233, v130, v138
v_sub_f32 v234, v131, v139
v_cvt_pk_bf16_f32 v147, v233, v234
ds_write_b128 v247, v[144:147] offset:0
buffer_load_dwordx4 v[44:47], v148, s[8:11], 0 offen offset:128 nt
buffer_load_dwordx4 v[52:55], v148, s[8:11], 0 offen offset:1664 nt
buffer_load_dwordx4 v[60:63], v148, s[8:11], 0 offen offset:3200 nt
buffer_load_dwordx4 v[68:71], v149, s[8:11], 0 offen offset:896 nt
buffer_load_dwordx4 v[76:79], v245, s[8:11], 0 offen offset:128 nt
buffer_load_dwordx4 v[80:83], v244, s[8:11], 0 offen offset:896 nt
s_waitcnt lgkmcnt(0)
s_barrier
s_setprio 0
buffer_load_dwordx4 v[84:87], v148, s[8:11], 0 offen offset:256 nt
buffer_load_dwordx4 v[92:95], v148, s[8:11], 0 offen offset:1792 nt
s_waitcnt vmcnt(6)
v_lshlrev_b32 v124, 16, v44
v_and_b32 v125, s30, v44
v_lshlrev_b32 v126, 16, v45
v_and_b32 v127, s30, v45
v_lshlrev_b32 v128, 16, v46
v_and_b32 v129, s30, v46
v_lshlrev_b32 v130, 16, v47
v_and_b32 v131, s30, v47
v_lshlrev_b32 v132, 16, v52
v_and_b32 v133, s30, v52
v_lshlrev_b32 v134, 16, v53
v_and_b32 v135, s30, v53
v_lshlrev_b32 v136, 16, v54
v_and_b32 v137, s30, v54
v_lshlrev_b32 v138, 16, v55
v_and_b32 v139, s30, v55
v_sub_f32 v233, v124, v132
v_sub_f32 v234, v125, v133
v_cvt_pk_bf16_f32 v140, v233, v234
v_sub_f32 v233, v126, v134
v_sub_f32 v234, v127, v135
v_cvt_pk_bf16_f32 v141, v233, v234
v_sub_f32 v233, v128, v136
v_sub_f32 v234, v129, v137
v_cvt_pk_bf16_f32 v142, v233, v234
v_sub_f32 v233, v130, v138
v_sub_f32 v234, v131, v139
v_cvt_pk_bf16_f32 v143, v233, v234
ds_write_b128 v152, v[140:143] offset:16256
buffer_load_dwordx4 v[100:103], v148, s[8:11], 0 offen offset:3328 nt
buffer_load_dwordx4 v[108:111], v149, s[8:11], 0 offen offset:1024 nt
s_waitcnt vmcnt(7)
v_lshlrev_b32 v124, 16, v60
v_and_b32 v125, s30, v60
v_lshlrev_b32 v126, 16, v61
v_and_b32 v127, s30, v61
v_lshlrev_b32 v128, 16, v62
v_and_b32 v129, s30, v62
v_lshlrev_b32 v130, 16, v63
v_and_b32 v131, s30, v63
v_sub_f32 v233, v132, v124
v_sub_f32 v234, v133, v125
v_cvt_pk_bf16_f32 v144, v233, v234
v_sub_f32 v233, v134, v126
v_sub_f32 v234, v135, v127
v_cvt_pk_bf16_f32 v145, v233, v234
v_sub_f32 v233, v136, v128
v_sub_f32 v234, v137, v129
v_cvt_pk_bf16_f32 v146, v233, v234
v_sub_f32 v233, v138, v130
v_sub_f32 v234, v139, v131
v_cvt_pk_bf16_f32 v147, v233, v234
ds_write_b128 v153, v[144:147] offset:16256
buffer_load_dwordx4 v[116:119], v245, s[8:11], 0 offen offset:256 nt
s_waitcnt vmcnt(7)
v_lshlrev_b32 v132, 16, v68
v_and_b32 v133, s30, v68
v_lshlrev_b32 v134, 16, v69
v_and_b32 v135, s30, v69
v_lshlrev_b32 v136, 16, v70
v_and_b32 v137, s30, v70
v_lshlrev_b32 v138, 16, v71
v_and_b32 v139, s30, v71
v_sub_f32 v233, v124, v132
v_sub_f32 v234, v125, v133
v_cvt_pk_bf16_f32 v140, v233, v234
v_sub_f32 v233, v126, v134
v_sub_f32 v234, v127, v135
v_cvt_pk_bf16_f32 v141, v233, v234
v_sub_f32 v233, v128, v136
v_sub_f32 v234, v129, v137
v_cvt_pk_bf16_f32 v142, v233, v234
v_sub_f32 v233, v130, v138
v_sub_f32 v234, v131, v139
v_cvt_pk_bf16_f32 v143, v233, v234
ds_write_b128 v154, v[140:143] offset:16256
buffer_load_dwordx4 v[120:123], v244, s[8:11], 0 offen offset:1024 nt
s_waitcnt vmcnt(6)
v_lshlrev_b32 v124, 16, v76
v_and_b32 v125, s30, v76
v_lshlrev_b32 v126, 16, v77
v_and_b32 v127, s30, v77
v_lshlrev_b32 v128, 16, v78
v_and_b32 v129, s30, v78
v_lshlrev_b32 v130, 16, v79
v_and_b32 v131, s30, v79
v_lshlrev_b32 v132, 16, v80
v_and_b32 v133, s30, v80
v_lshlrev_b32 v134, 16, v81
v_and_b32 v135, s30, v81
v_lshlrev_b32 v136, 16, v82
v_and_b32 v137, s30, v82
v_lshlrev_b32 v138, 16, v83
v_and_b32 v139, s30, v83
v_sub_f32 v233, v124, v132
v_sub_f32 v234, v125, v133
v_cvt_pk_bf16_f32 v144, v233, v234
v_sub_f32 v233, v126, v134
v_sub_f32 v234, v127, v135
v_cvt_pk_bf16_f32 v145, v233, v234
v_sub_f32 v233, v128, v136
v_sub_f32 v234, v129, v137
v_cvt_pk_bf16_f32 v146, v233, v234
v_sub_f32 v233, v130, v138
v_sub_f32 v234, v131, v139
v_cvt_pk_bf16_f32 v147, v233, v234
ds_write_b128 v247, v[144:147] offset:16256
s_waitcnt lgkmcnt(0)
s_barrier
buffer_load_dwordx4 v[8:11], v148, s[8:11], 0 offen offset:768 nt
buffer_load_dwordx4 v[16:19], v148, s[8:11], 0 offen offset:2304 nt
buffer_load_dwordx4 v[24:27], v149, s[8:11], 0 offen offset:0 nt
buffer_load_dwordx4 v[184:187], v244, s[8:11], 0 offen offset:0 nt
s_waitcnt vmcnt(8)
v_lshlrev_b32 v124, 16, v84
v_and_b32 v125, s30, v84
v_lshlrev_b32 v126, 16, v85
v_and_b32 v127, s30, v85
v_lshlrev_b32 v128, 16, v86
v_and_b32 v129, s30, v86
v_lshlrev_b32 v130, 16, v87
v_and_b32 v131, s30, v87
v_lshlrev_b32 v132, 16, v92
v_and_b32 v133, s30, v92
v_lshlrev_b32 v134, 16, v93
v_and_b32 v135, s30, v93
v_lshlrev_b32 v136, 16, v94
v_and_b32 v137, s30, v94
v_lshlrev_b32 v138, 16, v95
v_and_b32 v139, s30, v95
v_sub_f32 v233, v124, v132
v_sub_f32 v234, v125, v133
v_cvt_pk_bf16_f32 v140, v233, v234
v_sub_f32 v233, v126, v134
v_sub_f32 v234, v127, v135
v_cvt_pk_bf16_f32 v141, v233, v234
v_sub_f32 v233, v128, v136
v_sub_f32 v234, v129, v137
v_cvt_pk_bf16_f32 v142, v233, v234
v_sub_f32 v233, v130, v138
v_sub_f32 v234, v131, v139
v_cvt_pk_bf16_f32 v143, v233, v234
ds_write_b128 v152, v[140:143] offset:32512
s_waitcnt vmcnt(7)
v_lshlrev_b32 v124, 16, v100
v_and_b32 v125, s30, v100
v_lshlrev_b32 v126, 16, v101
v_and_b32 v127, s30, v101
v_lshlrev_b32 v128, 16, v102
v_and_b32 v129, s30, v102
v_lshlrev_b32 v130, 16, v103
v_and_b32 v131, s30, v103
v_sub_f32 v233, v132, v124
v_sub_f32 v234, v133, v125
v_cvt_pk_bf16_f32 v144, v233, v234
v_sub_f32 v233, v134, v126
v_sub_f32 v234, v135, v127
v_cvt_pk_bf16_f32 v145, v233, v234
v_sub_f32 v233, v136, v128
v_sub_f32 v234, v137, v129
v_cvt_pk_bf16_f32 v146, v233, v234
v_sub_f32 v233, v138, v130
v_sub_f32 v234, v139, v131
v_cvt_pk_bf16_f32 v147, v233, v234
ds_write_b128 v153, v[144:147] offset:32512
s_waitcnt vmcnt(6)
v_lshlrev_b32 v132, 16, v108
v_and_b32 v133, s30, v108
v_lshlrev_b32 v134, 16, v109
v_and_b32 v135, s30, v109
v_lshlrev_b32 v136, 16, v110
v_and_b32 v137, s30, v110
v_lshlrev_b32 v138, 16, v111
v_and_b32 v139, s30, v111
v_sub_f32 v233, v124, v132
v_sub_f32 v234, v125, v133
v_cvt_pk_bf16_f32 v140, v233, v234
v_sub_f32 v233, v126, v134
v_sub_f32 v234, v127, v135
v_cvt_pk_bf16_f32 v141, v233, v234
v_sub_f32 v233, v128, v136
v_sub_f32 v234, v129, v137
v_cvt_pk_bf16_f32 v142, v233, v234
v_sub_f32 v233, v130, v138
v_sub_f32 v234, v131, v139
v_cvt_pk_bf16_f32 v143, v233, v234
ds_write_b128 v154, v[140:143] offset:32512
s_waitcnt vmcnt(4)
v_lshlrev_b32 v124, 16, v116
v_and_b32 v125, s30, v116
v_lshlrev_b32 v126, 16, v117
v_and_b32 v127, s30, v117
v_lshlrev_b32 v128, 16, v118
v_and_b32 v129, s30, v118
v_lshlrev_b32 v130, 16, v119
v_and_b32 v131, s30, v119
v_lshlrev_b32 v132, 16, v120
v_and_b32 v133, s30, v120
v_lshlrev_b32 v134, 16, v121
v_and_b32 v135, s30, v121
v_lshlrev_b32 v136, 16, v122
v_and_b32 v137, s30, v122
v_lshlrev_b32 v138, 16, v123
v_and_b32 v139, s30, v123
v_sub_f32 v233, v124, v132
v_sub_f32 v234, v125, v133
v_cvt_pk_bf16_f32 v144, v233, v234
v_sub_f32 v233, v126, v134
v_sub_f32 v234, v127, v135
v_cvt_pk_bf16_f32 v145, v233, v234
v_sub_f32 v233, v128, v136
v_sub_f32 v234, v129, v137
v_cvt_pk_bf16_f32 v146, v233, v234
v_sub_f32 v233, v130, v138
v_sub_f32 v234, v131, v139
v_cvt_pk_bf16_f32 v147, v233, v234
ds_write_b128 v247, v[144:147] offset:32512
s_waitcnt lgkmcnt(0)
s_barrier
buffer_load_dwordx4 v[48:51], v148, s[8:11], 0 offen offset:896 nt
buffer_load_dwordx4 v[56:59], v148, s[8:11], 0 offen offset:2432 nt
buffer_load_dwordx4 v[64:67], v149, s[8:11], 0 offen offset:128 nt
buffer_load_dwordx4 v[192:195], v244, s[8:11], 0 offen offset:128 nt
s_waitcnt vmcnt(7)
v_lshlrev_b32 v124, 16, v8
v_and_b32 v125, s30, v8
v_lshlrev_b32 v126, 16, v9
v_and_b32 v127, s30, v9
v_lshlrev_b32 v128, 16, v10
v_and_b32 v129, s30, v10
v_lshlrev_b32 v130, 16, v11
v_and_b32 v131, s30, v11
v_lshlrev_b32 v132, 16, v12
v_and_b32 v133, s30, v12
v_lshlrev_b32 v134, 16, v13
v_and_b32 v135, s30, v13
v_lshlrev_b32 v136, 16, v14
v_and_b32 v137, s30, v14
v_lshlrev_b32 v138, 16, v15
v_and_b32 v139, s30, v15
v_add_f32 v233, v124, v132
v_add_f32 v234, v125, v133
v_cvt_pk_bf16_f32 v140, v233, v234
v_add_f32 v233, v126, v134
v_add_f32 v234, v127, v135
v_cvt_pk_bf16_f32 v141, v233, v234
v_add_f32 v233, v128, v136
v_add_f32 v234, v129, v137
v_cvt_pk_bf16_f32 v142, v233, v234
v_add_f32 v233, v130, v138
v_add_f32 v234, v131, v139
v_cvt_pk_bf16_f32 v143, v233, v234
ds_write_b128 v156, v[140:143] offset:0
s_waitcnt vmcnt(6)
v_lshlrev_b32 v124, 16, v16
v_and_b32 v125, s30, v16
v_lshlrev_b32 v126, 16, v17
v_and_b32 v127, s30, v17
v_lshlrev_b32 v128, 16, v18
v_and_b32 v129, s30, v18
v_lshlrev_b32 v130, 16, v19
v_and_b32 v131, s30, v19
v_lshlrev_b32 v132, 16, v20
v_and_b32 v133, s30, v20
v_lshlrev_b32 v134, 16, v21
v_and_b32 v135, s30, v21
v_lshlrev_b32 v136, 16, v22
v_and_b32 v137, s30, v22
v_lshlrev_b32 v138, 16, v23
v_and_b32 v139, s30, v23
v_add_f32 v233, v124, v132
v_add_f32 v234, v125, v133
v_cvt_pk_bf16_f32 v144, v233, v234
v_add_f32 v233, v126, v134
v_add_f32 v234, v127, v135
v_cvt_pk_bf16_f32 v145, v233, v234
v_add_f32 v233, v128, v136
v_add_f32 v234, v129, v137
v_cvt_pk_bf16_f32 v146, v233, v234
v_add_f32 v233, v130, v138
v_add_f32 v234, v131, v139
v_cvt_pk_bf16_f32 v147, v233, v234
ds_write_b128 v157, v[144:147] offset:0
s_cmp_eq_u32 s31, 3
s_cbranch_scc0 L_nopoll
v_lshlrev_b32 v249, 6, v0
s_mov_b64 exec, 15
s_mov_b32 s84, 0x40000
L_poll:
buffer_load_dword v250, v249, s[76:79], 0 offen sc1
s_waitcnt vmcnt(0)
v_cmp_gt_u32 vcc, 54, v250
s_sub_u32 s84, s84, 1
s_cbranch_scc1 L_polldone
s_cbranch_vccz L_polldone
s_branch L_poll
L_polldone:
s_mov_b64 exec, -1
L_nopoll:
s_waitcnt lgkmcnt(0)
s_barrier
buffer_load_dwordx4 v[88:91], v148, s[8:11], 0 offen offset:1024 nt
buffer_load_dwordx4 v[96:99], v148, s[8:11], 0 offen offset:2560 nt
s_waitcnt vmcnt(7)
v_lshlrev_b32 v124, 16, v24
v_and_b32 v125, s30, v24
v_lshlrev_b32 v126, 16, v25
v_and_b32 v127, s30, v25
v_lshlrev_b32 v128, 16, v26
v_and_b32 v129, s30, v26
v_lshlrev_b32 v130, 16, v27
v_and_b32 v131, s30, v27
v_lshlrev_b32 v132, 16, v28
v_and_b32 v133, s30, v28
v_lshlrev_b32 v134, 16, v29
v_and_b32 v135, s30, v29
v_lshlrev_b32 v136, 16, v30
v_and_b32 v137, s30, v30
v_lshlrev_b32 v138, 16, v31
v_and_b32 v139, s30, v31
v_add_f32 v233, v124, v132
v_add_f32 v234, v125, v133
v_cvt_pk_bf16_f32 v140, v233, v234
v_add_f32 v233, v126, v134
v_add_f32 v234, v127, v135
v_cvt_pk_bf16_f32 v141, v233, v234
v_add_f32 v233, v128, v136
v_add_f32 v234, v129, v137
v_cvt_pk_bf16_f32 v142, v233, v234
v_add_f32 v233, v130, v138
v_add_f32 v234, v131, v139
v_cvt_pk_bf16_f32 v143, v233, v234
ds_write_b128 v158, v[140:143] offset:0
s_waitcnt vmcnt(6)
v_lshlrev_b32 v124, 16, v184
v_and_b32 v125, s30, v184
v_lshlrev_b32 v126, 16, v185
v_and_b32 v127, s30, v185
v_lshlrev_b32 v128, 16, v186
v_and_b32 v129, s30, v186
v_lshlrev_b32 v130, 16, v187
v_and_b32 v131, s30, v187
v_lshlrev_b32 v132, 16, v40
v_and_b32 v133, s30, v40
v_lshlrev_b32 v134, 16, v41
v_and_b32 v135, s30, v41
v_lshlrev_b32 v136, 16, v42
v_and_b32 v137, s30, v42
v_lshlrev_b32 v138, 16, v43
v_and_b32 v139, s30, v43
v_add_f32 v233, v124, v132
v_add_f32 v234, v125, v133
v_cvt_pk_bf16_f32 v144, v233, v234
v_add_f32 v233, v126, v134
v_add_f32 v234, v127, v135
v_cvt_pk_bf16_f32 v145, v233, v234
v_add_f32 v233, v128, v136
v_add_f32 v234, v129, v137
v_cvt_pk_bf16_f32 v146, v233, v234
v_add_f32 v233, v130, v138
v_add_f32 v234, v131, v139
v_cvt_pk_bf16_f32 v147, v233, v234
ds_write_b128 v248, v[144:147] offset:0
s_waitcnt lgkmcnt(0)
s_barrier
buffer_load_dwordx4 v[104:107], v149, s[8:11], 0 offen offset:256 nt
buffer_load_dwordx4 v[200:203], v244, s[8:11], 0 offen offset:256 nt
buffer_load_dwordx4 v[32:35], v150, s[8:11], 0 offen offset:0 nt
buffer_load_dwordx4 v[188:191], v246, s[8:11], 0 offen offset:0 nt
buffer_load_dwordx4 v[72:75], v150, s[8:11], 0 offen offset:128 nt
buffer_load_dwordx4 v[196:199], v246, s[8:11], 0 offen offset:128 nt
buffer_load_dwordx4 v[112:115], v150, s[8:11], 0 offen offset:256 nt
buffer_load_dwordx4 v[204:207], v246, s[8:11], 0 offen offset:256 nt
s_waitcnt vmcnt(13)
v_lshlrev_b32 v124, 16, v48
v_and_b32 v125, s30, v48
v_lshlrev_b32 v126, 16, v49
v_and_b32 v127, s30, v49
v_lshlrev_b32 v128, 16, v50
v_and_b32 v129, s30, v50
v_lshlrev_b32 v130, 16, v51
v_and_b32 v131, s30, v51
v_lshlrev_b32 v132, 16, v52
v_and_b32 v133, s30, v52
v_lshlrev_b32 v134, 16, v53
v_and_b32 v135, s30, v53
v_lshlrev_b32 v136, 16, v54
v_and_b32 v137, s30, v54
v_lshlrev_b32 v138, 16, v55
v_and_b32 v139, s30, v55
v_add_f32 v233, v124, v132
v_add_f32 v234, v125, v133
v_cvt_pk_bf16_f32 v140, v233, v234
v_add_f32 v233, v126, v134
v_add_f32 v234, v127, v135
v_cvt_pk_bf16_f32 v141, v233, v234
v_add_f32 v233, v128, v136
v_add_f32 v234, v129, v137
v_cvt_pk_bf16_f32 v142, v233, v234
v_add_f32 v233, v130, v138
v_add_f32 v234, v131, v139
v_cvt_pk_bf16_f32 v143, v233, v234
ds_write_b128 v156, v[140:143] offset:16256
s_waitcnt vmcnt(12)
v_lshlrev_b32 v124, 16, v56
v_and_b32 v125, s30, v56
v_lshlrev_b32 v126, 16, v57
v_and_b32 v127, s30, v57
v_lshlrev_b32 v128, 16, v58
v_and_b32 v129, s30, v58
v_lshlrev_b32 v130, 16, v59
v_and_b32 v131, s30, v59
v_lshlrev_b32 v132, 16, v60
v_and_b32 v133, s30, v60
v_lshlrev_b32 v134, 16, v61
v_and_b32 v135, s30, v61
v_lshlrev_b32 v136, 16, v62
v_and_b32 v137, s30, v62
v_lshlrev_b32 v138, 16, v63
v_and_b32 v139, s30, v63
v_add_f32 v233, v124, v132
v_add_f32 v234, v125, v133
v_cvt_pk_bf16_f32 v144, v233, v234
v_add_f32 v233, v126, v134
v_add_f32 v234, v127, v135
v_cvt_pk_bf16_f32 v145, v233, v234
v_add_f32 v233, v128, v136
v_add_f32 v234, v129, v137
v_cvt_pk_bf16_f32 v146, v233, v234
v_add_f32 v233, v130, v138
v_add_f32 v234, v131, v139
v_cvt_pk_bf16_f32 v147, v233, v234
ds_write_b128 v157, v[144:147] offset:16256
s_waitcnt vmcnt(11)
v_lshlrev_b32 v124, 16, v64
v_and_b32 v125, s30, v64
v_lshlrev_b32 v126, 16, v65
v_and_b32 v127, s30, v65
v_lshlrev_b32 v128, 16, v66
v_and_b32 v129, s30, v66
v_lshlrev_b32 v130, 16, v67
v_and_b32 v131, s30, v67
v_lshlrev_b32 v132, 16, v68
v_and_b32 v133, s30, v68
v_lshlrev_b32 v134, 16, v69
v_and_b32 v135, s30, v69
v_lshlrev_b32 v136, 16, v70
v_and_b32 v137, s30, v70
v_lshlrev_b32 v138, 16, v71
v_and_b32 v139, s30, v71
v_add_f32 v233, v124, v132
v_add_f32 v234, v125, v133
v_cvt_pk_bf16_f32 v140, v233, v234
v_add_f32 v233, v126, v134
v_add_f32 v234, v127, v135
v_cvt_pk_bf16_f32 v141, v233, v234
v_add_f32 v233, v128, v136
v_add_f32 v234, v129, v137
v_cvt_pk_bf16_f32 v142, v233, v234
v_add_f32 v233, v130, v138
v_add_f32 v234, v131, v139
v_cvt_pk_bf16_f32 v143, v233, v234
ds_write_b128 v158, v[140:143] offset:16256
s_waitcnt vmcnt(10)
v_lshlrev_b32 v124, 16, v192
v_and_b32 v125, s30, v192
v_lshlrev_b32 v126, 16, v193
v_and_b32 v127, s30, v193
v_lshlrev_b32 v128, 16, v194
v_and_b32 v129, s30, v194
v_lshlrev_b32 v130, 16, v195
v_and_b32 v131, s30, v195
v_lshlrev_b32 v132, 16, v80
v_and_b32 v133, s30, v80
v_lshlrev_b32 v134, 16, v81
v_and_b32 v135, s30, v81
v_lshlrev_b32 v136, 16, v82
v_and_b32 v137, s30, v82
v_lshlrev_b32 v138, 16, v83
v_and_b32 v139, s30, v83
v_add_f32 v233, v124, v132
v_add_f32 v234, v125, v133
v_cvt_pk_bf16_f32 v144, v233, v234
v_add_f32 v233, v126, v134
v_add_f32 v234, v127, v135
v_cvt_pk_bf16_f32 v145, v233, v234
v_add_f32 v233, v128, v136
v_add_f32 v234, v129, v137
v_cvt_pk_bf16_f32 v146, v233, v234
v_add_f32 v233, v130, v138
v_add_f32 v234, v131, v139
v_cvt_pk_bf16_f32 v147, v233, v234
ds_write_b128 v248, v[144:147] offset:16256
s_waitcnt lgkmcnt(0)
s_barrier
s_waitcnt vmcnt(9)
v_lshlrev_b32 v124, 16, v88
v_and_b32 v125, s30, v88
v_lshlrev_b32 v126, 16, v89
v_and_b32 v127, s30, v89
v_lshlrev_b32 v128, 16, v90
v_and_b32 v129, s30, v90
v_lshlrev_b32 v130, 16, v91
v_and_b32 v131, s30, v91
v_lshlrev_b32 v132, 16, v92
v_and_b32 v133, s30, v92
v_lshlrev_b32 v134, 16, v93
v_and_b32 v135, s30, v93
v_lshlrev_b32 v136, 16, v94
v_and_b32 v137, s30, v94
v_lshlrev_b32 v138, 16, v95
v_and_b32 v139, s30, v95
v_add_f32 v233, v124, v132
v_add_f32 v234, v125, v133
v_cvt_pk_bf16_f32 v140, v233, v234
v_add_f32 v233, v126, v134
v_add_f32 v234, v127, v135
v_cvt_pk_bf16_f32 v141, v233, v234
v_add_f32 v233, v128, v136
v_add_f32 v234, v129, v137
v_cvt_pk_bf16_f32 v142, v233, v234
v_add_f32 v233, v130, v138
v_add_f32 v234, v131, v139
v_cvt_pk_bf16_f32 v143, v233, v234
ds_write_b128 v156, v[140:143] offset:32512
s_waitcnt vmcnt(8)
v_lshlrev_b32 v124, 16, v96
v_and_b32 v125, s30, v96
v_lshlrev_b32 v126, 16, v97
v_and_b32 v127, s30, v97
v_lshlrev_b32 v128, 16, v98
v_and_b32 v129, s30, v98
v_lshlrev_b32 v130, 16, v99
v_and_b32 v131, s30, v99
v_lshlrev_b32 v132, 16, v100
v_and_b32 v133, s30, v100
v_lshlrev_b32 v134, 16, v101
v_and_b32 v135, s30, v101
v_lshlrev_b32 v136, 16, v102
v_and_b32 v137, s30, v102
v_lshlrev_b32 v138, 16, v103
v_and_b32 v139, s30, v103
v_add_f32 v233, v124, v132
v_add_f32 v234, v125, v133
v_cvt_pk_bf16_f32 v144, v233, v234
v_add_f32 v233, v126, v134
v_add_f32 v234, v127, v135
v_cvt_pk_bf16_f32 v145, v233, v234
v_add_f32 v233, v128, v136
v_add_f32 v234, v129, v137
v_cvt_pk_bf16_f32 v146, v233, v234
v_add_f32 v233, v130, v138
v_add_f32 v234, v131, v139
v_cvt_pk_bf16_f32 v147, v233, v234
ds_write_b128 v157, v[144:147] offset:32512
s_waitcnt vmcnt(7)
v_lshlrev_b32 v124, 16, v104
v_and_b32 v125, s30, v104
v_lshlrev_b32 v126, 16, v105
v_and_b32 v127, s30, v105
v_lshlrev_b32 v128, 16, v106
v_and_b32 v129, s30, v106
v_lshlrev_b32 v130, 16, v107
v_and_b32 v131, s30, v107
v_lshlrev_b32 v132, 16, v108
v_and_b32 v133, s30, v108
v_lshlrev_b32 v134, 16, v109
v_and_b32 v135, s30, v109
v_lshlrev_b32 v136, 16, v110
v_and_b32 v137, s30, v110
v_lshlrev_b32 v138, 16, v111
v_and_b32 v139, s30, v111
v_add_f32 v233, v124, v132
v_add_f32 v234, v125, v133
v_cvt_pk_bf16_f32 v140, v233, v234
v_add_f32 v233, v126, v134
v_add_f32 v234, v127, v135
v_cvt_pk_bf16_f32 v141, v233, v234
v_add_f32 v233, v128, v136
v_add_f32 v234, v129, v137
v_cvt_pk_bf16_f32 v142, v233, v234
v_add_f32 v233, v130, v138
v_add_f32 v234, v131, v139
v_cvt_pk_bf16_f32 v143, v233, v234
ds_write_b128 v158, v[140:143] offset:32512
s_waitcnt vmcnt(6)
v_lshlrev_b32 v124, 16, v200
v_and_b32 v125, s30, v200
v_lshlrev_b32 v126, 16, v201
v_and_b32 v127, s30, v201
v_lshlrev_b32 v128, 16, v202
v_and_b32 v129, s30, v202
v_lshlrev_b32 v130, 16, v203
v_and_b32 v131, s30, v203
v_lshlrev_b32 v132, 16, v120
v_and_b32 v133, s30, v120
v_lshlrev_b32 v134, 16, v121
v_and_b32 v135, s30, v121
v_lshlrev_b32 v136, 16, v122
v_and_b32 v137, s30, v122
v_lshlrev_b32 v138, 16, v123
v_and_b32 v139, s30, v123
v_add_f32 v233, v124, v132
v_add_f32 v234, v125, v133
v_cvt_pk_bf16_f32 v144, v233, v234
v_add_f32 v233, v126, v134
v_add_f32 v234, v127, v135
v_cvt_pk_bf16_f32 v145, v233, v234
v_add_f32 v233, v128, v136
v_add_f32 v234, v129, v137
v_cvt_pk_bf16_f32 v146, v233, v234
v_add_f32 v233, v130, v138
v_add_f32 v234, v131, v139
v_cvt_pk_bf16_f32 v147, v233, v234
ds_write_b128 v248, v[144:147] offset:32512
v_lshlrev_b32 v124, 16, v8
v_and_b32 v125, s30, v8
v_lshlrev_b32 v126, 16, v9
v_and_b32 v127, s30, v9
v_lshlrev_b32 v128, 16, v10
v_and_b32 v129, s30, v10
v_lshlrev_b32 v130, 16, v11
v_and_b32 v131, s30, v11
v_lshlrev_b32 v132, 16, v12
v_and_b32 v133, s30, v12
v_lshlrev_b32 v134, 16, v13
v_and_b32 v135, s30, v13
v_lshlrev_b32 v136, 16, v14
v_and_b32 v137, s30, v14
v_lshlrev_b32 v138, 16, v15
v_and_b32 v139, s30, v15
v_sub_f32 v233, v132, v124
v_sub_f32 v234, v133, v125
v_cvt_pk_bf16_f32 v140, v233, v234
v_sub_f32 v233, v134, v126
v_sub_f32 v234, v135, v127
v_cvt_pk_bf16_f32 v141, v233, v234
v_sub_f32 v233, v136, v128
v_sub_f32 v234, v137, v129
v_cvt_pk_bf16_f32 v142, v233, v234
v_sub_f32 v233, v138, v130
v_sub_f32 v234, v139, v131
v_cvt_pk_bf16_f32 v143, v233, v234
ds_write_b128 v152, v[140:143] offset:0
v_lshlrev_b32 v124, 16, v16
v_and_b32 v125, s30, v16
v_lshlrev_b32 v126, 16, v17
v_and_b32 v127, s30, v17
v_lshlrev_b32 v128, 16, v18
v_and_b32 v129, s30, v18
v_lshlrev_b32 v130, 16, v19
v_and_b32 v131, s30, v19
v_lshlrev_b32 v132, 16, v20
v_and_b32 v133, s30, v20
v_lshlrev_b32 v134, 16, v21
v_and_b32 v135, s30, v21
v_lshlrev_b32 v136, 16, v22
v_and_b32 v137, s30, v22
v_lshlrev_b32 v138, 16, v23
v_and_b32 v139, s30, v23
v_sub_f32 v233, v132, v124
v_sub_f32 v234, v133, v125
v_cvt_pk_bf16_f32 v144, v233, v234
v_sub_f32 v233, v134, v126
v_sub_f32 v234, v135, v127
v_cvt_pk_bf16_f32 v145, v233, v234
v_sub_f32 v233, v136, v128
v_sub_f32 v234, v137, v129
v_cvt_pk_bf16_f32 v146, v233, v234
v_sub_f32 v233, v138, v130
v_sub_f32 v234, v139, v131
v_cvt_pk_bf16_f32 v147, v233, v234
ds_write_b128 v153, v[144:147] offset:0
v_lshlrev_b32 v124, 16, v24
v_and_b32 v125, s30, v24
v_lshlrev_b32 v126, 16, v25
v_and_b32 v127, s30, v25
v_lshlrev_b32 v128, 16, v26
v_and_b32 v129, s30, v26
v_lshlrev_b32 v130, 16, v27
v_and_b32 v131, s30, v27
v_lshlrev_b32 v132, 16, v28
v_and_b32 v133, s30, v28
v_lshlrev_b32 v134, 16, v29
v_and_b32 v135, s30, v29
v_lshlrev_b32 v136, 16, v30
v_and_b32 v137, s30, v30
v_lshlrev_b32 v138, 16, v31
v_and_b32 v139, s30, v31
v_sub_f32 v233, v132, v124
v_sub_f32 v234, v133, v125
v_cvt_pk_bf16_f32 v140, v233, v234
v_sub_f32 v233, v134, v126
v_sub_f32 v234, v135, v127
v_cvt_pk_bf16_f32 v141, v233, v234
v_sub_f32 v233, v136, v128
v_sub_f32 v234, v137, v129
v_cvt_pk_bf16_f32 v142, v233, v234
v_sub_f32 v233, v138, v130
v_sub_f32 v234, v139, v131
v_cvt_pk_bf16_f32 v143, v233, v234
ds_write_b128 v154, v[140:143] offset:0
v_lshlrev_b32 v124, 16, v40
v_and_b32 v125, s30, v40
v_lshlrev_b32 v126, 16, v41
v_and_b32 v127, s30, v41
v_lshlrev_b32 v128, 16, v42
v_and_b32 v129, s30, v42
v_lshlrev_b32 v130, 16, v43
v_and_b32 v131, s30, v43
v_lshlrev_b32 v132, 16, v184
v_and_b32 v133, s30, v184
v_lshlrev_b32 v134, 16, v185
v_and_b32 v135, s30, v185
v_lshlrev_b32 v136, 16, v186
v_and_b32 v137, s30, v186
v_lshlrev_b32 v138, 16, v187
v_and_b32 v139, s30, v187
v_sub_f32 v233, v124, v132
v_sub_f32 v234, v125, v133
v_cvt_pk_bf16_f32 v144, v233, v234
v_sub_f32 v233, v126, v134
v_sub_f32 v234, v127, v135
v_cvt_pk_bf16_f32 v145, v233, v234
v_sub_f32 v233, v128, v136
v_sub_f32 v234, v129, v137
v_cvt_pk_bf16_f32 v146, v233, v234
v_sub_f32 v233, v130, v138
v_sub_f32 v234, v131, v139
v_cvt_pk_bf16_f32 v147, v233, v234
ds_write_b128 v247, v[144:147] offset:0
s_waitcnt lgkmcnt(0)
s_barrier
v_lshlrev_b32 v124, 16, v48
v_and_b32 v125, s30, v48
v_lshlrev_b32 v126, 16, v49
v_and_b32 v127, s30, v49
v_lshlrev_b32 v128, 16, v50
v_and_b32 v129, s30, v50
v_lshlrev_b32 v130, 16, v51
v_and_b32 v131, s30, v51
v_lshlrev_b32 v132, 16, v52
v_and_b32 v133, s30, v52
v_lshlrev_b32 v134, 16, v53
v_and_b32 v135, s30, v53
v_lshlrev_b32 v136, 16, v54
v_and_b32 v137, s30, v54
v_lshlrev_b32 v138, 16, v55
v_and_b32 v139, s30, v55
v_sub_f32 v233, v132, v124
v_sub_f32 v234, v133, v125
v_cvt_pk_bf16_f32 v140, v233, v234
v_sub_f32 v233, v134, v126
v_sub_f32 v234, v135, v127
v_cvt_pk_bf16_f32 v141, v233, v234
v_sub_f32 v233, v136, v128
v_sub_f32 v234, v137, v129
v_cvt_pk_bf16_f32 v142, v233, v234
v_sub_f32 v233, v138, v130
v_sub_f32 v234, v139, v131
v_cvt_pk_bf16_f32 v143, v233, v234
ds_write_b128 v152, v[140:143] offset:16256
v_lshlrev_b32 v124, 16, v56
v_and_b32 v125, s30, v56
v_lshlrev_b32 v126, 16, v57
v_and_b32 v127, s30, v57
v_lshlrev_b32 v128, 16, v58
v_and_b32 v129, s30, v58
v_lshlrev_b32 v130, 16, v59
v_and_b32 v131, s30, v59
v_lshlrev_b32 v132, 16, v60
v_and_b32 v133, s30, v60
v_lshlrev_b32 v134, 16, v61
v_and_b32 v135, s30, v61
v_lshlrev_b32 v136, 16, v62
v_and_b32 v137, s30, v62
v_lshlrev_b32 v138, 16, v63
v_and_b32 v139, s30, v63
v_sub_f32 v233, v132, v124
v_sub_f32 v234, v133, v125
v_cvt_pk_bf16_f32 v144, v233, v234
v_sub_f32 v233, v134, v126
v_sub_f32 v234, v135, v127
v_cvt_pk_bf16_f32 v145, v233, v234
v_sub_f32 v233, v136, v128
v_sub_f32 v234, v137, v129
v_cvt_pk_bf16_f32 v146, v233, v234
v_sub_f32 v233, v138, v130
v_sub_f32 v234, v139, v131
v_cvt_pk_bf16_f32 v147, v233, v234
ds_write_b128 v153, v[144:147] offset:16256
v_lshlrev_b32 v124, 16, v64
v_and_b32 v125, s30, v64
v_lshlrev_b32 v126, 16, v65
v_and_b32 v127, s30, v65
v_lshlrev_b32 v128, 16, v66
v_and_b32 v129, s30, v66
v_lshlrev_b32 v130, 16, v67
v_and_b32 v131, s30, v67
v_lshlrev_b32 v132, 16, v68
v_and_b32 v133, s30, v68
v_lshlrev_b32 v134, 16, v69
v_and_b32 v135, s30, v69
v_lshlrev_b32 v136, 16, v70
v_and_b32 v137, s30, v70
v_lshlrev_b32 v138, 16, v71
v_and_b32 v139, s30, v71
v_sub_f32 v233, v132, v124
v_sub_f32 v234, v133, v125
v_cvt_pk_bf16_f32 v140, v233, v234
v_sub_f32 v233, v134, v126
v_sub_f32 v234, v135, v127
v_cvt_pk_bf16_f32 v141, v233, v234
v_sub_f32 v233, v136, v128
v_sub_f32 v234, v137, v129
v_cvt_pk_bf16_f32 v142, v233, v234
v_sub_f32 v233, v138, v130
v_sub_f32 v234, v139, v131
v_cvt_pk_bf16_f32 v143, v233, v234
ds_write_b128 v154, v[140:143] offset:16256
v_lshlrev_b32 v124, 16, v80
v_and_b32 v125, s30, v80
v_lshlrev_b32 v126, 16, v81
v_and_b32 v127, s30, v81
v_lshlrev_b32 v128, 16, v82
v_and_b32 v129, s30, v82
v_lshlrev_b32 v130, 16, v83
v_and_b32 v131, s30, v83
v_lshlrev_b32 v132, 16, v192
v_and_b32 v133, s30, v192
v_lshlrev_b32 v134, 16, v193
v_and_b32 v135, s30, v193
v_lshlrev_b32 v136, 16, v194
v_and_b32 v137, s30, v194
v_lshlrev_b32 v138, 16, v195
v_and_b32 v139, s30, v195
v_sub_f32 v233, v124, v132
v_sub_f32 v234, v125, v133
v_cvt_pk_bf16_f32 v144, v233, v234
v_sub_f32 v233, v126, v134
v_sub_f32 v234, v127, v135
v_cvt_pk_bf16_f32 v145, v233, v234
v_sub_f32 v233, v128, v136
v_sub_f32 v234, v129, v137
v_cvt_pk_bf16_f32 v146, v233, v234
v_sub_f32 v233, v130, v138
v_sub_f32 v234, v131, v139
v_cvt_pk_bf16_f32 v147, v233, v234
ds_write_b128 v247, v[144:147] offset:16256
v_lshlrev_b32 v124, 16, v88
v_and_b32 v125, s30, v88
v_lshlrev_b32 v126, 16, v89
v_and_b32 v127, s30, v89
v_lshlrev_b32 v128, 16, v90
v_and_b32 v129, s30, v90
v_lshlrev_b32 v130, 16, v91
v_and_b32 v131, s30, v91
v_lshlrev_b32 v132, 16, v92
v_and_b32 v133, s30, v92
v_lshlrev_b32 v134, 16, v93
v_and_b32 v135, s30, v93
v_lshlrev_b32 v136, 16, v94
v_and_b32 v137, s30, v94
v_lshlrev_b32 v138, 16, v95
v_and_b32 v139, s30, v95
v_sub_f32 v233, v132, v124
v_sub_f32 v234, v133, v125
v_cvt_pk_bf16_f32 v140, v233, v234
v_sub_f32 v233, v134, v126
v_sub_f32 v234, v135, v127
v_cvt_pk_bf16_f32 v141, v233, v234
v_sub_f32 v233, v136, v128
v_sub_f32 v234, v137, v129
v_cvt_pk_bf16_f32 v142, v233, v234
v_sub_f32 v233, v138, v130
v_sub_f32 v234, v139, v131
v_cvt_pk_bf16_f32 v143, v233, v234
ds_write_b128 v152, v[140:143] offset:32512
v_lshlrev_b32 v124, 16, v96
v_and_b32 v125, s30, v96
v_lshlrev_b32 v126, 16, v97
v_and_b32 v127, s30, v97
v_lshlrev_b32 v128, 16, v98
v_and_b32 v129, s30, v98
v_lshlrev_b32 v130, 16, v99
v_and_b32 v131, s30, v99
v_lshlrev_b32 v132, 16, v100
v_and_b32 v133, s30, v100
v_lshlrev_b32 v134, 16, v101
v_and_b32 v135, s30, v101
v_lshlrev_b32 v136, 16, v102
v_and_b32 v137, s30, v102
v_lshlrev_b32 v138, 16, v103
v_and_b32 v139, s30, v103
v_sub_f32 v233, v132, v124
v_sub_f32 v234, v133, v125
v_cvt_pk_bf16_f32 v144, v233, v234
v_sub_f32 v233, v134, v126
v_sub_f32 v234, v135, v127
v_cvt_pk_bf16_f32 v145, v233, v234
v_sub_f32 v233, v136, v128
v_sub_f32 v234, v137, v129
v_cvt_pk_bf16_f32 v146, v233, v234
v_sub_f32 v233, v138, v130
v_sub_f32 v234, v139, v131
v_cvt_pk_bf16_f32 v147, v233, v234
ds_write_b128 v153, v[144:147] offset:32512
v_lshlrev_b32 v124, 16, v104
v_and_b32 v125, s30, v104
v_lshlrev_b32 v126, 16, v105
v_and_b32 v127, s30, v105
v_lshlrev_b32 v128, 16, v106
v_and_b32 v129, s30, v106
v_lshlrev_b32 v130, 16, v107
v_and_b32 v131, s30, v107
v_lshlrev_b32 v132, 16, v108
v_and_b32 v133, s30, v108
v_lshlrev_b32 v134, 16, v109
v_and_b32 v135, s30, v109
v_lshlrev_b32 v136, 16, v110
v_and_b32 v137, s30, v110
v_lshlrev_b32 v138, 16, v111
v_and_b32 v139, s30, v111
v_sub_f32 v233, v132, v124
v_sub_f32 v234, v133, v125
v_cvt_pk_bf16_f32 v140, v233, v234
v_sub_f32 v233, v134, v126
v_sub_f32 v234, v135, v127
v_cvt_pk_bf16_f32 v141, v233, v234
v_sub_f32 v233, v136, v128
v_sub_f32 v234, v137, v129
v_cvt_pk_bf16_f32 v142, v233, v234
v_sub_f32 v233, v138, v130
v_sub_f32 v234, v139, v131
v_cvt_pk_bf16_f32 v143, v233, v234
ds_write_b128 v154, v[140:143] offset:32512
v_lshlrev_b32 v124, 16, v120
v_and_b32 v125, s30, v120
v_lshlrev_b32 v126, 16, v121
v_and_b32 v127, s30, v121
v_lshlrev_b32 v128, 16, v122
v_and_b32 v129, s30, v122
v_lshlrev_b32 v130, 16, v123
v_and_b32 v131, s30, v123
v_lshlrev_b32 v132, 16, v200
v_and_b32 v133, s30, v200
v_lshlrev_b32 v134, 16, v201
v_and_b32 v135, s30, v201
v_lshlrev_b32 v136, 16, v202
v_and_b32 v137, s30, v202
v_lshlrev_b32 v138, 16, v203
v_and_b32 v139, s30, v203
v_sub_f32 v233, v124, v132
v_sub_f32 v234, v125, v133
v_cvt_pk_bf16_f32 v144, v233, v234
v_sub_f32 v233, v126, v134
v_sub_f32 v234, v127, v135
v_cvt_pk_bf16_f32 v145, v233, v234
v_sub_f32 v233, v128, v136
v_sub_f32 v234, v129, v137
v_cvt_pk_bf16_f32 v146, v233, v234
v_sub_f32 v233, v130, v138
v_sub_f32 v234, v131, v139
v_cvt_pk_bf16_f32 v147, v233, v234
ds_write_b128 v247, v[144:147] offset:32512
s_waitcnt lgkmcnt(0)
s_barrier
v_lshlrev_b32 v124, 16, v8
v_and_b32 v125, s30, v8
v_lshlrev_b32 v126, 16, v9
v_and_b32 v127, s30, v9
v_lshlrev_b32 v128, 16, v10
v_and_b32 v129, s30, v10
v_lshlrev_b32 v130, 16, v11
v_and_b32 v131, s30, v11
v_lshlrev_b32 v132, 16, v16
v_and_b32 v133, s30, v16
v_lshlrev_b32 v134, 16, v17
v_and_b32 v135, s30, v17
v_lshlrev_b32 v136, 16, v18
v_and_b32 v137, s30, v18
v_lshlrev_b32 v138, 16, v19
v_and_b32 v139, s30, v19
v_sub_f32 v233, v124, v132
v_sub_f32 v234, v125, v133
v_cvt_pk_bf16_f32 v140, v233, v234
v_sub_f32 v233, v126, v134
v_sub_f32 v234, v127, v135
v_cvt_pk_bf16_f32 v141, v233, v234
v_sub_f32 v233, v128, v136
v_sub_f32 v234, v129, v137
v_cvt_pk_bf16_f32 v142, v233, v234
v_sub_f32 v233, v130, v138
v_sub_f32 v234, v131, v139
v_cvt_pk_bf16_f32 v143, v233, v234
ds_write_b128 v156, v[140:143] offset:0
v_lshlrev_b32 v124, 16, v24
v_and_b32 v125, s30, v24
v_lshlrev_b32 v126, 16, v25
v_and_b32 v127, s30, v25
v_lshlrev_b32 v128, 16, v26
v_and_b32 v129, s30, v26
v_lshlrev_b32 v130, 16, v27
v_and_b32 v131, s30, v27
v_sub_f32 v233, v132, v124
v_sub_f32 v234, v133, v125
v_cvt_pk_bf16_f32 v144, v233, v234
v_sub_f32 v233, v134, v126
v_sub_f32 v234, v135, v127
v_cvt_pk_bf16_f32 v145, v233, v234
v_sub_f32 v233, v136, v128
v_sub_f32 v234, v137, v129
v_cvt_pk_bf16_f32 v146, v233, v234
v_sub_f32 v233, v138, v130
v_sub_f32 v234, v139, v131
v_cvt_pk_bf16_f32 v147, v233, v234
ds_write_b128 v157, v[144:147] offset:0
s_waitcnt vmcnt(5)
v_lshlrev_b32 v132, 16, v32
v_and_b32 v133, s30, v32
v_lshlrev_b32 v134, 16, v33
v_and_b32 v135, s30, v33
v_lshlrev_b32 v136, 16, v34
v_and_b32 v137, s30, v34
v_lshlrev_b32 v138, 16, v35
v_and_b32 v139, s30, v35
v_sub_f32 v233, v124, v132
v_sub_f32 v234, v125, v133
v_cvt_pk_bf16_f32 v140, v233, v234
v_sub_f32 v233, v126, v134
v_sub_f32 v234, v127, v135
v_cvt_pk_bf16_f32 v141, v233, v234
v_sub_f32 v233, v128, v136
v_sub_f32 v234, v129, v137
v_cvt_pk_bf16_f32 v142, v233, v234
v_sub_f32 v233, v130, v138
v_sub_f32 v234, v131, v139
v_cvt_pk_bf16_f32 v143, v233, v234
ds_write_b128 v158, v[140:143] offset:0
s_waitcnt vmcnt(4)
v_lshlrev_b32 v124, 16, v184
v_and_b32 v125, s30, v184
v_lshlrev_b32 v126, 16, v185
v_and_b32 v127, s30, v185
v_lshlrev_b32 v128, 16, v186
v_and_b32 v129, s30, v186
v_lshlrev_b32 v130, 16, v187
v_and_b32 v131, s30, v187
v_lshlrev_b32 v132, 16, v188
v_and_b32 v133, s30, v188
v_lshlrev_b32 v134, 16, v189
v_and_b32 v135, s30, v189
v_lshlrev_b32 v136, 16, v190
v_and_b32 v137, s30, v190
v_lshlrev_b32 v138, 16, v191
v_and_b32 v139, s30, v191
v_sub_f32 v233, v124, v132
v_sub_f32 v234, v125, v133
v_cvt_pk_bf16_f32 v144, v233, v234
v_sub_f32 v233, v126, v134
v_sub_f32 v234, v127, v135
v_cvt_pk_bf16_f32 v145, v233, v234
v_sub_f32 v233, v128, v136
v_sub_f32 v234, v129, v137
v_cvt_pk_bf16_f32 v146, v233, v234
v_sub_f32 v233, v130, v138
v_sub_f32 v234, v131, v139
v_cvt_pk_bf16_f32 v147, v233, v234
ds_write_b128 v248, v[144:147] offset:0
v_lshlrev_b32 v124, 16, v48
v_and_b32 v125, s30, v48
v_lshlrev_b32 v126, 16, v49
v_and_b32 v127, s30, v49
v_lshlrev_b32 v128, 16, v50
v_and_b32 v129, s30, v50
v_lshlrev_b32 v130, 16, v51
v_and_b32 v131, s30, v51
v_lshlrev_b32 v132, 16, v56
v_and_b32 v133, s30, v56
v_lshlrev_b32 v134, 16, v57
v_and_b32 v135, s30, v57
v_lshlrev_b32 v136, 16, v58
v_and_b32 v137, s30, v58
v_lshlrev_b32 v138, 16, v59
v_and_b32 v139, s30, v59
v_sub_f32 v233, v124, v132
v_sub_f32 v234, v125, v133
v_cvt_pk_bf16_f32 v140, v233, v234
v_sub_f32 v233, v126, v134
v_sub_f32 v234, v127, v135
v_cvt_pk_bf16_f32 v141, v233, v234
v_sub_f32 v233, v128, v136
v_sub_f32 v234, v129, v137
v_cvt_pk_bf16_f32 v142, v233, v234
v_sub_f32 v233, v130, v138
v_sub_f32 v234, v131, v139
v_cvt_pk_bf16_f32 v143, v233, v234
ds_write_b128 v156, v[140:143] offset:16256
v_lshlrev_b32 v124, 16, v64
v_and_b32 v125, s30, v64
v_lshlrev_b32 v126, 16, v65
v_and_b32 v127, s30, v65
v_lshlrev_b32 v128, 16, v66
v_and_b32 v129, s30, v66
v_lshlrev_b32 v130, 16, v67
v_and_b32 v131, s30, v67
v_sub_f32 v233, v132, v124
v_sub_f32 v234, v133, v125
v_cvt_pk_bf16_f32 v144, v233, v234
v_sub_f32 v233, v134, v126
v_sub_f32 v234, v135, v127
v_cvt_pk_bf16_f32 v145, v233, v234
v_sub_f32 v233, v136, v128
v_sub_f32 v234, v137, v129
v_cvt_pk_bf16_f32 v146, v233, v234
v_sub_f32 v233, v138, v130
v_sub_f32 v234, v139, v131
v_cvt_pk_bf16_f32 v147, v233, v234
ds_write_b128 v157, v[144:147] offset:16256
s_waitcnt vmcnt(3)
v_lshlrev_b32 v132, 16, v72
v_and_b32 v133, s30, v72
v_lshlrev_b32 v134, 16, v73
v_and_b32 v135, s30, v73
v_lshlrev_b32 v136, 16, v74
v_and_b32 v137, s30, v74
v_lshlrev_b32 v138, 16, v75
v_and_b32 v139, s30, v75
v_sub_f32 v233, v124, v132
v_sub_f32 v234, v125, v133
v_cvt_pk_bf16_f32 v140, v233, v234
v_sub_f32 v233, v126, v134
v_sub_f32 v234, v127, v135
v_cvt_pk_bf16_f32 v141, v233, v234
v_sub_f32 v233, v128, v136
v_sub_f32 v234, v129, v137
v_cvt_pk_bf16_f32 v142, v233, v234
v_sub_f32 v233, v130, v138
v_sub_f32 v234, v131, v139
v_cvt_pk_bf16_f32 v143, v233, v234
ds_write_b128 v158, v[140:143] offset:16256
s_waitcnt vmcnt(2)
v_lshlrev_b32 v124, 16, v192
v_and_b32 v125, s30, v192
v_lshlrev_b32 v126, 16, v193
v_and_b32 v127, s30, v193
v_lshlrev_b32 v128, 16, v194
v_and_b32 v129, s30, v194
v_lshlrev_b32 v130, 16, v195
v_and_b32 v131, s30, v195
v_lshlrev_b32 v132, 16, v196
v_and_b32 v133, s30, v196
v_lshlrev_b32 v134, 16, v197
v_and_b32 v135, s30, v197
v_lshlrev_b32 v136, 16, v198
v_and_b32 v137, s30, v198
v_lshlrev_b32 v138, 16, v199
v_and_b32 v139, s30, v199
v_sub_f32 v233, v124, v132
v_sub_f32 v234, v125, v133
v_cvt_pk_bf16_f32 v144, v233, v234
v_sub_f32 v233, v126, v134
v_sub_f32 v234, v127, v135
v_cvt_pk_bf16_f32 v145, v233, v234
v_sub_f32 v233, v128, v136
v_sub_f32 v234, v129, v137
v_cvt_pk_bf16_f32 v146, v233, v234
v_sub_f32 v233, v130, v138
v_sub_f32 v234, v131, v139
v_cvt_pk_bf16_f32 v147, v233, v234
ds_write_b128 v248, v[144:147] offset:16256
v_lshlrev_b32 v124, 16, v88
v_and_b32 v125, s30, v88
v_lshlrev_b32 v126, 16, v89
v_and_b32 v127, s30, v89
v_lshlrev_b32 v128, 16, v90
v_and_b32 v129, s30, v90
v_lshlrev_b32 v130, 16, v91
v_and_b32 v131, s30, v91
v_lshlrev_b32 v132, 16, v96
v_and_b32 v133, s30, v96
v_lshlrev_b32 v134, 16, v97
v_and_b32 v135, s30, v97
v_lshlrev_b32 v136, 16, v98
v_and_b32 v137, s30, v98
v_lshlrev_b32 v138, 16, v99
v_and_b32 v139, s30, v99
v_sub_f32 v233, v124, v132
v_sub_f32 v234, v125, v133
v_cvt_pk_bf16_f32 v140, v233, v234
v_sub_f32 v233, v126, v134
v_sub_f32 v234, v127, v135
v_cvt_pk_bf16_f32 v141, v233, v234
v_sub_f32 v233, v128, v136
v_sub_f32 v234, v129, v137
v_cvt_pk_bf16_f32 v142, v233, v234
v_sub_f32 v233, v130, v138
v_sub_f32 v234, v131, v139
v_cvt_pk_bf16_f32 v143, v233, v234
ds_write_b128 v156, v[140:143] offset:32512
v_lshlrev_b32 v124, 16, v104
v_and_b32 v125, s30, v104
v_lshlrev_b32 v126, 16, v105
v_and_b32 v127, s30, v105
v_lshlrev_b32 v128, 16, v106
v_and_b32 v129, s30, v106
v_lshlrev_b32 v130, 16, v107
v_and_b32 v131, s30, v107
v_sub_f32 v233, v132, v124
v_sub_f32 v234, v133, v125
v_cvt_pk_bf16_f32 v144, v233, v234
v_sub_f32 v233, v134, v126
v_sub_f32 v234, v135, v127
v_cvt_pk_bf16_f32 v145, v233, v234
v_sub_f32 v233, v136, v128
v_sub_f32 v234, v137, v129
v_cvt_pk_bf16_f32 v146, v233, v234
v_sub_f32 v233, v138, v130
v_sub_f32 v234, v139, v131
v_cvt_pk_bf16_f32 v147, v233, v234
ds_write_b128 v157, v[144:147] offset:32512
s_waitcnt vmcnt(1)
v_lshlrev_b32 v132, 16, v112
v_and_b32 v133, s30, v112
v_lshlrev_b32 v134, 16, v113
v_and_b32 v135, s30, v113
v_lshlrev_b32 v136, 16, v114
v_and_b32 v137, s30, v114
v_lshlrev_b32 v138, 16, v115
v_and_b32 v139, s30, v115
v_sub_f32 v233, v124, v132
v_sub_f32 v234, v125, v133
v_cvt_pk_bf16_f32 v140, v233, v234
v_sub_f32 v233, v126, v134
v_sub_f32 v234, v127, v135
v_cvt_pk_bf16_f32 v141, v233, v234
v_sub_f32 v233, v128, v136
v_sub_f32 v234, v129, v137
v_cvt_pk_bf16_f32 v142, v233, v234
v_sub_f32 v233, v130, v138
v_sub_f32 v234, v131, v139
v_cvt_pk_bf16_f32 v143, v233, v234
ds_write_b128 v158, v[140:143] offset:32512
s_waitcnt vmcnt(0)
v_lshlrev_b32 v124, 16, v200
v_and_b32 v125, s30, v200
v_lshlrev_b32 v126, 16, v201
v_and_b32 v127, s30, v201
v_lshlrev_b32 v128, 16, v202
v_and_b32 v129, s30, v202
v_lshlrev_b32 v130, 16, v203
v_and_b32 v131, s30, v203
v_lshlrev_b32 v132, 16, v204
v_and_b32 v133, s30, v204
v_lshlrev_b32 v134, 16, v205
v_and_b32 v135, s30, v205
v_lshlrev_b32 v136, 16, v206
v_and_b32 v137, s30, v206
v_lshlrev_b32 v138, 16, v207
v_and_b32 v139, s30, v207
v_sub_f32 v233, v124, v132
v_sub_f32 v234, v125, v133
v_cvt_pk_bf16_f32 v144, v233, v234
v_sub_f32 v233, v126, v134
v_sub_f32 v234, v127, v135
v_cvt_pk_bf16_f32 v145, v233, v234
v_sub_f32 v233, v128, v136
v_sub_f32 v234, v129, v137
v_cvt_pk_bf16_f32 v146, v233, v234
v_sub_f32 v233, v130, v138
v_sub_f32 v234, v131, v139
v_cvt_pk_bf16_f32 v147, v233, v234
ds_write_b128 v248, v[144:147] offset:32512
s_lshl_b32 s32, s29, 1
s_add_u32 s32, s32, s25
s_mul_i32 s32, s32, 224
s_lshl_b32 s33, s35, 1
s_add_u32 s33, s33, s26
s_add_u32 s32, s32, s33
s_mul_i32 s32, s32, 384
s_mov_b32 s33, 172032
s_lshl_b32 s36, s31, 6
s_add_u32 s36, s36, 0
v_add_u32 v236, s36, v0
v_mul_u32_u24 v237, 2731, v236
v_lshrrev_b32 v237, 16, v237
v_mul_u32_u24 v238, 24, v237
v_sub_u32 v238, v236, v238
v_mul_u32_u24 v160, 400, v237
v_lshl_add_u32 v160, v238, 4, v160
v_mul_u32_u24 v239, 147, v237
v_lshrrev_b32 v239, 10, v239
v_mul_u32_u24 v240, 7, v239
v_sub_u32 v240, v237, v240
v_mul_u32_u24 v240, 1536, v240
v_lshl_add_u32 v240, v238, 4, v240
v_mul_lo_u32 v239, v239, s33
v_add_u32 v240, v240, v239
v_add_u32 v240, s32, v240
v_mov_b32 v171, v240
s_lshl_b32 s36, s31, 6
s_add_u32 s36, s36, 256
v_add_u32 v236, s36, v0
v_mul_u32_u24 v237, 2731, v236
v_lshrrev_b32 v237, 16, v237
v_mul_u32_u24 v238, 24, v237
v_sub_u32 v238, v236, v238
v_mul_u32_u24 v161, 400, v237
v_lshl_add_u32 v161, v238, 4, v161
v_mul_u32_u24 v239, 147, v237
v_lshrrev_b32 v239, 10, v239
v_mul_u32_u24 v240, 7, v239
v_sub_u32 v240, v237, v240
v_mul_u32_u24 v240, 1536, v240
v_lshl_add_u32 v240, v238, 4, v240
v_mul_lo_u32 v239, v239, s33
v_add_u32 v240, v240, v239
v_add_u32 v240, s32, v240
v_mov_b32 v172, v240
s_lshl_b32 s36, s31, 6
s_add_u32 s36, s36, 512
v_add_u32 v236, s36, v0
v_mul_u32_u24 v237, 2731, v236
v_lshrrev_b32 v237, 16, v237
v_mul_u32_u24 v238, 24, v237
v_sub_u32 v238, v236, v238
v_mul_u32_u24 v162, 400, v237
v_lshl_add_u32 v162, v238, 4, v162
v_mul_u32_u24 v239, 147, v237
v_lshrrev_b32 v239, 10, v239
v_mul_u32_u24 v240, 7, v239
v_sub_u32 v240, v237, v240
v_mul_u32_u24 v240, 1536, v240
v_lshl_add_u32 v240, v238, 4, v240
v_mul_lo_u32 v239, v239, s33
v_add_u32 v240, v240, v239
v_add_u32 v240, s32, v240
v_mov_b32 v173, v240
s_lshl_b32 s36, s31, 6
s_add_u32 s36, s36, 768
v_add_u32 v236, s36, v0
v_mul_u32_u24 v237, 2731, v236
v_lshrrev_b32 v237, 16, v237
v_mul_u32_u24 v238, 24, v237
v_sub_u32 v238, v236, v238
v_mul_u32_u24 v163, 400, v237
v_lshl_add_u32 v163, v238, 4, v163
v_mul_u32_u24 v239, 147, v237
v_lshrrev_b32 v239, 10, v239
v_mul_u32_u24 v240, 7, v239
v_sub_u32 v240, v237, v240
v_mul_u32_u24 v240, 1536, v240
v_lshl_add_u32 v240, v238, 4, v240
v_mul_lo_u32 v239, v239, s33
v_add_u32 v240, v240, v239
v_add_u32 v240, s32, v240
v_mov_b32 v174, v240
s_lshl_b32 s36, s31, 6
s_add_u32 s36, s36, 1024
v_add_u32 v236, s36, v0
v_mul_u32_u24 v237, 2731, v236
v_lshrrev_b32 v237, 16, v237
v_mul_u32_u24 v238, 24, v237
v_sub_u32 v238, v236, v238
v_mul_u32_u24 v164, 400, v237
v_lshl_add_u32 v164, v238, 4, v164
v_mul_u32_u24 v239, 147, v237
v_lshrrev_b32 v239, 10, v239
v_mul_u32_u24 v240, 7, v239
v_sub_u32 v240, v237, v240
v_mul_u32_u24 v240, 1536, v240
v_lshl_add_u32 v240, v238, 4, v240
v_mul_lo_u32 v239, v239, s33
v_add_u32 v240, v240, v239
v_add_u32 v240, s32, v240
v_mov_b32 v175, v240
s_lshl_b32 s36, s31, 6
s_add_u32 s36, s36, 1280
v_add_u32 v236, s36, v0
v_mul_u32_u24 v237, 2731, v236
v_lshrrev_b32 v237, 16, v237
v_mul_u32_u24 v238, 24, v237
v_sub_u32 v238, v236, v238
v_mul_u32_u24 v165, 400, v237
v_lshl_add_u32 v165, v238, 4, v165
v_mul_u32_u24 v239, 147, v237
v_lshrrev_b32 v239, 10, v239
v_mul_u32_u24 v240, 7, v239
v_sub_u32 v240, v237, v240
v_mul_u32_u24 v240, 1536, v240
v_lshl_add_u32 v240, v238, 4, v240
v_mul_lo_u32 v239, v239, s33
v_add_u32 v240, v240, v239
v_add_u32 v240, s32, v240
v_mov_b32 v176, v240
s_lshl_b32 s36, s31, 6
s_add_u32 s36, s36, 1536
v_add_u32 v236, s36, v0
v_mul_u32_u24 v237, 2731, v236
v_lshrrev_b32 v237, 16, v237
v_mul_u32_u24 v238, 24, v237
v_sub_u32 v238, v236, v238
v_mul_u32_u24 v166, 400, v237
v_lshl_add_u32 v166, v238, 4, v166
v_mul_u32_u24 v239, 147, v237
v_lshrrev_b32 v239, 10, v239
v_mul_u32_u24 v240, 7, v239
v_sub_u32 v240, v237, v240
v_mul_u32_u24 v240, 1536, v240
v_lshl_add_u32 v240, v238, 4, v240
v_mul_lo_u32 v239, v239, s33
v_add_u32 v240, v240, v239
v_add_u32 v240, s32, v240
v_mov_b32 v177, v240
s_lshl_b32 s36, s31, 6
s_add_u32 s36, s36, 1792
v_add_u32 v236, s36, v0
v_mul_u32_u24 v237, 2731, v236
v_lshrrev_b32 v237, 16, v237
v_mul_u32_u24 v238, 24, v237
v_sub_u32 v238, v236, v238
v_mul_u32_u24 v167, 400, v237
v_lshl_add_u32 v167, v238, 4, v167
v_mul_u32_u24 v239, 147, v237
v_lshrrev_b32 v239, 10, v239
v_mul_u32_u24 v240, 7, v239
v_sub_u32 v240, v237, v240
v_mul_u32_u24 v240, 1536, v240
v_lshl_add_u32 v240, v238, 4, v240
v_mul_lo_u32 v239, v239, s33
v_add_u32 v240, v240, v239
v_add_u32 v240, s32, v240
v_mov_b32 v178, v240
s_lshl_b32 s36, s31, 6
s_add_u32 s36, s36, 2048
v_add_u32 v236, s36, v0
v_mul_u32_u24 v237, 2731, v236
v_lshrrev_b32 v237, 16, v237
v_mul_u32_u24 v238, 24, v237
v_sub_u32 v238, v236, v238
v_mul_u32_u24 v168, 400, v237
v_lshl_add_u32 v168, v238, 4, v168
v_mul_u32_u24 v239, 147, v237
v_lshrrev_b32 v239, 10, v239
v_mul_u32_u24 v240, 7, v239
v_sub_u32 v240, v237, v240
v_mul_u32_u24 v240, 1536, v240
v_lshl_add_u32 v240, v238, 4, v240
v_mul_lo_u32 v239, v239, s33
v_add_u32 v240, v240, v239
v_add_u32 v240, s32, v240
v_mov_b32 v179, v240
s_lshl_b32 s36, s31, 6
s_add_u32 s36, s36, 2304
v_add_u32 v236, s36, v0
v_mul_u32_u24 v237, 2731, v236
v_lshrrev_b32 v237, 16, v237
v_mul_u32_u24 v238, 24, v237
v_sub_u32 v238, v236, v238
v_mul_u32_u24 v169, 400, v237
v_lshl_add_u32 v169, v238, 4, v169
v_mul_u32_u24 v239, 147, v237
v_lshrrev_b32 v239, 10, v239
v_mul_u32_u24 v240, 7, v239
v_sub_u32 v240, v237, v240
v_mul_u32_u24 v240, 1536, v240
v_lshl_add_u32 v240, v238, 4, v240
v_mul_lo_u32 v239, v239, s33
v_add_u32 v240, v240, v239
v_add_u32 v240, s32, v240
v_mov_b32 v180, v240
s_lshl_b32 s36, s31, 6
s_add_u32 s36, s36, 2560
v_add_u32 v236, s36, v0
v_mul_u32_u24 v237, 2731, v236
v_lshrrev_b32 v237, 16, v237
v_mul_u32_u24 v238, 24, v237
v_sub_u32 v238, v236, v238
v_mul_u32_u24 v170, 400, v237
v_lshl_add_u32 v170, v238, 4, v170
v_mul_u32_u24 v239, 147, v237
v_lshrrev_b32 v239, 10, v239
v_mul_u32_u24 v240, 7, v239
v_sub_u32 v240, v237, v240
v_mul_u32_u24 v240, 1536, v240
v_lshl_add_u32 v240, v238, 4, v240
v_mul_lo_u32 v239, v239, s33
v_add_u32 v240, v240, v239
v_add_u32 v240, s32, v240
v_mov_b32 v239, 0x7ff00000
v_cmp_gt_u32 vcc, 112, v237
s_nop 1
v_cndmask_b32 v181, v239, v240, vcc
s_waitcnt lgkmcnt(0)
s_barrier
s_barrier
s_mov_b32 s36, 0
ds_read_b128 v[184:187], v160 offset:0
ds_read_b128 v[188:191], v161 offset:0
ds_read_b128 v[192:195], v162 offset:0
s_waitcnt lgkmcnt(2)
buffer_store_dwordx4 v[184:187], v171, s[16:19], s36 offen nt
s_waitcnt lgkmcnt(1)
buffer_store_dwordx4 v[188:191], v172, s[16:19], s36 offen nt
s_waitcnt lgkmcnt(0)
buffer_store_dwordx4 v[192:195], v173, s[16:19], s36 offen nt
s_barrier
s_mov_b32 s36, 0
ds_read_b128 v[196:199], v163 offset:0
ds_read_b128 v[200:203], v164 offset:0
ds_read_b128 v[204:207], v165 offset:0
s_waitcnt lgkmcnt(2)
buffer_store_dwordx4 v[196:199], v174, s[16:19], s36 offen nt
s_waitcnt lgkmcnt(1)
buffer_store_dwordx4 v[200:203], v175, s[16:19], s36 offen nt
s_waitcnt lgkmcnt(0)
buffer_store_dwordx4 v[204:207], v176, s[16:19], s36 offen nt
s_barrier
s_mov_b32 s36, 0
ds_read_b128 v[208:211], v166 offset:0
ds_read_b128 v[212:215], v167 offset:0
ds_read_b128 v[216:219], v168 offset:0
s_waitcnt lgkmcnt(2)
buffer_store_dwordx4 v[208:211], v177, s[16:19], s36 offen nt
s_waitcnt lgkmcnt(1)
buffer_store_dwordx4 v[212:215], v178, s[16:19], s36 offen nt
s_waitcnt lgkmcnt(0)
buffer_store_dwordx4 v[216:219], v179, s[16:19], s36 offen nt
s_barrier
s_mov_b32 s36, 0
ds_read_b128 v[220:223], v169 offset:0
ds_read_b128 v[224:227], v170 offset:0
s_waitcnt lgkmcnt(1)
buffer_store_dwordx4 v[220:223], v180, s[16:19], s36 offen nt
s_waitcnt lgkmcnt(0)
buffer_store_dwordx4 v[224:227], v181, s[16:19], s36 offen nt
v_add_u32 v160, 97536, v160
v_add_u32 v161, 97536, v161
v_add_u32 v162, 97536, v162
v_add_u32 v163, 97536, v163
v_add_u32 v164, 97536, v164
v_add_u32 v165, 97536, v165
v_add_u32 v166, 97536, v166
v_add_u32 v167, 97536, v167
v_add_u32 v168, 97536, v168
v_add_u32 v169, 97536, v169
v_add_u32 v170, 97536, v170
s_barrier
s_mov_b32 s36, 768
ds_read_b128 v[184:187], v160 offset:0
ds_read_b128 v[188:191], v161 offset:0
ds_read_b128 v[192:195], v162 offset:0
s_waitcnt lgkmcnt(2)
buffer_store_dwordx4 v[184:187], v171, s[16:19], s36 offen nt
s_waitcnt lgkmcnt(1)
buffer_store_dwordx4 v[188:191], v172, s[16:19], s36 offen nt
s_waitcnt lgkmcnt(0)
buffer_store_dwordx4 v[192:195], v173, s[16:19], s36 offen nt
s_barrier
s_mov_b32 s36, 768
ds_read_b128 v[196:199], v163 offset:0
ds_read_b128 v[200:203], v164 offset:0
ds_read_b128 v[204:207], v165 offset:0
s_waitcnt lgkmcnt(2)
buffer_store_dwordx4 v[196:199], v174, s[16:19], s36 offen nt
s_waitcnt lgkmcnt(1)
buffer_store_dwordx4 v[200:203], v175, s[16:19], s36 offen nt
s_waitcnt lgkmcnt(0)
buffer_store_dwordx4 v[204:207], v176, s[16:19], s36 offen nt
s_barrier
s_mov_b32 s36, 768
ds_read_b128 v[208:211], v166 offset:0
ds_read_b128 v[212:215], v167 offset:0
ds_read_b128 v[216:219], v168 offset:0
s_waitcnt lgkmcnt(2)
buffer_store_dwordx4 v[208:211], v177, s[16:19], s36 offen nt
s_waitcnt lgkmcnt(1)
buffer_store_dwordx4 v[212:215], v178, s[16:19], s36 offen nt
s_waitcnt lgkmcnt(0)
buffer_store_dwordx4 v[216:219], v179, s[16:19], s36 offen nt
s_barrier
s_mov_b32 s36, 768
ds_read_b128 v[220:223], v169 offset:0
ds_read_b128 v[224:227], v170 offset:0
s_waitcnt lgkmcnt(1)
buffer_store_dwordx4 v[220:223], v180, s[16:19], s36 offen nt
s_waitcnt lgkmcnt(0)
buffer_store_dwordx4 v[224:227], v181, s[16:19], s36 offen nt
s_endpgm
L_end:
s_endpgm
.section .rodata,"a"
.p2align 6
.amdhsa_kernel standalone__dilated_atrous__vision_kernel
  .amdhsa_next_free_vgpr 256
  .amdhsa_next_free_sgpr 102
  .amdhsa_accum_offset 256
  .amdhsa_group_segment_fixed_size 0
  .amdhsa_kernarg_size 40
  .amdhsa_user_sgpr_count 2
  .amdhsa_user_sgpr_kernarg_segment_ptr 1
  .amdhsa_system_sgpr_workgroup_id_x 1
  .amdhsa_float_denorm_mode_32 3
.end_amdhsa_kernel
```
